```python
import torch

def _softmax(x, axis=-1):
    return torch.softmax(x, dim=axis)

def _gelu(x):
    return torch.nn.functional.gelu(x, approximate='tanh')

def _silu(x):
    return torch.nn.functional.silu(x)

def _sigmoid(x):
    return torch.sigmoid(x)

def _layernorm(x, axis=-1, eps=1e-05):
    m = x.mean(dim=axis, keepdim=True)
    v = x.var(dim=axis, keepdim=True, unbiased=False)
    return (x - m) / torch.sqrt(v + eps)

def _scatter_add(tgt, idx, src, axis=0):
    return tgt.clone().index_add_(axis, idx, src)

def _segment_sum(src, seg, n):
    out = torch.zeros((n,) + src.shape[1:], dtype=src.dtype)
    return out.index_add_(0, seg, src)

def _pad(x, pw):
    flat = tuple((v for pair in reversed(pw) for v in pair))
    return torch.nn.functional.pad(x, flat)
kernel_name = 'standalone__autoregressive_conv_wavernn__speech'

def setup_inputs():

    _w = lambda a: (lambda t: t.to(torch.bfloat16) if t.is_floating_point() else t)(torch.as_tensor(a))
    B, T, D, K = (2, 16000, 256, 5)
    return {'x': _w((lambda *s: torch.randn(*s, dtype=torch.bfloat16) * 0.1)(B, T, D)), 'w': _w((lambda *s: torch.randn(*s, dtype=torch.bfloat16) * 0.1)(K, D, 2 * D))}

def reference(x, w):
    B, T, D = x.shape
    K = w.shape[0]
    dil = 2
    pad = (K - 1) * dil
    xp = _pad(x, ((0, 0), (pad, 0), (0, 0)))
    h = torch.einsum('btd,de->bte', xp[:, 0:T, :], w[0])
    for i in range(1, K):
        h = h + torch.einsum('btd,de->bte', xp[:, i * dil:i * dil + T, :], w[i])
    f, g = (h[..., :D].clone(), h[..., D:].clone())
    return torch.tanh(f) * _sigmoid(g)
```

```asm
; @launch grid=(256,1,1) block=(256,1,1) lds=163840
.amdgcn_target "amdgcn-amd-amdhsa--gfx950"
.text
.globl standalone__autoregressive_conv_wavernn__speech_kernel
.p2align 8
.type standalone__autoregressive_conv_wavernn__speech_kernel,@function
standalone__autoregressive_conv_wavernn__speech_kernel:
    s_load_dwordx4 s[4:7], s[0:1], 0
    s_load_dwordx4 s[8:11], s[0:1], 16
    s_load_dwordx2 s[44:45], s[0:1], 32
    s_cmp_ge_u32 s2, 256
    s_cbranch_scc1 L_exit
    s_lshr_b32 s24, s2, 4
    s_and_b32 s25, s2, 7
    s_lshl_b32 s24, s24, 3
    s_add_u32 s24, s24, s25
    s_bfe_u32 s26, s2, 0x10003
    s_cmp_ge_u32 s24, 126
    s_cbranch_scc1 L_helper
    s_cmp_ge_u32 s24, 63
    s_cselect_b32 s27, 63, 0
    s_cselect_b32 s28, 8192000, 0
    s_sub_u32 s24, s24, s27
    s_mul_i32 s29, s24, 130048
    s_lshl_b32 s26, s26, 8
    v_and_b32 v27, 63, v0
    v_lshrrev_b32 v28, 6, v0
    v_lshrrev_b32 v29, 4, v27
    v_readfirstlane_b32 s30, v28
    v_lshrrev_b32 v30, 5, v27
    v_lshlrev_b32 v30, 14, v30
    v_bfe_u32 v31, v27, 3, 1
    v_lshl_add_u32 v30, v31, 13, v30
    v_bfe_u32 v31, v27, 4, 1
    v_lshl_add_u32 v30, v31, 12, v30
    v_bfe_u32 v31, v27, 2, 1
    v_lshl_add_u32 v30, v31, 11, v30
    v_and_b32 v31, 3, v27
    v_lshl_add_u32 v30, v31, 4, v30
    v_lshl_add_u32 v30, v28, 6, v30
    v_add_u32 v18, s26, v30
    v_xor_b32 v19, 32, v18
    v_and_b32 v30, 1, v28
    v_lshl_add_u32 v30, v30, 2, v29
    v_xor_b32 v31, v30, v27
    v_and_b32 v31, 7, v31
    v_lshlrev_b32 v31, 4, v31
    v_lshl_add_u32 v31, v30, 14, v31
    v_bfe_u32 v30, v27, 3, 1
    v_lshl_add_u32 v31, v30, 9, v31
    v_lshrrev_b32 v30, 1, v28
    v_mul_u32_u24 v30, 10240, v30
    v_add3_u32 v17, v30, v31, s29
    v_add_u32 v16, 0xfffff000, v17
    s_lshl_b32 s36, s30, 11
    s_lshr_b32 s37, s30, 1
    s_mul_i32 s37, s37, 10240
    s_and_b32 s38, s30, 1
    s_lshl_b32 s38, s38, 10
    s_add_u32 s37, s37, s38
    s_waitcnt lgkmcnt(0)
    s_mov_b32 s16, s6
    s_mov_b32 s17, s7
    s_mov_b32 s18, 1310720
    s_mov_b32 s19, 0x20000
    s_add_u32 s12, s4, s28
    s_addc_u32 s13, s5, 0
    s_mov_b32 s14, 8192000
    s_mov_b32 s15, 0x20000
    s_add_u32 m0, s36, 102400
    s_mov_b32 s38, 262144
    buffer_load_dwordx4 v18, s[16:19], s38 offen offset:0 lds
    buffer_load_dwordx4 v19, s[16:19], s38 offen offset:1024 lds
    s_add_u32 m0, s36, 110592
    s_mov_b32 s38, 262656
    buffer_load_dwordx4 v18, s[16:19], s38 offen offset:0 lds
    buffer_load_dwordx4 v19, s[16:19], s38 offen offset:1024 lds
    s_add_u32 m0, s37, 0
    s_mov_b32 s38, 1024
    buffer_load_dwordx4 v16, s[12:15], s38 offen offset:0 nt lds
    buffer_load_dwordx4 v16, s[12:15], s38 offen offset:2048 nt lds
    s_add_u32 m0, s37, 4096
    s_nop 0
    buffer_load_dwordx4 v17, s[12:15], s38 offen offset:0 nt lds
    buffer_load_dwordx4 v17, s[12:15], s38 offen offset:2048 nt lds
    s_add_u32 m0, s37, 8192
    s_mov_b32 s38, 5120
    buffer_load_dwordx4 v17, s[12:15], s38 offen offset:0 nt lds
    s_getpc_b64 s[56:57]
L_pc:
    s_lshr_b32 s58, s2, 3
    s_lshl_b32 s58, s58, 2
    s_add_u32 s58, s58, s30
    s_lshl_b32 s59, s58, 9
    v_min_u32 v30, 3, v27
    v_lshlrev_b32 v30, 7, v30
    v_add_u32 v30, s59, v30
    s_mov_b32 s59, L_code_end-L_pc-4
    v_min_u32 v30, s59, v30
    global_load_dword a192, v30, s[56:57]
    s_mul_i32 s58, s58, 20
    v_min_u32 v26, 19, v27
    v_add_u32 v26, s58, v26
    v_lshrrev_b32 v31, 9, v26
    v_mul_u32_u24 v31, 1536, v31
    v_add_u32 v26, v26, v31
    v_lshlrev_b32 v26, 7, v26
    s_mov_b32 s55, 65536
    buffer_load_dword a193, v26, s[16:19], 0 offen
    s_mov_b32 s24, 131072
    s_mov_b32 s25, 196608
    v_and_b32 v30, 15, v27
    v_lshrrev_b32 v31, 1, v30
    v_xor_b32 v14, v31, v29
    v_lshlrev_b32 v14, 4, v14
    v_and_b32 v15, 7, v27
    v_lshl_add_u32 v14, v15, 7, v14
    v_bfe_u32 v15, v27, 3, 1
    v_lshl_add_u32 v0, v15, 10, v14
    v_xor_b32 v1, 64, v0
    v_lshlrev_b32 v14, 4, v27
    v_add_u32 v2, s37, v14
    s_lshl_b32 s58, s26, 6
    s_lshl_b32 s59, s30, 12
    s_add_u32 s58, s58, s59
    v_add_u32 v3, s58, v14
    v_and_b32 v14, 1, v30
    v_lshl_add_u32 v14, v31, 5, v14
    v_lshlrev_b32 v14, 9, v14
    v_and_b32 v15, 1, v29
    v_lshl_add_u32 v14, v15, 5, v14
    v_lshrrev_b32 v15, 1, v29
    v_lshl_add_u32 v14, v15, 4, v14
    v_lshl_add_u32 v14, v28, 6, v14
    s_add_u32 s29, s29, s26
    v_add_u32 v4, s29, v14
    v_bfe_u32 v14, v27, 2, 1
    v_lshlrev_b32 v15, 10, v14
    v_lshl_add_u32 v15, v14, 5, v15
    v_lshrrev_b32 v14, 5, v27
    v_lshl_add_u32 v15, v14, 9, v15
    v_bfe_u32 v14, v27, 4, 1
    v_lshl_add_u32 v15, v14, 7, v15
    v_bfe_u32 v14, v27, 3, 1
    v_lshl_add_u32 v15, v14, 6, v15
    v_and_b32 v14, 3, v27
    v_lshl_add_u32 v15, v14, 3, v15
    s_add_u32 s58, s36, 102400
    v_add_u32 v20, s58, v15
    v_xor_b32 v21, 32, v20
    v_mov_b32 v5, 0xc1800000
    s_add_u32 s20, s8, s28
    s_addc_u32 s21, s9, 0
    s_mov_b32 s22, 8192000
    s_mov_b32 s23, 0x20000
    s_mov_b32 s48, s10
    s_mov_b32 s49, s11
    s_mov_b32 s50, 256
    s_mov_b32 s51, 0x20000
    s_mov_b32 s46, 1441792
    s_mov_b32 s47, 0x20000
    s_mov_b32 s31, 0xc038aa3b
    s_mov_b32 s32, 0xbfb8aa3b
    s_mov_b32 s33, 0x47000000
    s_mov_b32 s34, 0xffff0000
    s_mov_b32 s52, 4096
    s_mov_b32 s53, 8192
    s_mov_b32 s54, 12288
    s_branch L_main
.p2align 12
L_main:
    s_add_u32 m0, s36, 122880
    s_mov_b32 s38, 786432
    buffer_load_dwordx4 v18, s[16:19], s38 offen offset:0 lds
    buffer_load_dwordx4 v19, s[16:19], s38 offen offset:1024 lds
    s_add_u32 m0, s36, 131072
    s_mov_b32 s38, 786944
    buffer_load_dwordx4 v18, s[16:19], s38 offen offset:0 lds
    buffer_load_dwordx4 v19, s[16:19], s38 offen offset:1024 lds
    s_add_u32 m0, s37, 40960
    s_mov_b32 s38, 0
    buffer_load_dwordx4 v16, s[12:15], s38 offen offset:0 nt lds
    buffer_load_dwordx4 v16, s[12:15], s38 offen offset:2048 nt lds
    s_add_u32 m0, s37, 45056
    s_nop 0
    buffer_load_dwordx4 v17, s[12:15], s38 offen offset:0 nt lds
    buffer_load_dwordx4 v17, s[12:15], s38 offen offset:2048 nt lds
    s_add_u32 m0, s37, 49152
    s_mov_b32 s38, 4096
    buffer_load_dwordx4 v17, s[12:15], s38 offen offset:0 nt lds
    s_waitcnt vmcnt(18)
    ds_read_b64_tr_b16 a[32:33], v20 offset:0
    ds_read_b64_tr_b16 a[34:35], v20 offset:256
    ds_read_b64_tr_b16 a[36:37], v21 offset:0
    ds_read_b64_tr_b16 a[38:39], v21 offset:256
    s_waitcnt vmcnt(16)
    ds_read_b64_tr_b16 a[40:41], v20 offset:8192
    ds_read_b64_tr_b16 a[42:43], v20 offset:8448
    ds_read_b64_tr_b16 a[44:45], v21 offset:8192
    ds_read_b64_tr_b16 a[46:47], v21 offset:8448
    s_waitcnt vmcnt(11)
    s_barrier
    ds_read_b128 a[208:211], v0 offset:0
    ds_read_b128 a[212:215], v0 offset:2048
    ds_read_b128 a[216:219], v0 offset:4096
    ds_read_b128 a[220:223], v0 offset:6144
    ds_read_b128 a[224:227], v0 offset:8192
    ds_read_b128 a[228:231], v0 offset:10240
    s_waitcnt lgkmcnt(5)
    v_mfma_f32_16x16x32_bf16 v[160:163], a[32:35], a[208:211], 0
    s_add_u32 m0, s36, 139264
    ds_read_b128 a[232:235], v0 offset:12288
    ds_read_b128 a[236:239], v0 offset:14336
    v_mfma_f32_16x16x32_bf16 v[164:167], a[36:39], a[208:211], 0
    s_mov_b32 s38, 294912
    buffer_load_dwordx4 v18, s[16:19], s38 offen offset:0 lds
    v_mfma_f32_16x16x32_bf16 v[168:171], a[40:43], a[208:211], 0
    ds_read_b128 a[240:243], v0 offset:2048
    ds_read_b128 a[244:247], v0 offset:4096
    v_mfma_f32_16x16x32_bf16 v[172:175], a[44:47], a[208:211], 0
    s_waitcnt lgkmcnt(8)
    ds_read_b128 a[248:251], v0 offset:6144
    v_mfma_f32_16x16x32_bf16 v[176:179], a[32:35], a[212:215], 0
    ds_read_b128 a[252:255], v0 offset:8192
    v_mfma_f32_16x16x32_bf16 v[180:183], a[36:39], a[212:215], 0
    buffer_load_dwordx4 v19, s[16:19], s38 offen offset:1024 lds
    v_mfma_f32_16x16x32_bf16 v[184:187], a[40:43], a[212:215], 0
    v_mfma_f32_16x16x32_bf16 v[188:191], a[44:47], a[212:215], 0
    s_waitcnt lgkmcnt(9)
    v_mfma_f32_16x16x32_bf16 v[192:195], a[32:35], a[216:219], 0
    ds_read_b128 a[208:211], v0 offset:10240
    v_mfma_f32_16x16x32_bf16 v[196:199], a[36:39], a[216:219], 0
    v_mfma_f32_16x16x32_bf16 v[200:203], a[40:43], a[216:219], 0
    v_mfma_f32_16x16x32_bf16 v[204:207], a[44:47], a[216:219], 0
    s_waitcnt lgkmcnt(9)
    v_mfma_f32_16x16x32_bf16 v[208:211], a[32:35], a[220:223], 0
    ds_read_b128 a[212:215], v0 offset:12288
    v_mfma_f32_16x16x32_bf16 v[212:215], a[36:39], a[220:223], 0
    v_mfma_f32_16x16x32_bf16 v[216:219], a[40:43], a[220:223], 0
    v_mfma_f32_16x16x32_bf16 v[220:223], a[44:47], a[220:223], 0
    s_waitcnt lgkmcnt(4)
    v_mfma_f32_16x16x32_bf16 v[224:227], a[32:35], a[224:227], 0
    ds_read_b128 a[216:219], v0 offset:14336
    v_mfma_f32_16x16x32_bf16 v[228:231], a[36:39], a[224:227], 0
    v_mfma_f32_16x16x32_bf16 v[232:235], a[40:43], a[224:227], 0
    v_mfma_f32_16x16x32_bf16 v[236:239], a[44:47], a[224:227], 0
    v_mfma_f32_16x16x32_bf16 v[240:243], a[32:35], a[228:231], 0
    ds_read_b128 a[220:223], v0 offset:16384
    v_mfma_f32_16x16x32_bf16 v[244:247], a[36:39], a[228:231], 0
    v_mfma_f32_16x16x32_bf16 v[248:251], a[40:43], a[228:231], 0
    s_waitcnt vmcnt(9) lgkmcnt(3)
    ds_read_b64_tr_b16 a[48:49], v20 offset:20480
    ds_read_b64_tr_b16 a[50:51], v20 offset:20736
    v_mfma_f32_16x16x32_bf16 v[252:255], a[44:47], a[228:231], 0
    ds_read_b64_tr_b16 a[52:53], v21 offset:20480
    ds_read_b64_tr_b16 a[54:55], v21 offset:20736
    v_mfma_f32_16x16x32_bf16 a[0:3], a[32:35], a[232:235], 0
    s_waitcnt vmcnt(7)
    ds_read_b64_tr_b16 a[56:57], v20 offset:28672
    ds_read_b64_tr_b16 a[58:59], v20 offset:28928
    v_mfma_f32_16x16x32_bf16 a[4:7], a[36:39], a[232:235], 0
    ds_read_b64_tr_b16 a[60:61], v21 offset:28672
    ds_read_b64_tr_b16 a[62:63], v21 offset:28928
    v_mfma_f32_16x16x32_bf16 a[8:11], a[40:43], a[232:235], 0
    ds_read_b128 a[224:227], v1 offset:0
    v_mfma_f32_16x16x32_bf16 a[12:15], a[44:47], a[232:235], 0
    v_mfma_f32_16x16x32_bf16 a[16:19], a[32:35], a[236:239], 0
    ds_read_b128 a[228:231], v1 offset:2048
    v_mfma_f32_16x16x32_bf16 a[20:23], a[36:39], a[236:239], 0
    v_mfma_f32_16x16x32_bf16 a[24:27], a[40:43], a[236:239], 0
    v_mfma_f32_16x16x32_bf16 a[28:31], a[44:47], a[236:239], 0
    s_waitcnt lgkmcnt(8)
    v_mfma_f32_16x16x32_bf16 v[160:163], a[48:51], a[240:243], v[160:163]
    s_waitcnt lgkmcnt(6)
    ds_read_b128 a[232:235], v1 offset:4096
    v_mfma_f32_16x16x32_bf16 v[164:167], a[52:55], a[240:243], v[164:167]
    s_waitcnt lgkmcnt(5)
    v_mfma_f32_16x16x32_bf16 v[168:171], a[56:59], a[240:243], v[168:171]
    s_waitcnt lgkmcnt(3)
    s_add_u32 m0, s36, 147456
    s_mov_b32 s38, 295424
    v_mfma_f32_16x16x32_bf16 v[172:175], a[60:63], a[240:243], v[172:175]
    buffer_load_dwordx4 v18, s[16:19], s38 offen offset:0 lds
    v_mfma_f32_16x16x32_bf16 v[176:179], a[48:51], a[244:247], v[176:179]
    ds_read_b128 a[236:239], v1 offset:6144
    v_mfma_f32_16x16x32_bf16 v[180:183], a[52:55], a[244:247], v[180:183]
    v_mfma_f32_16x16x32_bf16 v[184:187], a[56:59], a[244:247], v[184:187]
    v_mfma_f32_16x16x32_bf16 v[188:191], a[60:63], a[244:247], v[188:191]
    buffer_load_dwordx4 v19, s[16:19], s38 offen offset:1024 lds
    v_mfma_f32_16x16x32_bf16 v[192:195], a[48:51], a[248:251], v[192:195]
    ds_read_b128 a[240:243], v1 offset:8192
    v_mfma_f32_16x16x32_bf16 v[196:199], a[52:55], a[248:251], v[196:199]
    v_mfma_f32_16x16x32_bf16 v[200:203], a[56:59], a[248:251], v[200:203]
    s_add_u32 m0, s36, 155648
    s_mov_b32 s38, 819200
    v_mfma_f32_16x16x32_bf16 v[204:207], a[60:63], a[248:251], v[204:207]
    v_mfma_f32_16x16x32_bf16 v[208:211], a[48:51], a[252:255], v[208:211]
    buffer_load_dwordx4 v18, s[16:19], s38 offen offset:0 lds
    v_mfma_f32_16x16x32_bf16 v[212:215], a[52:55], a[252:255], v[212:215]
    ds_read_b128 a[244:247], v1 offset:10240
    v_mfma_f32_16x16x32_bf16 v[216:219], a[56:59], a[252:255], v[216:219]
    v_mfma_f32_16x16x32_bf16 v[220:223], a[60:63], a[252:255], v[220:223]
    v_mfma_f32_16x16x32_bf16 v[224:227], a[48:51], a[208:211], v[224:227]
    buffer_load_dwordx4 v19, s[16:19], s38 offen offset:1024 lds
    v_mfma_f32_16x16x32_bf16 v[228:231], a[52:55], a[208:211], v[228:231]
    ds_read_b128 a[248:251], v1 offset:12288
    v_mfma_f32_16x16x32_bf16 v[232:235], a[56:59], a[208:211], v[232:235]
    v_mfma_f32_16x16x32_bf16 v[236:239], a[60:63], a[208:211], v[236:239]
    s_add_u32 m0, s36, 102400
    s_mov_b32 s38, 819712
    v_mfma_f32_16x16x32_bf16 v[240:243], a[48:51], a[212:215], v[240:243]
    s_waitcnt vmcnt(4) lgkmcnt(3)
    ds_read_b64_tr_b16 a[64:65], v20 offset:36864
    ds_read_b64_tr_b16 a[66:67], v20 offset:37120
    v_mfma_f32_16x16x32_bf16 v[244:247], a[52:55], a[212:215], v[244:247]
    buffer_load_dwordx4 v18, s[16:19], s38 offen offset:0 lds
    v_mfma_f32_16x16x32_bf16 v[248:251], a[56:59], a[212:215], v[248:251]
    ds_read_b64_tr_b16 a[68:69], v21 offset:36864
    ds_read_b64_tr_b16 a[70:71], v21 offset:37120
    v_mfma_f32_16x16x32_bf16 v[252:255], a[60:63], a[212:215], v[252:255]
    ds_read_b128 a[252:255], v1 offset:14336
    v_mfma_f32_16x16x32_bf16 a[0:3], a[48:51], a[216:219], a[0:3]
    s_waitcnt vmcnt(3) lgkmcnt(7)
    ds_read_b64_tr_b16 a[72:73], v20 offset:45056
    ds_read_b64_tr_b16 a[74:75], v20 offset:45312
    v_mfma_f32_16x16x32_bf16 a[4:7], a[52:55], a[216:219], a[4:7]
    ds_read_b64_tr_b16 a[76:77], v21 offset:45056
    ds_read_b64_tr_b16 a[78:79], v21 offset:45312
    v_mfma_f32_16x16x32_bf16 a[8:11], a[56:59], a[216:219], a[8:11]
    buffer_load_dwordx4 v19, s[16:19], s38 offen offset:1024 lds
    v_mfma_f32_16x16x32_bf16 a[12:15], a[60:63], a[216:219], a[12:15]
    ds_read_b128 a[208:211], v1 offset:2048
    v_mfma_f32_16x16x32_bf16 a[16:19], a[48:51], a[220:223], a[16:19]
    s_add_u32 m0, s36, 110592
    ds_read_b128 a[212:215], v1 offset:4096
    s_mov_b32 s38, 0
    v_mfma_f32_16x16x32_bf16 a[20:23], a[52:55], a[220:223], a[20:23]
    v_mfma_f32_16x16x32_bf16 a[24:27], a[56:59], a[220:223], a[24:27]
    buffer_load_dwordx4 v18, s[16:19], s38 offen offset:0 lds
    v_mfma_f32_16x16x32_bf16 a[28:31], a[60:63], a[220:223], a[28:31]
    s_waitcnt lgkmcnt(9)
    v_mfma_f32_16x16x32_bf16 v[160:163], a[64:67], a[224:227], v[160:163]
    s_waitcnt lgkmcnt(7)
    ds_read_b128 a[216:219], v1 offset:6144
    v_mfma_f32_16x16x32_bf16 v[164:167], a[68:71], a[224:227], v[164:167]
    s_waitcnt lgkmcnt(5)
    v_mfma_f32_16x16x32_bf16 v[168:171], a[72:75], a[224:227], v[168:171]
    s_waitcnt lgkmcnt(3)
    buffer_load_dwordx4 v19, s[16:19], s38 offen offset:1024 lds
    v_mfma_f32_16x16x32_bf16 v[172:175], a[76:79], a[224:227], v[172:175]
    v_mfma_f32_16x16x32_bf16 v[176:179], a[64:67], a[228:231], v[176:179]
    ds_read_b128 a[220:223], v1 offset:8192
    v_mfma_f32_16x16x32_bf16 v[180:183], a[68:71], a[228:231], v[180:183]
    s_add_u32 m0, s36, 122880
    s_mov_b32 s38, 524288
    v_mfma_f32_16x16x32_bf16 v[184:187], a[72:75], a[228:231], v[184:187]
    v_mfma_f32_16x16x32_bf16 v[188:191], a[76:79], a[228:231], v[188:191]
    buffer_load_dwordx4 v18, s[16:19], s38 offen offset:0 lds
    v_mfma_f32_16x16x32_bf16 v[192:195], a[64:67], a[232:235], v[192:195]
    ds_read_b128 a[224:227], v1 offset:10240
    v_mfma_f32_16x16x32_bf16 v[196:199], a[68:71], a[232:235], v[196:199]
    v_mfma_f32_16x16x32_bf16 v[200:203], a[72:75], a[232:235], v[200:203]
    v_mfma_f32_16x16x32_bf16 v[204:207], a[76:79], a[232:235], v[204:207]
    buffer_load_dwordx4 v19, s[16:19], s38 offen offset:1024 lds
    v_mfma_f32_16x16x32_bf16 v[208:211], a[64:67], a[236:239], v[208:211]
    ds_read_b128 a[228:231], v1 offset:12288
    v_mfma_f32_16x16x32_bf16 v[212:215], a[68:71], a[236:239], v[212:215]
    v_mfma_f32_16x16x32_bf16 v[216:219], a[72:75], a[236:239], v[216:219]
    buffer_load_dword a194, v26, s[16:19], s55 offen
    v_mfma_f32_16x16x32_bf16 v[220:223], a[76:79], a[236:239], v[220:223]
    v_mfma_f32_16x16x32_bf16 v[224:227], a[64:67], a[240:243], v[224:227]
    s_waitcnt vmcnt(7) lgkmcnt(3)
    ds_read_b64_tr_b16 a[80:81], v20 offset:53248
    ds_read_b64_tr_b16 a[82:83], v20 offset:53504
    v_mfma_f32_16x16x32_bf16 v[228:231], a[68:71], a[240:243], v[228:231]
    s_add_u32 m0, s36, 131072
    ds_read_b64_tr_b16 a[84:85], v21 offset:53248
    ds_read_b64_tr_b16 a[86:87], v21 offset:53504
    v_mfma_f32_16x16x32_bf16 v[232:235], a[72:75], a[240:243], v[232:235]
    s_mov_b32 s38, 1048576
    ds_read_b128 a[232:235], v1 offset:14336
    v_mfma_f32_16x16x32_bf16 v[236:239], a[76:79], a[240:243], v[236:239]
    buffer_load_dwordx4 v18, s[16:19], s38 offen offset:0 lds
    v_mfma_f32_16x16x32_bf16 v[240:243], a[64:67], a[244:247], v[240:243]
    ds_read_b128 a[236:239], v1 offset:16384
    v_mfma_f32_16x16x32_bf16 v[244:247], a[68:71], a[244:247], v[244:247]
    v_mfma_f32_16x16x32_bf16 v[248:251], a[72:75], a[244:247], v[248:251]
    v_mfma_f32_16x16x32_bf16 v[252:255], a[76:79], a[244:247], v[252:255]
    buffer_load_dwordx4 v19, s[16:19], s38 offen offset:1024 lds
    v_mfma_f32_16x16x32_bf16 a[0:3], a[64:67], a[248:251], a[0:3]
    s_waitcnt vmcnt(7) lgkmcnt(7)
    ds_read_b64_tr_b16 a[88:89], v20 offset:0
    ds_read_b64_tr_b16 a[90:91], v20 offset:256
    v_mfma_f32_16x16x32_bf16 a[4:7], a[68:71], a[248:251], a[4:7]
    ds_read_b64_tr_b16 a[92:93], v21 offset:0
    ds_read_b64_tr_b16 a[94:95], v21 offset:256
    v_mfma_f32_16x16x32_bf16 a[8:11], a[72:75], a[248:251], a[8:11]
    s_add_u32 m0, s36, 139264
    s_mov_b32 s38, 512
    v_mfma_f32_16x16x32_bf16 a[12:15], a[76:79], a[248:251], a[12:15]
    v_mfma_f32_16x16x32_bf16 a[16:19], a[64:67], a[252:255], a[16:19]
    buffer_load_dwordx4 v18, s[16:19], s38 offen offset:0 lds
    v_mfma_f32_16x16x32_bf16 a[20:23], a[68:71], a[252:255], a[20:23]
    v_mfma_f32_16x16x32_bf16 a[24:27], a[72:75], a[252:255], a[24:27]
    v_mfma_f32_16x16x32_bf16 a[28:31], a[76:79], a[252:255], a[28:31]
    s_waitcnt lgkmcnt(5)
    v_mfma_f32_16x16x32_bf16 v[160:163], a[80:83], a[208:211], v[160:163]
    buffer_load_dwordx4 v19, s[16:19], s38 offen offset:1024 lds
    v_mfma_f32_16x16x32_bf16 v[164:167], a[84:87], a[208:211], v[164:167]
    s_waitcnt lgkmcnt(2)
    v_mfma_f32_16x16x32_bf16 v[168:171], a[88:91], a[208:211], v[168:171]
    s_waitcnt lgkmcnt(0)
    s_waitcnt vmcnt(7)
    ds_read_b64_tr_b16 a[96:97], v20 offset:8192
    v_mfma_f32_16x16x32_bf16 v[172:175], a[92:95], a[208:211], v[172:175]
    ds_read_b64_tr_b16 a[98:99], v20 offset:8448
    ds_read_b64_tr_b16 a[100:101], v21 offset:8192
    v_mfma_f32_16x16x32_bf16 v[176:179], a[80:83], a[212:215], v[176:179]
    ds_read_b64_tr_b16 a[102:103], v21 offset:8448
    v_mfma_f32_16x16x32_bf16 v[180:183], a[84:87], a[212:215], v[180:183]
    v_mfma_f32_16x16x32_bf16 v[184:187], a[88:91], a[212:215], v[184:187]
    v_mfma_f32_16x16x32_bf16 v[188:191], a[92:95], a[212:215], v[188:191]
    v_mfma_f32_16x16x32_bf16 v[192:195], a[80:83], a[216:219], v[192:195]
    v_mfma_f32_16x16x32_bf16 v[196:199], a[84:87], a[216:219], v[196:199]
    v_mfma_f32_16x16x32_bf16 v[200:203], a[88:91], a[216:219], v[200:203]
    v_mfma_f32_16x16x32_bf16 v[204:207], a[92:95], a[216:219], v[204:207]
    s_waitcnt vmcnt(5)
    ds_read_b64_tr_b16 a[112:113], v20 offset:20480
    ds_read_b64_tr_b16 a[114:115], v20 offset:20736
    v_mfma_f32_16x16x32_bf16 v[208:211], a[80:83], a[220:223], v[208:211]
    ds_read_b64_tr_b16 a[116:117], v21 offset:20480
    ds_read_b64_tr_b16 a[118:119], v21 offset:20736
    v_mfma_f32_16x16x32_bf16 v[212:215], a[84:87], a[220:223], v[212:215]
    v_mfma_f32_16x16x32_bf16 v[216:219], a[88:91], a[220:223], v[216:219]
    s_barrier
    ds_read_b128 a[240:243], v0 offset:40960
    ds_read_b128 a[244:247], v0 offset:43008
    v_mfma_f32_16x16x32_bf16 v[220:223], a[92:95], a[220:223], v[220:223]
    ds_read_b128 a[248:251], v0 offset:45056
    ds_read_b128 a[252:255], v0 offset:47104
    v_mfma_f32_16x16x32_bf16 v[224:227], a[80:83], a[224:227], v[224:227]
    s_add_u32 m0, s36, 147456
    s_mov_b32 s38, 524800
    buffer_load_dwordx4 v18, s[16:19], s38 offen offset:0 lds
    buffer_load_dwordx4 v19, s[16:19], s38 offen offset:1024 lds
    v_mfma_f32_16x16x32_bf16 v[228:231], a[84:87], a[224:227], v[228:231]
    s_add_u32 m0, s36, 155648
    s_mov_b32 s38, 1049088
    buffer_load_dwordx4 v18, s[16:19], s38 offen offset:0 lds
    buffer_load_dwordx4 v19, s[16:19], s38 offen offset:1024 lds
    v_mfma_f32_16x16x32_bf16 v[232:235], a[88:91], a[224:227], v[232:235]
    ds_read_b128 a[208:211], v0 offset:49152
    v_mfma_f32_16x16x32_bf16 v[236:239], a[92:95], a[224:227], v[236:239]
    v_mfma_f32_16x16x32_bf16 v[240:243], a[80:83], a[228:231], v[240:243]
    v_mfma_f32_16x16x32_bf16 v[244:247], a[84:87], a[228:231], v[244:247]
    s_add_u32 m0, s36, 102400
    s_mov_b32 s38, 32768
    v_mfma_f32_16x16x32_bf16 v[248:251], a[88:91], a[228:231], v[248:251]
    s_waitcnt vmcnt(6) lgkmcnt(8)
    ds_read_b64_tr_b16 a[128:129], v20 offset:28672
    ds_read_b64_tr_b16 a[130:131], v20 offset:28928
    v_mfma_f32_16x16x32_bf16 v[252:255], a[92:95], a[228:231], v[252:255]
    buffer_load_dwordx4 v18, s[16:19], s38 offen offset:0 lds
    v_mfma_f32_16x16x32_bf16 a[0:3], a[80:83], a[232:235], a[0:3]
    ds_read_b64_tr_b16 a[132:133], v21 offset:28672
    ds_read_b64_tr_b16 a[134:135], v21 offset:28928
    v_mfma_f32_16x16x32_bf16 a[4:7], a[84:87], a[232:235], a[4:7]
    v_mfma_f32_16x16x32_bf16 a[8:11], a[88:91], a[232:235], a[8:11]
    buffer_load_dwordx4 v19, s[16:19], s38 offen offset:1024 lds
    v_mfma_f32_16x16x32_bf16 a[12:15], a[92:95], a[232:235], a[12:15]
    v_mfma_f32_16x16x32_bf16 a[16:19], a[80:83], a[236:239], a[16:19]
    s_waitcnt vmcnt(6) lgkmcnt(5)
    ds_read_b64_tr_b16 a[104:105], v20 offset:36864
    ds_read_b64_tr_b16 a[106:107], v20 offset:37120
    v_mfma_f32_16x16x32_bf16 a[20:23], a[84:87], a[236:239], a[20:23]
    s_add_u32 m0, s36, 110592
    ds_read_b64_tr_b16 a[108:109], v21 offset:36864
    ds_read_b64_tr_b16 a[110:111], v21 offset:37120
    s_waitcnt vmcnt(4)
    ds_read_b64_tr_b16 a[120:121], v20 offset:45056
    ds_read_b64_tr_b16 a[122:123], v20 offset:45312
    v_mfma_f32_16x16x32_bf16 a[24:27], a[88:91], a[236:239], a[24:27]
    s_mov_b32 s38, 557056
    ds_read_b64_tr_b16 a[124:125], v21 offset:45056
    ds_read_b64_tr_b16 a[126:127], v21 offset:45312
    s_waitcnt vmcnt(2) lgkmcnt(12)
    ds_read_b64_tr_b16 a[136:137], v20 offset:53248
    ds_read_b64_tr_b16 a[138:139], v20 offset:53504
    v_mfma_f32_16x16x32_bf16 a[28:31], a[92:95], a[236:239], a[28:31]
    ds_read_b64_tr_b16 a[140:141], v21 offset:53248
    ds_read_b64_tr_b16 a[142:143], v21 offset:53504
    v_mfma_f32_16x16x32_bf16 v[32:35], a[96:99], a[240:243], 0
    buffer_load_dwordx4 v18, s[16:19], s38 offen offset:0 lds
    v_mfma_f32_16x16x32_bf16 v[32:35], a[112:115], a[244:247], v[32:35]
    s_waitcnt lgkmcnt(14)
    ds_read_b128 a[212:215], v0 offset:51200
    v_mfma_f32_16x16x32_bf16 v[32:35], a[128:131], a[248:251], v[32:35]
    s_waitcnt lgkmcnt(13)
    v_mfma_f32_16x16x32_bf16 v[36:39], a[132:135], a[248:251], 0
    buffer_load_dwordx4 v19, s[16:19], s38 offen offset:1024 lds
    v_mfma_f32_16x16x32_bf16 v[36:39], a[116:119], a[244:247], v[36:39]
    ds_read_b128 v[6:9], v2 offset:40960
    ds_read_b128 v[10:13], v2 offset:0
    v_mfma_f32_16x16x32_bf16 v[36:39], a[100:103], a[240:243], v[36:39]
    s_waitcnt lgkmcnt(13)
    v_mfma_f32_16x16x32_bf16 v[40:43], a[104:107], a[240:243], 0
    s_waitcnt lgkmcnt(9)
    s_add_u32 m0, s36, 122880
    s_mov_b32 s38, 1081344
    v_mfma_f32_16x16x32_bf16 v[40:43], a[120:123], a[244:247], v[40:43]
    s_waitcnt lgkmcnt(5)
    v_mfma_f32_16x16x32_bf16 v[40:43], a[136:139], a[248:251], v[40:43]
    s_waitcnt lgkmcnt(3)
    buffer_load_dwordx4 v18, s[16:19], s38 offen offset:0 lds
    v_mfma_f32_16x16x32_bf16 v[44:47], a[140:143], a[248:251], 0
    v_mfma_f32_16x16x32_bf16 v[44:47], a[124:127], a[244:247], v[44:47]
    ds_read_b128 a[216:219], v0 offset:53248
    v_mfma_f32_16x16x32_bf16 v[44:47], a[108:111], a[240:243], v[44:47]
    v_mfma_f32_16x16x32_bf16 v[60:63], a[108:111], a[244:247], 0
    buffer_load_dwordx4 v19, s[16:19], s38 offen offset:1024 lds
    v_mfma_f32_16x16x32_bf16 v[60:63], a[124:127], a[248:251], v[60:63]
    v_mfma_f32_16x16x32_bf16 v[60:63], a[140:143], a[252:255], v[60:63]
    s_waitcnt lgkmcnt(2)
    v_lshlrev_b32 v14, 16, v6
    v_mfma_f32_16x16x32_bf16 v[56:59], a[136:139], a[252:255], 0
    s_add_u32 m0, s36, 131072
    s_mov_b32 s38, 33280
    v_mfma_f32_16x16x32_bf16 v[56:59], a[120:123], a[248:251], v[56:59]
    s_waitcnt lgkmcnt(1)
    v_lshlrev_b32 v15, 16, v10
    v_and_b32 v6, s34, v6
    v_mfma_f32_16x16x32_bf16 v[56:59], a[104:107], a[244:247], v[56:59]
    buffer_load_dwordx4 v18, s[16:19], s38 offen offset:0 lds
    v_mfma_f32_16x16x32_bf16 v[52:55], a[100:103], a[244:247], 0
    v_and_b32 v10, s34, v10
    v_add_f32 v14, v14, v15
    v_mfma_f32_16x16x32_bf16 v[52:55], a[116:119], a[248:251], v[52:55]
    v_add_f32 v6, v6, v10
    v_cvt_pk_bf16_f32 v6, v14, v6
    v_mfma_f32_16x16x32_bf16 v[52:55], a[132:135], a[252:255], v[52:55]
    v_lshlrev_b32 v14, 16, v7
    v_lshlrev_b32 v15, 16, v11
    v_mfma_f32_16x16x32_bf16 v[48:51], a[128:131], a[252:255], 0
    buffer_load_dwordx4 v19, s[16:19], s38 offen offset:1024 lds
    v_mfma_f32_16x16x32_bf16 v[48:51], a[112:115], a[248:251], v[48:51]
    ds_read_b128 a[220:223], v0 offset:55296
    v_and_b32 v7, s34, v7
    v_mfma_f32_16x16x32_bf16 v[48:51], a[96:99], a[244:247], v[48:51]
    v_and_b32 v11, s34, v11
    v_add_f32 v14, v14, v15
    v_mfma_f32_16x16x32_bf16 v[64:67], a[96:99], a[248:251], 0
    s_add_u32 m0, s36, 139264
    s_mov_b32 s38, 557568
    v_add_f32 v7, v7, v11
    v_mfma_f32_16x16x32_bf16 v[64:67], a[112:115], a[252:255], v[64:67]
    v_cvt_pk_bf16_f32 v7, v14, v7
    v_lshlrev_b32 v14, 16, v8
    v_mfma_f32_16x16x32_bf16 v[64:67], a[128:131], a[208:211], v[64:67]
    s_waitcnt vmcnt(6) lgkmcnt(1)
    ds_read_b64_tr_b16 a[144:145], v20 offset:0
    ds_read_b64_tr_b16 a[146:147], v20 offset:256
    v_mfma_f32_16x16x32_bf16 v[68:71], a[132:135], a[208:211], 0
    buffer_load_dwordx4 v18, s[16:19], s38 offen offset:0 lds
    v_mfma_f32_16x16x32_bf16 v[68:71], a[116:119], a[252:255], v[68:71]
    ds_read_b64_tr_b16 a[148:149], v21 offset:0
    ds_read_b64_tr_b16 a[150:151], v21 offset:256
    v_mfma_f32_16x16x32_bf16 v[68:71], a[100:103], a[248:251], v[68:71]
    v_lshlrev_b32 v15, 16, v12
    v_and_b32 v8, s34, v8
    v_mfma_f32_16x16x32_bf16 v[72:75], a[104:107], a[248:251], 0
    buffer_load_dwordx4 v19, s[16:19], s38 offen offset:1024 lds
    v_mfma_f32_16x16x32_bf16 v[72:75], a[120:123], a[252:255], v[72:75]
    v_and_b32 v12, s34, v12
    v_add_f32 v14, v14, v15
    v_mfma_f32_16x16x32_bf16 v[72:75], a[136:139], a[208:211], v[72:75]
    v_add_f32 v8, v8, v12
    v_cvt_pk_bf16_f32 v8, v14, v8
    v_mfma_f32_16x16x32_bf16 v[76:79], a[140:143], a[208:211], 0
    s_add_u32 m0, s36, 147456
    s_mov_b32 s38, 1081856
    v_lshlrev_b32 v14, 16, v9
    v_mfma_f32_16x16x32_bf16 v[76:79], a[124:127], a[252:255], v[76:79]
    ds_read_b128 a[224:227], v0 offset:57344
    v_lshlrev_b32 v15, 16, v13
    v_mfma_f32_16x16x32_bf16 v[76:79], a[108:111], a[248:251], v[76:79]
    s_waitcnt vmcnt(6) lgkmcnt(5)
    ds_read_b64_tr_b16 a[160:161], v20 offset:8192
    ds_read_b64_tr_b16 a[162:163], v20 offset:8448
    v_mfma_f32_16x16x32_bf16 v[92:95], a[108:111], a[252:255], 0
    buffer_load_dwordx4 v18, s[16:19], s38 offen offset:0 lds
    v_mfma_f32_16x16x32_bf16 v[92:95], a[124:127], a[208:211], v[92:95]
    ds_read_b64_tr_b16 a[164:165], v21 offset:8192
    ds_read_b64_tr_b16 a[166:167], v21 offset:8448
    v_mfma_f32_16x16x32_bf16 v[92:95], a[140:143], a[212:215], v[92:95]
    v_and_b32 v9, s34, v9
    v_and_b32 v13, s34, v13
    v_mfma_f32_16x16x32_bf16 v[88:91], a[136:139], a[212:215], 0
    buffer_load_dwordx4 v19, s[16:19], s38 offen offset:1024 lds
    v_mfma_f32_16x16x32_bf16 v[88:91], a[120:123], a[208:211], v[88:91]
    v_add_f32 v14, v14, v15
    v_add_f32 v9, v9, v13
    v_mfma_f32_16x16x32_bf16 v[88:91], a[104:107], a[252:255], v[88:91]
    v_cvt_pk_bf16_f32 v9, v14, v9
    v_mfma_f32_16x16x32_bf16 v[84:87], a[100:103], a[252:255], 0
    s_add_u32 m0, s36, 155648
    ds_write_b128 v2, v[6:9] offset:0
    v_mfma_f32_16x16x32_bf16 v[84:87], a[116:119], a[208:211], v[84:87]
    s_mov_b32 s38, 327680
    ds_read_b128 v[6:9], v2 offset:43008
    ds_read_b128 v[10:13], v2 offset:2048
    v_mfma_f32_16x16x32_bf16 v[84:87], a[132:135], a[212:215], v[84:87]
    s_waitcnt vmcnt(6) lgkmcnt(8)
    ds_read_b64_tr_b16 a[176:177], v20 offset:20480
    ds_read_b64_tr_b16 a[178:179], v20 offset:20736
    v_mfma_f32_16x16x32_bf16 v[80:83], a[128:131], a[212:215], 0
    buffer_load_dwordx4 v18, s[16:19], s38 offen offset:0 lds
    v_mfma_f32_16x16x32_bf16 v[80:83], a[112:115], a[208:211], v[80:83]
    ds_read_b64_tr_b16 a[180:181], v21 offset:20480
    ds_read_b64_tr_b16 a[182:183], v21 offset:20736
    v_mfma_f32_16x16x32_bf16 v[80:83], a[96:99], a[252:255], v[80:83]
    ds_read_b128 a[228:231], v0 offset:59392
    v_mfma_f32_16x16x32_bf16 v[96:99], a[96:99], a[208:211], 0
    v_mfma_f32_16x16x32_bf16 v[96:99], a[112:115], a[212:215], v[96:99]
    buffer_load_dwordx4 v19, s[16:19], s38 offen offset:1024 lds
    v_mfma_f32_16x16x32_bf16 v[96:99], a[128:131], a[216:219], v[96:99]
    v_mfma_f32_16x16x32_bf16 v[100:103], a[132:135], a[216:219], 0
    v_mfma_f32_16x16x32_bf16 v[100:103], a[116:119], a[212:215], v[100:103]
    s_add_u32 m0, s36, 102400
    s_mov_b32 s38, 851968
    v_mfma_f32_16x16x32_bf16 v[100:103], a[100:103], a[208:211], v[100:103]
    s_waitcnt vmcnt(6) lgkmcnt(8)
    ds_read_b64_tr_b16 a[152:153], v20 offset:28672
    ds_read_b64_tr_b16 a[154:155], v20 offset:28928
    v_mfma_f32_16x16x32_bf16 v[104:107], a[104:107], a[208:211], 0
    buffer_load_dwordx4 v18, s[16:19], s38 offen offset:0 lds
    v_mfma_f32_16x16x32_bf16 v[104:107], a[120:123], a[212:215], v[104:107]
    ds_read_b64_tr_b16 a[156:157], v21 offset:28672
    ds_read_b64_tr_b16 a[158:159], v21 offset:28928
    v_mfma_f32_16x16x32_bf16 v[104:107], a[136:139], a[216:219], v[104:107]
    ds_read_b128 a[232:235], v1 offset:40960
    v_mfma_f32_16x16x32_bf16 v[108:111], a[140:143], a[216:219], 0
    ds_read_b128 a[236:239], v1 offset:43008
    v_mfma_f32_16x16x32_bf16 v[108:111], a[124:127], a[212:215], v[108:111]
    ds_read_b128 a[240:243], v1 offset:45056
    v_mfma_f32_16x16x32_bf16 v[108:111], a[108:111], a[208:211], v[108:111]
    buffer_load_dwordx4 v19, s[16:19], s38 offen offset:1024 lds
    v_mfma_f32_16x16x32_bf16 v[124:127], a[108:111], a[212:215], 0
    s_waitcnt lgkmcnt(7)
    v_lshlrev_b32 v14, 16, v6
    v_lshlrev_b32 v15, 16, v10
    v_mfma_f32_16x16x32_bf16 v[124:127], a[124:127], a[216:219], v[124:127]
    v_and_b32 v6, s34, v6
    v_and_b32 v10, s34, v10
    v_mfma_f32_16x16x32_bf16 v[124:127], a[140:143], a[220:223], v[124:127]
    s_add_u32 m0, s36, 110592
    s_waitcnt vmcnt(6)
    ds_read_b64_tr_b16 a[168:169], v20 offset:36864
    v_mfma_f32_16x16x32_bf16 v[120:123], a[136:139], a[220:223], 0
    s_mov_b32 s38, 328192
    ds_read_b64_tr_b16 a[170:171], v20 offset:37120
    ds_read_b64_tr_b16 a[172:173], v21 offset:36864
    v_mfma_f32_16x16x32_bf16 v[120:123], a[120:123], a[216:219], v[120:123]
    buffer_load_dwordx4 v18, s[16:19], s38 offen offset:0 lds
    v_mfma_f32_16x16x32_bf16 v[120:123], a[104:107], a[212:215], v[120:123]
    ds_read_b64_tr_b16 a[174:175], v21 offset:37120
    v_add_f32 v14, v14, v15
    v_mfma_f32_16x16x32_bf16 v[116:119], a[100:103], a[212:215], 0
    v_add_f32 v6, v6, v10
    v_cvt_pk_bf16_f32 v6, v14, v6
    v_mfma_f32_16x16x32_bf16 v[116:119], a[116:119], a[216:219], v[116:119]
    v_lshlrev_b32 v14, 16, v7
    v_lshlrev_b32 v15, 16, v11
    v_mfma_f32_16x16x32_bf16 v[116:119], a[132:135], a[220:223], v[116:119]
    v_and_b32 v7, s34, v7
    v_and_b32 v11, s34, v11
    v_mfma_f32_16x16x32_bf16 v[112:115], a[128:131], a[220:223], 0
    buffer_load_dwordx4 v19, s[16:19], s38 offen offset:1024 lds
    v_mfma_f32_16x16x32_bf16 v[112:115], a[112:115], a[216:219], v[112:115]
    ds_read_b128 a[244:247], v1 offset:47104
    v_add_f32 v14, v14, v15
    v_mfma_f32_16x16x32_bf16 v[112:115], a[96:99], a[212:215], v[112:115]
    s_waitcnt vmcnt(6) lgkmcnt(5)
    ds_read_b64_tr_b16 a[184:185], v20 offset:45056
    ds_read_b64_tr_b16 a[186:187], v20 offset:45312
    v_mfma_f32_16x16x32_bf16 v[128:131], a[96:99], a[216:219], 0
    s_add_u32 m0, s36, 122880
    ds_read_b64_tr_b16 a[188:189], v21 offset:45056
    ds_read_b64_tr_b16 a[190:191], v21 offset:45312
    v_mfma_f32_16x16x32_bf16 v[128:131], a[112:115], a[220:223], v[128:131]
    s_mov_b32 s38, 852480
    v_add_f32 v7, v7, v11
    v_cvt_pk_bf16_f32 v7, v14, v7
    v_mfma_f32_16x16x32_bf16 v[128:131], a[128:131], a[224:227], v[128:131]
    buffer_load_dwordx4 v18, s[16:19], s38 offen offset:0 lds
    v_mfma_f32_16x16x32_bf16 v[132:135], a[132:135], a[224:227], 0
    v_lshlrev_b32 v14, 16, v8
    v_lshlrev_b32 v15, 16, v12
    v_mfma_f32_16x16x32_bf16 v[132:135], a[116:119], a[220:223], v[132:135]
    v_and_b32 v8, s34, v8
    v_and_b32 v12, s34, v12
    v_mfma_f32_16x16x32_bf16 v[132:135], a[100:103], a[216:219], v[132:135]
    v_add_f32 v14, v14, v15
    v_add_f32 v8, v8, v12
    v_mfma_f32_16x16x32_bf16 v[136:139], a[104:107], a[216:219], 0
    v_cvt_pk_bf16_f32 v8, v14, v8
    v_lshlrev_b32 v14, 16, v9
    v_mfma_f32_16x16x32_bf16 v[136:139], a[120:123], a[220:223], v[136:139]
    buffer_load_dwordx4 v19, s[16:19], s38 offen offset:1024 lds
    v_mfma_f32_16x16x32_bf16 v[136:139], a[136:139], a[224:227], v[136:139]
    v_lshlrev_b32 v15, 16, v13
    v_and_b32 v9, s34, v9
    v_mfma_f32_16x16x32_bf16 v[140:143], a[140:143], a[224:227], 0
    s_waitcnt vmcnt(6) lgkmcnt(5)
    ds_read_b64_tr_b16 a[32:33], v20 offset:53248
    ds_read_b64_tr_b16 a[34:35], v20 offset:53504
    v_mfma_f32_16x16x32_bf16 v[140:143], a[124:127], a[220:223], v[140:143]
    ds_read_b64_tr_b16 a[36:37], v21 offset:53248
    ds_read_b64_tr_b16 a[38:39], v21 offset:53504
    v_mfma_f32_16x16x32_bf16 v[140:143], a[108:111], a[216:219], v[140:143]
    s_add_u32 m0, s37, 20480
    ds_read_b128 a[248:251], v1 offset:49152
    s_mov_b32 s38, 1152
    v_mfma_f32_16x16x32_bf16 v[144:147], a[96:99], a[220:223], 0
    buffer_load_dwordx4 v16, s[12:15], s38 offen offset:0 nt lds
    v_mfma_f32_16x16x32_bf16 v[144:147], a[112:115], a[224:227], v[144:147]
    v_and_b32 v13, s34, v13
    v_add_f32 v14, v14, v15
    v_mfma_f32_16x16x32_bf16 v[144:147], a[128:131], a[228:231], v[144:147]
    v_add_f32 v9, v9, v13
    v_cvt_pk_bf16_f32 v9, v14, v9
    v_mfma_f32_16x16x32_bf16 v[148:151], a[132:135], a[228:231], 0
    v_mfma_f32_16x16x32_bf16 v[148:151], a[116:119], a[224:227], v[148:151]
    v_mfma_f32_16x16x32_bf16 v[148:151], a[100:103], a[220:223], v[148:151]
    buffer_load_dwordx4 v16, s[12:15], s38 offen offset:2048 nt lds
    v_mfma_f32_16x16x32_bf16 v[152:155], a[104:107], a[220:223], 0
    s_add_u32 m0, s37, 24576
    ds_write_b128 v2, v[6:9] offset:2048
    v_mfma_f32_16x16x32_bf16 v[152:155], a[120:123], a[224:227], v[152:155]
    s_waitcnt vmcnt(6) lgkmcnt(6)
    ds_read_b64_tr_b16 a[48:49], v20 offset:0
    ds_read_b64_tr_b16 a[50:51], v20 offset:256
    v_mfma_f32_16x16x32_bf16 v[152:155], a[136:139], a[228:231], v[152:155]
    buffer_load_dwordx4 v17, s[12:15], s38 offen offset:0 nt lds
    v_mfma_f32_16x16x32_bf16 v[156:159], a[140:143], a[228:231], 0
    buffer_load_dwordx4 v17, s[12:15], s38 offen offset:2048 nt lds
    v_mfma_f32_16x16x32_bf16 v[156:159], a[124:127], a[224:227], v[156:159]
    s_add_u32 m0, s37, 28672
    ds_read_b64_tr_b16 a[52:53], v21 offset:0
    ds_read_b64_tr_b16 a[54:55], v21 offset:256
    v_mfma_f32_16x16x32_bf16 v[156:159], a[108:111], a[220:223], v[156:159]
    s_mov_b32 s38, 5248
    ds_read_b128 a[252:255], v1 offset:51200
    ds_read_b128 v[6:9], v2 offset:45056
    v_mfma_f32_16x16x32_bf16 v[32:35], a[144:147], a[232:235], v[32:35]
    buffer_load_dwordx4 v17, s[12:15], s38 offen offset:0 nt lds
    v_mfma_f32_16x16x32_bf16 v[32:35], a[160:163], a[236:239], v[32:35]
    s_add_u32 m0, s37, 61440
    ds_read_b128 v[10:13], v2 offset:4096
    s_mov_b32 s38, 128
    v_mfma_f32_16x16x32_bf16 v[32:35], a[176:179], a[240:243], v[32:35]
    v_mfma_f32_16x16x32_bf16 v[36:39], a[180:183], a[240:243], v[36:39]
    buffer_load_dwordx4 v16, s[12:15], s38 offen offset:0 nt lds
    v_mfma_f32_16x16x32_bf16 v[36:39], a[164:167], a[236:239], v[36:39]
    v_mfma_f32_16x16x32_bf16 v[36:39], a[148:151], a[232:235], v[36:39]
    s_waitcnt vmcnt(8) lgkmcnt(8)
    ds_read_b64_tr_b16 a[40:41], v20 offset:8192
    ds_read_b64_tr_b16 a[42:43], v20 offset:8448
    v_mfma_f32_16x16x32_bf16 v[40:43], a[152:155], a[232:235], v[40:43]
    buffer_load_dwordx4 v16, s[12:15], s38 offen offset:2048 nt lds
    v_mfma_f32_16x16x32_bf16 v[40:43], a[168:171], a[236:239], v[40:43]
    s_add_u32 m0, s37, 65536
    ds_read_b64_tr_b16 a[44:45], v21 offset:8192
    ds_read_b64_tr_b16 a[46:47], v21 offset:8448
    v_mfma_f32_16x16x32_bf16 v[40:43], a[184:187], a[240:243], v[40:43]
    v_mfma_f32_16x16x32_bf16 v[44:47], a[188:191], a[240:243], v[44:47]
    buffer_load_dwordx4 v17, s[12:15], s38 offen offset:0 nt lds
    v_mfma_f32_16x16x32_bf16 v[44:47], a[172:175], a[236:239], v[44:47]
    ds_read_b128 a[208:211], v1 offset:53248
    v_mfma_f32_16x16x32_bf16 v[44:47], a[156:159], a[232:235], v[44:47]
    s_waitcnt lgkmcnt(6)
    v_lshlrev_b32 v14, 16, v6
    v_mfma_f32_16x16x32_bf16 v[60:63], a[156:159], a[236:239], v[60:63]
    buffer_load_dwordx4 v17, s[12:15], s38 offen offset:2048 nt lds
    v_mfma_f32_16x16x32_bf16 v[60:63], a[172:175], a[240:243], v[60:63]
    s_add_u32 m0, s37, 69632
    s_mov_b32 s38, 4224
    v_mfma_f32_16x16x32_bf16 v[60:63], a[188:191], a[244:247], v[60:63]
    s_waitcnt lgkmcnt(5)
    v_lshlrev_b32 v15, 16, v10
    v_and_b32 v6, s34, v6
    v_mfma_f32_16x16x32_bf16 v[56:59], a[184:187], a[244:247], v[56:59]
    s_waitcnt vmcnt(9)
    ds_read_b64_tr_b16 a[56:57], v20 offset:20480
    ds_read_b64_tr_b16 a[58:59], v20 offset:20736
    v_mfma_f32_16x16x32_bf16 v[56:59], a[168:171], a[240:243], v[56:59]
    buffer_load_dwordx4 v17, s[12:15], s38 offen offset:0 nt lds
    v_mfma_f32_16x16x32_bf16 v[56:59], a[152:155], a[236:239], v[56:59]
    ds_read_b64_tr_b16 a[60:61], v21 offset:20480
    ds_read_b64_tr_b16 a[62:63], v21 offset:20736
    v_mfma_f32_16x16x32_bf16 v[52:55], a[148:151], a[236:239], v[52:55]
    v_and_b32 v10, s34, v10
    v_add_f32 v14, v14, v15
    v_mfma_f32_16x16x32_bf16 v[52:55], a[164:167], a[240:243], v[52:55]
    v_add_f32 v6, v6, v10
    v_cvt_pk_bf16_f32 v6, v14, v6
    v_mfma_f32_16x16x32_bf16 v[52:55], a[180:183], a[244:247], v[52:55]
    v_lshlrev_b32 v14, 16, v7
    v_lshlrev_b32 v15, 16, v11
    v_mfma_f32_16x16x32_bf16 v[48:51], a[176:179], a[244:247], v[48:51]
    v_and_b32 v7, s34, v7
    v_and_b32 v11, s34, v11
    v_mfma_f32_16x16x32_bf16 v[48:51], a[160:163], a[240:243], v[48:51]
    ds_read_b128 a[212:215], v1 offset:55296
    v_add_f32 v14, v14, v15
    v_mfma_f32_16x16x32_bf16 v[48:51], a[144:147], a[236:239], v[48:51]
    v_add_f32 v7, v7, v11
    v_cvt_pk_bf16_f32 v7, v14, v7
    v_mfma_f32_16x16x32_bf16 v[64:67], a[144:147], a[240:243], v[64:67]
    v_lshlrev_b32 v14, 16, v8
    v_lshlrev_b32 v15, 16, v12
    v_mfma_f32_16x16x32_bf16 v[64:67], a[160:163], a[244:247], v[64:67]
    v_and_b32 v8, s34, v8
    v_and_b32 v12, s34, v12
    v_mfma_f32_16x16x32_bf16 v[64:67], a[176:179], a[248:251], v[64:67]
    v_add_f32 v14, v14, v15
    v_add_f32 v8, v8, v12
    v_mfma_f32_16x16x32_bf16 v[68:71], a[180:183], a[248:251], v[68:71]
    v_cvt_pk_bf16_f32 v8, v14, v8
    v_lshlrev_b32 v14, 16, v9
    v_mfma_f32_16x16x32_bf16 v[68:71], a[164:167], a[244:247], v[68:71]
    v_lshlrev_b32 v15, 16, v13
    v_and_b32 v9, s34, v9
    v_mfma_f32_16x16x32_bf16 v[68:71], a[148:151], a[240:243], v[68:71]
    v_and_b32 v13, s34, v13
    v_add_f32 v14, v14, v15
    v_mfma_f32_16x16x32_bf16 v[72:75], a[152:155], a[240:243], v[72:75]
    v_add_f32 v9, v9, v13
    v_cvt_pk_bf16_f32 v9, v14, v9
    v_mfma_f32_16x16x32_bf16 v[72:75], a[168:171], a[244:247], v[72:75]
    ds_write_b128 v2, v[6:9] offset:4096
    v_mfma_f32_16x16x32_bf16 v[72:75], a[184:187], a[248:251], v[72:75]
    ds_read_b128 v[6:9], v2 offset:47104
    ds_read_b128 v[10:13], v2 offset:6144
    v_mfma_f32_16x16x32_bf16 v[76:79], a[188:191], a[248:251], v[76:79]
    v_mfma_f32_16x16x32_bf16 v[76:79], a[172:175], a[244:247], v[76:79]
    ds_read_b128 a[216:219], v1 offset:57344
    v_mfma_f32_16x16x32_bf16 v[76:79], a[156:159], a[240:243], v[76:79]
    v_mfma_f32_16x16x32_bf16 v[92:95], a[156:159], a[244:247], v[92:95]
    v_mfma_f32_16x16x32_bf16 v[92:95], a[172:175], a[248:251], v[92:95]
    v_mfma_f32_16x16x32_bf16 v[92:95], a[188:191], a[252:255], v[92:95]
    v_mfma_f32_16x16x32_bf16 v[88:91], a[184:187], a[252:255], v[88:91]
    v_mfma_f32_16x16x32_bf16 v[88:91], a[168:171], a[248:251], v[88:91]
    v_mfma_f32_16x16x32_bf16 v[88:91], a[152:155], a[244:247], v[88:91]
    v_mfma_f32_16x16x32_bf16 v[84:87], a[148:151], a[244:247], v[84:87]
    s_waitcnt lgkmcnt(2)
    v_lshlrev_b32 v14, 16, v6
    v_mfma_f32_16x16x32_bf16 v[84:87], a[164:167], a[248:251], v[84:87]
    s_waitcnt lgkmcnt(1)
    v_lshlrev_b32 v15, 16, v10
    v_and_b32 v6, s34, v6
    v_mfma_f32_16x16x32_bf16 v[84:87], a[180:183], a[252:255], v[84:87]
    v_and_b32 v10, s34, v10
    v_add_f32 v14, v14, v15
    v_mfma_f32_16x16x32_bf16 v[80:83], a[176:179], a[252:255], v[80:83]
    v_add_f32 v6, v6, v10
    v_cvt_pk_bf16_f32 v6, v14, v6
    v_mfma_f32_16x16x32_bf16 v[80:83], a[160:163], a[248:251], v[80:83]
    ds_read_b128 a[228:231], v1 offset:59392
    v_lshlrev_b32 v14, 16, v7
    v_mfma_f32_16x16x32_bf16 v[80:83], a[144:147], a[244:247], v[80:83]
    v_lshlrev_b32 v15, 16, v11
    v_and_b32 v7, s34, v7
    v_mfma_f32_16x16x32_bf16 v[96:99], a[144:147], a[248:251], v[96:99]
    v_and_b32 v11, s34, v11
    v_add_f32 v14, v14, v15
    v_mfma_f32_16x16x32_bf16 v[96:99], a[160:163], a[252:255], v[96:99]
    v_add_f32 v7, v7, v11
    v_cvt_pk_bf16_f32 v7, v14, v7
    v_mfma_f32_16x16x32_bf16 v[96:99], a[176:179], a[208:211], v[96:99]
    v_lshlrev_b32 v14, 16, v8
    v_lshlrev_b32 v15, 16, v12
    v_mfma_f32_16x16x32_bf16 v[100:103], a[180:183], a[208:211], v[100:103]
    v_and_b32 v8, s34, v8
    v_and_b32 v12, s34, v12
    v_mfma_f32_16x16x32_bf16 v[100:103], a[164:167], a[252:255], v[100:103]
    v_add_f32 v14, v14, v15
    v_add_f32 v8, v8, v12
    v_mfma_f32_16x16x32_bf16 v[100:103], a[148:151], a[248:251], v[100:103]
    v_cvt_pk_bf16_f32 v8, v14, v8
    v_lshlrev_b32 v14, 16, v9
    v_mfma_f32_16x16x32_bf16 v[104:107], a[152:155], a[248:251], v[104:107]
    v_lshlrev_b32 v15, 16, v13
    v_and_b32 v9, s34, v9
    v_mfma_f32_16x16x32_bf16 v[104:107], a[168:171], a[252:255], v[104:107]
    v_and_b32 v13, s34, v13
    v_add_f32 v14, v14, v15
    v_mfma_f32_16x16x32_bf16 v[104:107], a[184:187], a[208:211], v[104:107]
    v_add_f32 v9, v9, v13
    v_cvt_pk_bf16_f32 v9, v14, v9
    v_mfma_f32_16x16x32_bf16 v[108:111], a[188:191], a[208:211], v[108:111]
    ds_write_b128 v2, v[6:9] offset:6144
    v_mfma_f32_16x16x32_bf16 v[108:111], a[172:175], a[252:255], v[108:111]
    ds_read_b128 v[6:9], v2 offset:49152
    ds_read_b128 v[10:13], v2 offset:8192
    v_mfma_f32_16x16x32_bf16 v[108:111], a[156:159], a[248:251], v[108:111]
    v_mfma_f32_16x16x32_bf16 v[124:127], a[156:159], a[252:255], v[124:127]
    v_mfma_f32_16x16x32_bf16 v[124:127], a[172:175], a[208:211], v[124:127]
    v_mfma_f32_16x16x32_bf16 v[124:127], a[188:191], a[212:215], v[124:127]
    v_mfma_f32_16x16x32_bf16 v[120:123], a[184:187], a[212:215], v[120:123]
    v_mfma_f32_16x16x32_bf16 v[120:123], a[168:171], a[208:211], v[120:123]
    v_mfma_f32_16x16x32_bf16 v[120:123], a[152:155], a[252:255], v[120:123]
    v_mfma_f32_16x16x32_bf16 v[116:119], a[148:151], a[252:255], v[116:119]
    v_mfma_f32_16x16x32_bf16 v[116:119], a[164:167], a[208:211], v[116:119]
    v_mfma_f32_16x16x32_bf16 v[116:119], a[180:183], a[212:215], v[116:119]
    s_waitcnt lgkmcnt(1)
    v_lshlrev_b32 v14, 16, v6
    v_mfma_f32_16x16x32_bf16 v[112:115], a[176:179], a[212:215], v[112:115]
    s_waitcnt lgkmcnt(0)
    v_lshlrev_b32 v15, 16, v10
    v_and_b32 v6, s34, v6
    v_mfma_f32_16x16x32_bf16 v[112:115], a[160:163], a[208:211], v[112:115]
    v_and_b32 v10, s34, v10
    v_add_f32 v14, v14, v15
    v_mfma_f32_16x16x32_bf16 v[112:115], a[144:147], a[252:255], v[112:115]
    v_add_f32 v6, v6, v10
    v_cvt_pk_bf16_f32 v6, v14, v6
    v_mfma_f32_16x16x32_bf16 v[128:131], a[144:147], a[208:211], v[128:131]
    v_lshlrev_b32 v14, 16, v7
    v_lshlrev_b32 v15, 16, v11
    v_mfma_f32_16x16x32_bf16 v[128:131], a[160:163], a[212:215], v[128:131]
    v_and_b32 v7, s34, v7
    v_and_b32 v11, s34, v11
    v_mfma_f32_16x16x32_bf16 v[128:131], a[176:179], a[216:219], v[128:131]
    v_add_f32 v14, v14, v15
    v_add_f32 v7, v7, v11
    v_mfma_f32_16x16x32_bf16 v[132:135], a[180:183], a[216:219], v[132:135]
    v_cvt_pk_bf16_f32 v7, v14, v7
    v_lshlrev_b32 v14, 16, v8
    v_mfma_f32_16x16x32_bf16 v[132:135], a[164:167], a[212:215], v[132:135]
    v_lshlrev_b32 v15, 16, v12
    v_and_b32 v8, s34, v8
    v_mfma_f32_16x16x32_bf16 v[132:135], a[148:151], a[208:211], v[132:135]
    s_add_u32 m0, s36, 131072
    s_mov_b32 s38, 360448
    v_and_b32 v12, s34, v12
    v_mfma_f32_16x16x32_bf16 v[136:139], a[152:155], a[208:211], v[136:139]
    buffer_load_dwordx4 v18, s[16:19], s38 offen offset:0 lds
    v_mfma_f32_16x16x32_bf16 v[136:139], a[168:171], a[212:215], v[136:139]
    v_add_f32 v14, v14, v15
    v_add_f32 v8, v8, v12
    v_mfma_f32_16x16x32_bf16 v[136:139], a[184:187], a[216:219], v[136:139]
    s_waitcnt vmcnt(6)
    s_barrier
    v_add_u32 v0, 0x5000, v0
    v_mfma_f32_16x16x32_bf16 v[140:143], a[188:191], a[216:219], v[140:143]
    v_add_u32 v1, 0x5000, v1
    v_cvt_pk_bf16_f32 v8, v14, v8
    v_mfma_f32_16x16x32_bf16 v[140:143], a[172:175], a[212:215], v[140:143]
    ds_read_b128 a[224:227], v0 offset:0
    ds_read_b128 a[220:223], v0 offset:2048
    v_mfma_f32_16x16x32_bf16 v[140:143], a[156:159], a[208:211], v[140:143]
    buffer_load_dwordx4 v19, s[16:19], s38 offen offset:1024 lds
    v_mfma_f32_16x16x32_bf16 v[144:147], a[144:147], a[212:215], v[144:147]
    ds_read_b128 a[232:235], v0 offset:4096
    ds_read_b128 a[236:239], v0 offset:6144
    v_mfma_f32_16x16x32_bf16 v[144:147], a[160:163], a[216:219], v[144:147]
    ds_read_b128 a[240:243], v0 offset:8192
    v_lshlrev_b32 v14, 16, v9
    v_mfma_f32_16x16x32_bf16 v[144:147], a[176:179], a[228:231], v[144:147]
    s_add_u32 m0, s36, 139264
    s_mov_b32 s38, 884736
    v_lshlrev_b32 v15, 16, v13
    v_mfma_f32_16x16x32_bf16 v[148:151], a[180:183], a[228:231], v[148:151]
    v_and_b32 v9, s34, v9
    v_and_b32 v13, s34, v13
    v_mfma_f32_16x16x32_bf16 v[148:151], a[164:167], a[216:219], v[148:151]
    buffer_load_dwordx4 v18, s[16:19], s38 offen offset:0 lds
    v_mfma_f32_16x16x32_bf16 v[148:151], a[148:151], a[212:215], v[148:151]
    ds_read_b128 a[244:247], v0 offset:10240
    v_add_f32 v14, v14, v15
    v_mfma_f32_16x16x32_bf16 v[152:155], a[152:155], a[212:215], v[152:155]
    v_add_f32 v9, v9, v13
    v_cvt_pk_bf16_f32 v9, v14, v9
    v_mfma_f32_16x16x32_bf16 v[152:155], a[168:171], a[216:219], v[152:155]
    ds_write_b128 v2, v[6:9] offset:8192
    v_mfma_f32_16x16x32_bf16 v[152:155], a[184:187], a[228:231], v[152:155]
    v_mfma_f32_16x16x32_bf16 v[156:159], a[188:191], a[228:231], v[156:159]
    buffer_load_dwordx4 v19, s[16:19], s38 offen offset:1024 lds
    v_mfma_f32_16x16x32_bf16 v[156:159], a[172:175], a[216:219], v[156:159]
    v_mfma_f32_16x16x32_bf16 v[156:159], a[156:159], a[212:215], v[156:159]
    s_waitcnt lgkmcnt(5)
    v_mfma_f32_16x16x32_bf16 v[160:163], a[32:35], a[224:227], v[160:163]
    s_add_u32 m0, s36, 147456
    s_mov_b32 s38, 360960
    v_mfma_f32_16x16x32_bf16 v[160:163], a[48:51], a[220:223], v[160:163]
    ds_read_b128 a[248:251], v0 offset:12288
    v_mfma_f32_16x16x32_bf16 v[164:167], a[52:55], a[220:223], v[164:167]
    buffer_load_dwordx4 v18, s[16:19], s38 offen offset:0 lds
    v_mfma_f32_16x16x32_bf16 v[164:167], a[36:39], a[224:227], v[164:167]
    v_mfma_f32_16x16x32_bf16 v[168:171], a[40:43], a[224:227], v[168:171]
    v_mfma_f32_16x16x32_bf16 v[168:171], a[56:59], a[220:223], v[168:171]
    v_mfma_f32_16x16x32_bf16 v[172:175], a[60:63], a[220:223], v[172:175]
    v_mfma_f32_16x16x32_bf16 v[172:175], a[44:47], a[224:227], v[172:175]
    buffer_load_dwordx4 v19, s[16:19], s38 offen offset:1024 lds
    v_mfma_f32_16x16x32_bf16 v[188:191], a[44:47], a[220:223], v[188:191]
    s_waitcnt lgkmcnt(1)
    v_mfma_f32_16x16x32_bf16 v[188:191], a[60:63], a[232:235], v[188:191]
    ds_read_b128 a[252:255], v0 offset:14336
    v_mfma_f32_16x16x32_bf16 v[184:187], a[56:59], a[232:235], v[184:187]
    s_add_u32 m0, s36, 155648
    s_mov_b32 s38, 885248
    v_mfma_f32_16x16x32_bf16 v[184:187], a[40:43], a[220:223], v[184:187]
    v_mfma_f32_16x16x32_bf16 v[180:183], a[36:39], a[220:223], v[180:183]
    buffer_load_dwordx4 v18, s[16:19], s38 offen offset:0 lds
    v_mfma_f32_16x16x32_bf16 v[180:183], a[52:55], a[232:235], v[180:183]
    v_mfma_f32_16x16x32_bf16 v[176:179], a[48:51], a[232:235], v[176:179]
    v_mfma_f32_16x16x32_bf16 v[176:179], a[32:35], a[220:223], v[176:179]
    v_mfma_f32_16x16x32_bf16 v[192:195], a[32:35], a[232:235], v[192:195]
    v_mfma_f32_16x16x32_bf16 v[192:195], a[48:51], a[236:239], v[192:195]
    buffer_load_dwordx4 v19, s[16:19], s38 offen offset:1024 lds
    v_mfma_f32_16x16x32_bf16 v[196:199], a[52:55], a[236:239], v[196:199]
    ds_read_b128 a[208:211], v0 offset:16384
    v_mfma_f32_16x16x32_bf16 v[196:199], a[36:39], a[232:235], v[196:199]
    s_waitcnt vmcnt(6) lgkmcnt(2)
    ds_read_b64_tr_b16 a[64:65], v20 offset:28672
    ds_read_b64_tr_b16 a[66:67], v20 offset:28928
    v_mfma_f32_16x16x32_bf16 v[200:203], a[40:43], a[232:235], v[200:203]
    s_add_u32 m0, s36, 102400
    ds_read_b64_tr_b16 a[68:69], v21 offset:28672
    ds_read_b64_tr_b16 a[70:71], v21 offset:28928
    v_mfma_f32_16x16x32_bf16 v[200:203], a[56:59], a[236:239], v[200:203]
    s_mov_b32 s38, 65536
    v_mfma_f32_16x16x32_bf16 v[204:207], a[60:63], a[236:239], v[204:207]
    buffer_load_dwordx4 v18, s[16:19], s38 offen offset:0 lds
    v_mfma_f32_16x16x32_bf16 v[204:207], a[44:47], a[232:235], v[204:207]
    v_mfma_f32_16x16x32_bf16 v[220:223], a[44:47], a[236:239], v[220:223]
    ds_read_b128 a[228:231], v1 offset:0
    v_mfma_f32_16x16x32_bf16 v[220:223], a[60:63], a[240:243], v[220:223]
    ds_read_b128 a[216:219], v1 offset:2048
    v_mfma_f32_16x16x32_bf16 v[216:219], a[56:59], a[240:243], v[216:219]
    v_mfma_f32_16x16x32_bf16 v[216:219], a[40:43], a[236:239], v[216:219]
    buffer_load_dwordx4 v19, s[16:19], s38 offen offset:1024 lds
    v_mfma_f32_16x16x32_bf16 v[212:215], a[36:39], a[236:239], v[212:215]
    v_mfma_f32_16x16x32_bf16 v[212:215], a[52:55], a[240:243], v[212:215]
    s_waitcnt vmcnt(6) lgkmcnt(7)
    ds_read_b64_tr_b16 a[80:81], v20 offset:36864
    ds_read_b64_tr_b16 a[82:83], v20 offset:37120
    v_mfma_f32_16x16x32_bf16 v[208:211], a[48:51], a[240:243], v[208:211]
    s_add_u32 m0, s36, 110592
    ds_read_b64_tr_b16 a[84:85], v21 offset:36864
    ds_read_b64_tr_b16 a[86:87], v21 offset:37120
    v_mfma_f32_16x16x32_bf16 v[208:211], a[32:35], a[236:239], v[208:211]
    s_mov_b32 s38, 589824
    v_mfma_f32_16x16x32_bf16 v[224:227], a[32:35], a[240:243], v[224:227]
    buffer_load_dwordx4 v18, s[16:19], s38 offen offset:0 lds
    v_mfma_f32_16x16x32_bf16 v[224:227], a[48:51], a[244:247], v[224:227]
    ds_read_b128 a[212:215], v1 offset:4096
    v_mfma_f32_16x16x32_bf16 v[228:231], a[52:55], a[244:247], v[228:231]
    v_mfma_f32_16x16x32_bf16 v[228:231], a[36:39], a[240:243], v[228:231]
    v_mfma_f32_16x16x32_bf16 v[232:235], a[40:43], a[240:243], v[232:235]
    v_mfma_f32_16x16x32_bf16 v[232:235], a[56:59], a[244:247], v[232:235]
    buffer_load_dwordx4 v19, s[16:19], s38 offen offset:1024 lds
    v_mfma_f32_16x16x32_bf16 v[236:239], a[60:63], a[244:247], v[236:239]
    v_mfma_f32_16x16x32_bf16 v[236:239], a[44:47], a[240:243], v[236:239]
    s_waitcnt vmcnt(6) lgkmcnt(5)
    ds_read_b64_tr_b16 a[72:73], v20 offset:45056
    ds_read_b64_tr_b16 a[74:75], v20 offset:45312
    v_mfma_f32_16x16x32_bf16 v[252:255], a[44:47], a[244:247], v[252:255]
    s_add_u32 m0, s36, 122880
    ds_read_b64_tr_b16 a[76:77], v21 offset:45056
    ds_read_b64_tr_b16 a[78:79], v21 offset:45312
    v_mfma_f32_16x16x32_bf16 v[252:255], a[60:63], a[248:251], v[252:255]
    s_mov_b32 s38, 1114112
    ds_read_b128 a[224:227], v1 offset:6144
    v_mfma_f32_16x16x32_bf16 v[248:251], a[56:59], a[248:251], v[248:251]
    buffer_load_dwordx4 v18, s[16:19], s38 offen offset:0 lds
    v_mfma_f32_16x16x32_bf16 v[248:251], a[40:43], a[244:247], v[248:251]
    v_mfma_f32_16x16x32_bf16 v[244:247], a[36:39], a[244:247], v[244:247]
    v_mfma_f32_16x16x32_bf16 v[244:247], a[52:55], a[248:251], v[244:247]
    v_mfma_f32_16x16x32_bf16 v[240:243], a[48:51], a[248:251], v[240:243]
    v_mfma_f32_16x16x32_bf16 v[240:243], a[32:35], a[244:247], v[240:243]
    buffer_load_dwordx4 v19, s[16:19], s38 offen offset:1024 lds
    v_mfma_f32_16x16x32_bf16 a[0:3], a[32:35], a[248:251], a[0:3]
    v_mfma_f32_16x16x32_bf16 a[0:3], a[48:51], a[252:255], a[0:3]
    s_waitcnt vmcnt(6) lgkmcnt(5)
    ds_read_b64_tr_b16 a[88:89], v20 offset:53248
    ds_read_b64_tr_b16 a[90:91], v20 offset:53504
    v_mfma_f32_16x16x32_bf16 a[4:7], a[52:55], a[252:255], a[4:7]
    s_add_u32 m0, s36, 131072
    ds_read_b64_tr_b16 a[92:93], v21 offset:53248
    ds_read_b64_tr_b16 a[94:95], v21 offset:53504
    v_mfma_f32_16x16x32_bf16 a[4:7], a[36:39], a[248:251], a[4:7]
    s_mov_b32 s38, 66048
    ds_read_b128 a[220:223], v1 offset:8192
    v_mfma_f32_16x16x32_bf16 a[8:11], a[40:43], a[248:251], a[8:11]
    buffer_load_dwordx4 v18, s[16:19], s38 offen offset:0 lds
    v_mfma_f32_16x16x32_bf16 a[8:11], a[56:59], a[252:255], a[8:11]
    v_mfma_f32_16x16x32_bf16 a[12:15], a[60:63], a[252:255], a[12:15]
    v_mfma_f32_16x16x32_bf16 a[12:15], a[44:47], a[248:251], a[12:15]
    v_mfma_f32_16x16x32_bf16 a[16:19], a[32:35], a[252:255], a[16:19]
    v_mfma_f32_16x16x32_bf16 a[16:19], a[48:51], a[208:211], a[16:19]
    buffer_load_dwordx4 v19, s[16:19], s38 offen offset:1024 lds
    v_mfma_f32_16x16x32_bf16 a[20:23], a[52:55], a[208:211], a[20:23]
    ds_read_b128 a[232:235], v1 offset:10240
    v_mfma_f32_16x16x32_bf16 a[20:23], a[36:39], a[252:255], a[20:23]
    s_waitcnt vmcnt(6) lgkmcnt(6)
    ds_read_b64_tr_b16 a[96:97], v20 offset:0
    ds_read_b64_tr_b16 a[98:99], v20 offset:256
    v_mfma_f32_16x16x32_bf16 a[24:27], a[40:43], a[252:255], a[24:27]
    s_add_u32 m0, s36, 139264
    ds_read_b64_tr_b16 a[100:101], v21 offset:0
    ds_read_b64_tr_b16 a[102:103], v21 offset:256
    v_mfma_f32_16x16x32_bf16 a[24:27], a[56:59], a[208:211], a[24:27]
    s_mov_b32 s38, 590336
    v_mfma_f32_16x16x32_bf16 a[28:31], a[60:63], a[208:211], a[28:31]
    buffer_load_dwordx4 v18, s[16:19], s38 offen offset:0 lds
    v_mfma_f32_16x16x32_bf16 a[28:31], a[44:47], a[252:255], a[28:31]
    v_mfma_f32_16x16x32_bf16 v[160:163], a[64:67], a[228:231], v[160:163]
    v_mfma_f32_16x16x32_bf16 v[160:163], a[80:83], a[216:219], v[160:163]
    ds_read_b128 a[236:239], v1 offset:12288
    v_mfma_f32_16x16x32_bf16 v[164:167], a[84:87], a[216:219], v[164:167]
    v_mfma_f32_16x16x32_bf16 v[164:167], a[68:71], a[228:231], v[164:167]
    buffer_load_dwordx4 v19, s[16:19], s38 offen offset:1024 lds
    v_mfma_f32_16x16x32_bf16 v[168:171], a[72:75], a[228:231], v[168:171]
    s_waitcnt lgkmcnt(6)
    v_mfma_f32_16x16x32_bf16 v[168:171], a[88:91], a[216:219], v[168:171]
    s_waitcnt vmcnt(6)
    ds_read_b64_tr_b16 a[112:113], v20 offset:8192
    ds_read_b64_tr_b16 a[114:115], v20 offset:8448
    v_mfma_f32_16x16x32_bf16 v[172:175], a[92:95], a[216:219], v[172:175]
    s_add_u32 m0, s36, 147456
    ds_read_b64_tr_b16 a[116:117], v21 offset:8192
    ds_read_b64_tr_b16 a[118:119], v21 offset:8448
    v_mfma_f32_16x16x32_bf16 v[172:175], a[76:79], a[228:231], v[172:175]
    s_mov_b32 s38, 1114624
    v_mfma_f32_16x16x32_bf16 v[188:191], a[76:79], a[216:219], v[188:191]
    buffer_load_dwordx4 v18, s[16:19], s38 offen offset:0 lds
    v_mfma_f32_16x16x32_bf16 v[188:191], a[92:95], a[212:215], v[188:191]
    ds_read_b128 a[240:243], v1 offset:14336
    v_mfma_f32_16x16x32_bf16 v[184:187], a[88:91], a[212:215], v[184:187]
    v_mfma_f32_16x16x32_bf16 v[184:187], a[72:75], a[216:219], v[184:187]
    v_mfma_f32_16x16x32_bf16 v[180:183], a[68:71], a[216:219], v[180:183]
    v_mfma_f32_16x16x32_bf16 v[180:183], a[84:87], a[212:215], v[180:183]
    buffer_load_dwordx4 v19, s[16:19], s38 offen offset:1024 lds
    v_mfma_f32_16x16x32_bf16 v[176:179], a[80:83], a[212:215], v[176:179]
    v_mfma_f32_16x16x32_bf16 v[176:179], a[64:67], a[216:219], v[176:179]
    s_waitcnt vmcnt(6) lgkmcnt(5)
    ds_read_b64_tr_b16 a[128:129], v20 offset:20480
    ds_read_b64_tr_b16 a[130:131], v20 offset:20736
    v_mfma_f32_16x16x32_bf16 v[192:195], a[64:67], a[212:215], v[192:195]
    s_add_u32 m0, s36, 155648
    ds_read_b64_tr_b16 a[132:133], v21 offset:20480
    ds_read_b64_tr_b16 a[134:135], v21 offset:20736
    v_mfma_f32_16x16x32_bf16 v[192:195], a[80:83], a[224:227], v[192:195]
    s_mov_b32 s38, 98304
    ds_read_b128 a[244:247], v1 offset:16384
    v_mfma_f32_16x16x32_bf16 v[196:199], a[84:87], a[224:227], v[196:199]
    buffer_load_dwordx4 v18, s[16:19], s38 offen offset:0 lds
    v_mfma_f32_16x16x32_bf16 v[196:199], a[68:71], a[212:215], v[196:199]
    v_mfma_f32_16x16x32_bf16 v[200:203], a[72:75], a[212:215], v[200:203]
    v_mfma_f32_16x16x32_bf16 v[200:203], a[88:91], a[224:227], v[200:203]
    v_mfma_f32_16x16x32_bf16 v[204:207], a[92:95], a[224:227], v[204:207]
    v_mfma_f32_16x16x32_bf16 v[204:207], a[76:79], a[212:215], v[204:207]
    buffer_load_dwordx4 v19, s[16:19], s38 offen offset:1024 lds
    v_mfma_f32_16x16x32_bf16 v[220:223], a[76:79], a[224:227], v[220:223]
    v_mfma_f32_16x16x32_bf16 v[220:223], a[92:95], a[220:223], v[220:223]
    s_waitcnt vmcnt(6) lgkmcnt(5)
    ds_read_b64_tr_b16 a[104:105], v20 offset:28672
    ds_read_b64_tr_b16 a[106:107], v20 offset:28928
    v_mfma_f32_16x16x32_bf16 v[216:219], a[88:91], a[220:223], v[216:219]
    s_add_u32 m0, s36, 102400
    ds_read_b64_tr_b16 a[108:109], v21 offset:28672
    ds_read_b64_tr_b16 a[110:111], v21 offset:28928
    v_mfma_f32_16x16x32_bf16 v[216:219], a[72:75], a[224:227], v[216:219]
    s_mov_b32 s38, 622592
    v_mfma_f32_16x16x32_bf16 v[212:215], a[68:71], a[224:227], v[212:215]
    buffer_load_dwordx4 v18, s[16:19], s38 offen offset:0 lds
    v_mfma_f32_16x16x32_bf16 v[212:215], a[84:87], a[220:223], v[212:215]
    v_mfma_f32_16x16x32_bf16 v[208:211], a[80:83], a[220:223], v[208:211]
    v_mfma_f32_16x16x32_bf16 v[208:211], a[64:67], a[224:227], v[208:211]
    v_mfma_f32_16x16x32_bf16 v[224:227], a[64:67], a[220:223], v[224:227]
    v_mfma_f32_16x16x32_bf16 v[224:227], a[80:83], a[232:235], v[224:227]
    buffer_load_dwordx4 v19, s[16:19], s38 offen offset:1024 lds
    v_mfma_f32_16x16x32_bf16 v[228:231], a[84:87], a[232:235], v[228:231]
    v_mfma_f32_16x16x32_bf16 v[228:231], a[68:71], a[220:223], v[228:231]
    s_waitcnt vmcnt(6) lgkmcnt(4)
    ds_read_b64_tr_b16 a[120:121], v20 offset:36864
    ds_read_b64_tr_b16 a[122:123], v20 offset:37120
    v_mfma_f32_16x16x32_bf16 v[232:235], a[72:75], a[220:223], v[232:235]
    s_add_u32 m0, s36, 110592
    ds_read_b64_tr_b16 a[124:125], v21 offset:36864
    ds_read_b64_tr_b16 a[126:127], v21 offset:37120
    v_mfma_f32_16x16x32_bf16 v[232:235], a[88:91], a[232:235], v[232:235]
    s_mov_b32 s38, 1146880
    v_mfma_f32_16x16x32_bf16 v[236:239], a[92:95], a[232:235], v[236:239]
    buffer_load_dwordx4 v18, s[16:19], s38 offen offset:0 lds
    v_mfma_f32_16x16x32_bf16 v[236:239], a[76:79], a[220:223], v[236:239]
    v_mfma_f32_16x16x32_bf16 v[252:255], a[76:79], a[232:235], v[252:255]
    v_mfma_f32_16x16x32_bf16 v[252:255], a[92:95], a[236:239], v[252:255]
    v_mfma_f32_16x16x32_bf16 v[248:251], a[88:91], a[236:239], v[248:251]
    v_mfma_f32_16x16x32_bf16 v[248:251], a[72:75], a[232:235], v[248:251]
    buffer_load_dwordx4 v19, s[16:19], s38 offen offset:1024 lds
    v_mfma_f32_16x16x32_bf16 v[244:247], a[68:71], a[232:235], v[244:247]
    v_mfma_f32_16x16x32_bf16 v[244:247], a[84:87], a[236:239], v[244:247]
    s_waitcnt vmcnt(6) lgkmcnt(4)
    ds_read_b64_tr_b16 a[136:137], v20 offset:45056
    ds_read_b64_tr_b16 a[138:139], v20 offset:45312
    v_mfma_f32_16x16x32_bf16 v[240:243], a[80:83], a[236:239], v[240:243]
    s_add_u32 m0, s36, 122880
    ds_read_b64_tr_b16 a[140:141], v21 offset:45056
    ds_read_b64_tr_b16 a[142:143], v21 offset:45312
    v_mfma_f32_16x16x32_bf16 v[240:243], a[64:67], a[232:235], v[240:243]
    s_mov_b32 s38, 98816
    s_barrier
    ds_read_b128 a[248:251], v0 offset:40960
    v_mfma_f32_16x16x32_bf16 a[0:3], a[64:67], a[236:239], a[0:3]
    buffer_load_dwordx4 v18, s[16:19], s38 offen offset:0 lds
    v_mfma_f32_16x16x32_bf16 a[0:3], a[80:83], a[240:243], a[0:3]
    ds_read_b128 a[208:211], v0 offset:43008
    ds_read_b128 a[252:255], v0 offset:45056
    v_mfma_f32_16x16x32_bf16 a[4:7], a[84:87], a[240:243], a[4:7]
    ds_read_b128 a[228:231], v0 offset:47104
    ds_read_b128 a[216:219], v0 offset:49152
    v_mfma_f32_16x16x32_bf16 a[4:7], a[68:71], a[236:239], a[4:7]
    v_mfma_f32_16x16x32_bf16 a[8:11], a[72:75], a[236:239], a[8:11]
    v_mfma_f32_16x16x32_bf16 a[8:11], a[88:91], a[240:243], a[8:11]
    buffer_load_dwordx4 v19, s[16:19], s38 offen offset:1024 lds
    v_mfma_f32_16x16x32_bf16 a[12:15], a[92:95], a[240:243], a[12:15]
    v_mfma_f32_16x16x32_bf16 a[12:15], a[76:79], a[236:239], a[12:15]
    s_waitcnt vmcnt(6) lgkmcnt(9)
    ds_read_b64_tr_b16 a[144:145], v20 offset:53248
    ds_read_b64_tr_b16 a[146:147], v20 offset:53504
    v_mfma_f32_16x16x32_bf16 a[16:19], a[64:67], a[240:243], a[16:19]
    buffer_load_dword a194, v26, s[16:19], s24 offen
    v_mfma_f32_16x16x32_bf16 a[16:19], a[80:83], a[244:247], a[16:19]
    ds_read_b64_tr_b16 a[148:149], v21 offset:53248
    ds_read_b64_tr_b16 a[150:151], v21 offset:53504
    v_mfma_f32_16x16x32_bf16 a[20:23], a[84:87], a[244:247], a[20:23]
    v_mfma_f32_16x16x32_bf16 a[20:23], a[68:71], a[240:243], a[20:23]
    s_add_u32 m0, s36, 131072
    s_mov_b32 s38, 623104
    v_mfma_f32_16x16x32_bf16 a[24:27], a[72:75], a[240:243], a[24:27]
    v_mfma_f32_16x16x32_bf16 a[24:27], a[88:91], a[244:247], a[24:27]
    buffer_load_dwordx4 v18, s[16:19], s38 offen offset:0 lds
    v_mfma_f32_16x16x32_bf16 a[28:31], a[92:95], a[244:247], a[28:31]
    ds_read_b128 a[212:215], v0 offset:51200
    v_mfma_f32_16x16x32_bf16 a[28:31], a[76:79], a[240:243], a[28:31]
    s_waitcnt lgkmcnt(5)
    v_mfma_f32_16x16x32_bf16 v[32:35], a[96:99], a[248:251], v[32:35]
    v_add_u32 v2, 20480, v2
    v_mfma_f32_16x16x32_bf16 v[32:35], a[112:115], a[208:211], v[32:35]
    s_waitcnt vmcnt(6)
    ds_read_b64_tr_b16 a[160:161], v20 offset:0
    ds_read_b64_tr_b16 a[162:163], v20 offset:256
    v_mfma_f32_16x16x32_bf16 v[32:35], a[128:131], a[252:255], v[32:35]
    buffer_load_dwordx4 v19, s[16:19], s38 offen offset:1024 lds
    v_mfma_f32_16x16x32_bf16 v[36:39], a[132:135], a[252:255], v[36:39]
    ds_read_b64_tr_b16 a[164:165], v21 offset:0
    ds_read_b64_tr_b16 a[166:167], v21 offset:256
    v_mfma_f32_16x16x32_bf16 v[36:39], a[116:119], a[208:211], v[36:39]
    ds_read_b128 v[6:9], v2 offset:40960
    ds_read_b128 v[10:13], v2 offset:0
    v_mfma_f32_16x16x32_bf16 v[36:39], a[100:103], a[248:251], v[36:39]
    s_add_u32 m0, s36, 139264
    s_mov_b32 s38, 1147392
    v_mfma_f32_16x16x32_bf16 v[40:43], a[104:107], a[248:251], v[40:43]
    v_mfma_f32_16x16x32_bf16 v[40:43], a[120:123], a[208:211], v[40:43]
    buffer_load_dwordx4 v18, s[16:19], s38 offen offset:0 lds
    v_mfma_f32_16x16x32_bf16 v[40:43], a[136:139], a[252:255], v[40:43]
    v_mfma_f32_16x16x32_bf16 v[44:47], a[140:143], a[252:255], v[44:47]
    v_mfma_f32_16x16x32_bf16 v[44:47], a[124:127], a[208:211], v[44:47]
    ds_read_b128 a[224:227], v0 offset:53248
    v_mfma_f32_16x16x32_bf16 v[44:47], a[108:111], a[248:251], v[44:47]
    s_waitcnt vmcnt(6) lgkmcnt(7)
    ds_read_b64_tr_b16 a[176:177], v20 offset:8192
    ds_read_b64_tr_b16 a[178:179], v20 offset:8448
    v_mfma_f32_16x16x32_bf16 v[60:63], a[108:111], a[208:211], v[60:63]
    buffer_load_dwordx4 v19, s[16:19], s38 offen offset:1024 lds
    v_mfma_f32_16x16x32_bf16 v[60:63], a[124:127], a[252:255], v[60:63]
    ds_read_b64_tr_b16 a[180:181], v21 offset:8192
    ds_read_b64_tr_b16 a[182:183], v21 offset:8448
    v_mfma_f32_16x16x32_bf16 v[60:63], a[140:143], a[228:231], v[60:63]
    s_waitcnt lgkmcnt(6)
    v_lshlrev_b32 v14, 16, v6
    v_mfma_f32_16x16x32_bf16 v[56:59], a[136:139], a[228:231], v[56:59]
    s_waitcnt lgkmcnt(5)
    v_lshlrev_b32 v15, 16, v10
    v_and_b32 v6, s34, v6
    v_mfma_f32_16x16x32_bf16 v[56:59], a[120:123], a[252:255], v[56:59]
    v_and_b32 v10, s34, v10
    v_add_f32 v14, v14, v15
    v_mfma_f32_16x16x32_bf16 v[56:59], a[104:107], a[208:211], v[56:59]
    v_add_f32 v6, v6, v10
    v_cvt_pk_bf16_f32 v6, v14, v6
    v_mfma_f32_16x16x32_bf16 v[52:55], a[100:103], a[208:211], v[52:55]
    v_lshlrev_b32 v14, 16, v7
    v_lshlrev_b32 v15, 16, v11
    v_mfma_f32_16x16x32_bf16 v[52:55], a[116:119], a[252:255], v[52:55]
    v_mfma_f32_16x16x32_bf16 v[52:55], a[132:135], a[228:231], v[52:55]
    v_mfma_f32_16x16x32_bf16 v[48:51], a[128:131], a[228:231], v[48:51]
    v_mfma_f32_16x16x32_bf16 v[48:51], a[112:115], a[252:255], v[48:51]
    s_waitcnt vmcnt(5)
    ds_read_b64_tr_b16 a[152:153], v20 offset:20480
    ds_read_b64_tr_b16 a[154:155], v20 offset:20736
    v_mfma_f32_16x16x32_bf16 v[48:51], a[96:99], a[208:211], v[48:51]
    ds_read_b64_tr_b16 a[156:157], v21 offset:20480
    ds_read_b64_tr_b16 a[158:159], v21 offset:20736
    v_mfma_f32_16x16x32_bf16 v[64:67], a[96:99], a[252:255], v[64:67]
    ds_read_b128 a[220:223], v0 offset:55296
    v_and_b32 v7, s34, v7
    v_mfma_f32_16x16x32_bf16 v[64:67], a[112:115], a[228:231], v[64:67]
    v_and_b32 v11, s34, v11
    v_add_f32 v14, v14, v15
    v_mfma_f32_16x16x32_bf16 v[64:67], a[128:131], a[216:219], v[64:67]
    v_add_f32 v7, v7, v11
    v_cvt_pk_bf16_f32 v7, v14, v7
    v_mfma_f32_16x16x32_bf16 v[68:71], a[132:135], a[216:219], v[68:71]
    v_lshlrev_b32 v14, 16, v8
    v_lshlrev_b32 v15, 16, v12
    v_mfma_f32_16x16x32_bf16 v[68:71], a[116:119], a[228:231], v[68:71]
    v_and_b32 v8, s34, v8
    v_and_b32 v12, s34, v12
    v_mfma_f32_16x16x32_bf16 v[68:71], a[100:103], a[252:255], v[68:71]
    v_add_f32 v14, v14, v15
    v_add_f32 v8, v8, v12
    v_mfma_f32_16x16x32_bf16 v[72:75], a[104:107], a[252:255], v[72:75]
    v_cvt_pk_bf16_f32 v8, v14, v8
    v_lshlrev_b32 v14, 16, v9
    v_mfma_f32_16x16x32_bf16 v[72:75], a[120:123], a[228:231], v[72:75]
    s_add_u32 m0, s36, 147456
    s_mov_b32 s38, 393216
    v_lshlrev_b32 v15, 16, v13
    v_mfma_f32_16x16x32_bf16 v[72:75], a[136:139], a[216:219], v[72:75]
    buffer_load_dwordx4 v18, s[16:19], s38 offen offset:0 lds
    v_mfma_f32_16x16x32_bf16 v[76:79], a[140:143], a[216:219], v[76:79]
    v_and_b32 v9, s34, v9
    v_and_b32 v13, s34, v13
    v_mfma_f32_16x16x32_bf16 v[76:79], a[124:127], a[228:231], v[76:79]
    ds_read_b128 a[232:235], v0 offset:57344
    v_add_f32 v14, v14, v15
    v_mfma_f32_16x16x32_bf16 v[76:79], a[108:111], a[252:255], v[76:79]
    v_add_f32 v9, v9, v13
    v_cvt_pk_bf16_f32 v9, v14, v9
    v_mfma_f32_16x16x32_bf16 v[92:95], a[108:111], a[228:231], v[92:95]
    ds_write_b128 v2, v[6:9] offset:0
    v_mfma_f32_16x16x32_bf16 v[92:95], a[124:127], a[216:219], v[92:95]
    buffer_load_dwordx4 v19, s[16:19], s38 offen offset:1024 lds
    v_mfma_f32_16x16x32_bf16 v[92:95], a[140:143], a[212:215], v[92:95]
    ds_read_b128 v[6:9], v2 offset:43008
    ds_read_b128 v[10:13], v2 offset:2048
    v_mfma_f32_16x16x32_bf16 v[88:91], a[136:139], a[212:215], v[88:91]
    v_mfma_f32_16x16x32_bf16 v[88:91], a[120:123], a[216:219], v[88:91]
    s_add_u32 m0, s36, 155648
    s_mov_b32 s38, 917504
    v_mfma_f32_16x16x32_bf16 v[88:91], a[104:107], a[228:231], v[88:91]
    v_mfma_f32_16x16x32_bf16 v[84:87], a[100:103], a[228:231], v[84:87]
    s_waitcnt vmcnt(4) lgkmcnt(4)
    ds_read_b64_tr_b16 a[168:169], v20 offset:28672
    ds_read_b64_tr_b16 a[170:171], v20 offset:28928
    v_mfma_f32_16x16x32_bf16 v[84:87], a[116:119], a[216:219], v[84:87]
    buffer_load_dwordx4 v18, s[16:19], s38 offen offset:0 lds
    v_mfma_f32_16x16x32_bf16 v[84:87], a[132:135], a[212:215], v[84:87]
    ds_read_b64_tr_b16 a[172:173], v21 offset:28672
    ds_read_b64_tr_b16 a[174:175], v21 offset:28928
    v_mfma_f32_16x16x32_bf16 v[80:83], a[128:131], a[212:215], v[80:83]
    s_waitcnt vmcnt(3)
    ds_read_b64_tr_b16 a[184:185], v20 offset:36864
    ds_read_b64_tr_b16 a[186:187], v20 offset:37120
    v_mfma_f32_16x16x32_bf16 v[80:83], a[112:115], a[216:219], v[80:83]
    ds_read_b64_tr_b16 a[188:189], v21 offset:36864
    ds_read_b64_tr_b16 a[190:191], v21 offset:37120
    v_mfma_f32_16x16x32_bf16 v[80:83], a[96:99], a[228:231], v[80:83]
    buffer_load_dwordx4 v19, s[16:19], s38 offen offset:1024 lds
    v_mfma_f32_16x16x32_bf16 v[96:99], a[96:99], a[216:219], v[96:99]
    ds_read_b128 a[236:239], v0 offset:59392
    v_mfma_f32_16x16x32_bf16 v[96:99], a[112:115], a[212:215], v[96:99]
    s_waitcnt lgkmcnt(10)
    v_lshlrev_b32 v14, 16, v6
    v_mfma_f32_16x16x32_bf16 v[96:99], a[128:131], a[224:227], v[96:99]
    s_add_u32 m0, s36, 102400
    s_mov_b32 s38, 393728
    v_mfma_f32_16x16x32_bf16 v[100:103], a[132:135], a[224:227], v[100:103]
    s_waitcnt lgkmcnt(9)
    v_lshlrev_b32 v15, 16, v10
    v_and_b32 v6, s34, v6
    v_mfma_f32_16x16x32_bf16 v[100:103], a[116:119], a[212:215], v[100:103]
    buffer_load_dwordx4 v18, s[16:19], s38 offen offset:0 lds
    v_mfma_f32_16x16x32_bf16 v[100:103], a[100:103], a[216:219], v[100:103]
    v_and_b32 v10, s34, v10
    v_add_f32 v14, v14, v15
    v_mfma_f32_16x16x32_bf16 v[104:107], a[104:107], a[216:219], v[104:107]
    v_add_f32 v6, v6, v10
    v_cvt_pk_bf16_f32 v6, v14, v6
    v_mfma_f32_16x16x32_bf16 v[104:107], a[120:123], a[212:215], v[104:107]
    v_lshlrev_b32 v14, 16, v7
    v_lshlrev_b32 v15, 16, v11
    v_mfma_f32_16x16x32_bf16 v[104:107], a[136:139], a[224:227], v[104:107]
    ds_read_b128 a[244:247], v1 offset:40960
    v_and_b32 v7, s34, v7
    v_mfma_f32_16x16x32_bf16 v[108:111], a[140:143], a[224:227], v[108:111]
    buffer_load_dwordx4 v19, s[16:19], s38 offen offset:1024 lds
    v_mfma_f32_16x16x32_bf16 v[108:111], a[124:127], a[212:215], v[108:111]
    ds_read_b128 a[240:243], v1 offset:43008
    ds_read_b128 a[248:251], v1 offset:45056
    v_mfma_f32_16x16x32_bf16 v[108:111], a[108:111], a[216:219], v[108:111]
    v_and_b32 v11, s34, v11
    v_add_f32 v14, v14, v15
    v_mfma_f32_16x16x32_bf16 v[124:127], a[108:111], a[212:215], v[124:127]
    s_add_u32 m0, s36, 110592
    s_mov_b32 s38, 918016
    v_add_f32 v7, v7, v11
    v_mfma_f32_16x16x32_bf16 v[124:127], a[124:127], a[224:227], v[124:127]
    v_cvt_pk_bf16_f32 v7, v14, v7
    v_lshlrev_b32 v14, 16, v8
    v_mfma_f32_16x16x32_bf16 v[124:127], a[140:143], a[220:223], v[124:127]
    buffer_load_dwordx4 v18, s[16:19], s38 offen offset:0 lds
    v_mfma_f32_16x16x32_bf16 v[120:123], a[136:139], a[220:223], v[120:123]
    v_lshlrev_b32 v15, 16, v12
    v_and_b32 v8, s34, v8
    v_mfma_f32_16x16x32_bf16 v[120:123], a[120:123], a[224:227], v[120:123]
    v_and_b32 v12, s34, v12
    v_add_f32 v14, v14, v15
    v_mfma_f32_16x16x32_bf16 v[120:123], a[104:107], a[212:215], v[120:123]
    v_add_f32 v8, v8, v12
    v_cvt_pk_bf16_f32 v8, v14, v8
    v_mfma_f32_16x16x32_bf16 v[116:119], a[100:103], a[212:215], v[116:119]
    v_lshlrev_b32 v14, 16, v9
    v_lshlrev_b32 v15, 16, v13
    v_mfma_f32_16x16x32_bf16 v[116:119], a[116:119], a[224:227], v[116:119]
    buffer_load_dwordx4 v19, s[16:19], s38 offen offset:1024 lds
    v_mfma_f32_16x16x32_bf16 v[116:119], a[132:135], a[220:223], v[116:119]
    v_and_b32 v9, s34, v9
    v_and_b32 v13, s34, v13
    v_mfma_f32_16x16x32_bf16 v[112:115], a[128:131], a[220:223], v[112:115]
    s_waitcnt vmcnt(6) lgkmcnt(2)
    ds_read_b64_tr_b16 a[32:33], v20 offset:45056
    ds_read_b64_tr_b16 a[34:35], v20 offset:45312
    v_mfma_f32_16x16x32_bf16 v[112:115], a[112:115], a[224:227], v[112:115]
    ds_read_b64_tr_b16 a[36:37], v21 offset:45056
    ds_read_b64_tr_b16 a[38:39], v21 offset:45312
    v_mfma_f32_16x16x32_bf16 v[112:115], a[96:99], a[212:215], v[112:115]
    s_add_u32 m0, s37, 81920
    ds_read_b128 a[208:211], v1 offset:47104
    s_mov_b32 s38, 1280
    v_mfma_f32_16x16x32_bf16 v[128:131], a[96:99], a[224:227], v[128:131]
    buffer_load_dwordx4 v16, s[12:15], s38 offen offset:0 nt lds
    v_mfma_f32_16x16x32_bf16 v[128:131], a[112:115], a[220:223], v[128:131]
    v_add_f32 v14, v14, v15
    v_add_f32 v9, v9, v13
    v_mfma_f32_16x16x32_bf16 v[128:131], a[128:131], a[232:235], v[128:131]
    v_cvt_pk_bf16_f32 v9, v14, v9
    v_mfma_f32_16x16x32_bf16 v[132:135], a[132:135], a[232:235], v[132:135]
    buffer_load_dwordx4 v16, s[12:15], s38 offen offset:2048 nt lds
    v_mfma_f32_16x16x32_bf16 v[132:135], a[116:119], a[220:223], v[132:135]
    s_add_u32 m0, s37, 86016
    ds_write_b128 v2, v[6:9] offset:2048
    v_mfma_f32_16x16x32_bf16 v[132:135], a[100:103], a[224:227], v[132:135]
    ds_read_b128 v[6:9], v2 offset:45056
    ds_read_b128 v[10:13], v2 offset:4096
    v_mfma_f32_16x16x32_bf16 v[136:139], a[104:107], a[224:227], v[136:139]
    buffer_load_dwordx4 v17, s[12:15], s38 offen offset:0 nt lds
    v_mfma_f32_16x16x32_bf16 v[136:139], a[120:123], a[220:223], v[136:139]
    s_waitcnt vmcnt(7) lgkmcnt(8)
    ds_read_b64_tr_b16 a[48:49], v20 offset:53248
    ds_read_b64_tr_b16 a[50:51], v20 offset:53504
    v_mfma_f32_16x16x32_bf16 v[136:139], a[136:139], a[232:235], v[136:139]
    ds_read_b64_tr_b16 a[52:53], v21 offset:53248
    ds_read_b64_tr_b16 a[54:55], v21 offset:53504
    v_mfma_f32_16x16x32_bf16 v[140:143], a[140:143], a[232:235], v[140:143]
    buffer_load_dwordx4 v17, s[12:15], s38 offen offset:2048 nt lds
    v_mfma_f32_16x16x32_bf16 v[140:143], a[124:127], a[220:223], v[140:143]
    s_add_u32 m0, s37, 90112
    ds_read_b128 a[252:255], v1 offset:49152
    s_mov_b32 s38, 5376
    v_mfma_f32_16x16x32_bf16 v[140:143], a[108:111], a[224:227], v[140:143]
    v_mfma_f32_16x16x32_bf16 v[144:147], a[96:99], a[220:223], v[144:147]
    buffer_load_dwordx4 v17, s[12:15], s38 offen offset:0 nt lds
    v_mfma_f32_16x16x32_bf16 v[144:147], a[112:115], a[232:235], v[144:147]
    s_add_u32 m0, s37, 40960
    s_mov_b32 s38, 256
    v_mfma_f32_16x16x32_bf16 v[144:147], a[128:131], a[236:239], v[144:147]
    v_mfma_f32_16x16x32_bf16 v[148:151], a[132:135], a[236:239], v[148:151]
    buffer_load_dwordx4 v16, s[12:15], s38 offen offset:0 nt lds
    v_mfma_f32_16x16x32_bf16 v[148:151], a[116:119], a[232:235], v[148:151]
    s_waitcnt lgkmcnt(6)
    v_lshlrev_b32 v14, 16, v6
    v_mfma_f32_16x16x32_bf16 v[148:151], a[100:103], a[220:223], v[148:151]
    s_waitcnt vmcnt(8)
    ds_read_b64_tr_b16 a[40:41], v20 offset:0
    ds_read_b64_tr_b16 a[42:43], v20 offset:256
    v_mfma_f32_16x16x32_bf16 v[152:155], a[104:107], a[220:223], v[152:155]
    buffer_load_dwordx4 v16, s[12:15], s38 offen offset:2048 nt lds
    v_mfma_f32_16x16x32_bf16 v[152:155], a[120:123], a[232:235], v[152:155]
    s_add_u32 m0, s37, 45056
    ds_read_b64_tr_b16 a[44:45], v21 offset:0
    ds_read_b64_tr_b16 a[46:47], v21 offset:256
    v_mfma_f32_16x16x32_bf16 v[152:155], a[136:139], a[236:239], v[152:155]
    s_waitcnt lgkmcnt(7)
    v_lshlrev_b32 v15, 16, v10
    v_and_b32 v6, s34, v6
    v_mfma_f32_16x16x32_bf16 v[156:159], a[140:143], a[236:239], v[156:159]
    buffer_load_dwordx4 v17, s[12:15], s38 offen offset:0 nt lds
    v_mfma_f32_16x16x32_bf16 v[156:159], a[124:127], a[232:235], v[156:159]
    ds_read_b128 a[228:231], v1 offset:51200
    v_and_b32 v10, s34, v10
    v_mfma_f32_16x16x32_bf16 v[156:159], a[108:111], a[220:223], v[156:159]
    v_add_f32 v14, v14, v15
    v_add_f32 v6, v6, v10
    v_mfma_f32_16x16x32_bf16 v[32:35], a[144:147], a[244:247], v[32:35]
    buffer_load_dwordx4 v17, s[12:15], s38 offen offset:2048 nt lds
    v_mfma_f32_16x16x32_bf16 v[32:35], a[160:163], a[240:243], v[32:35]
    s_add_u32 m0, s37, 49152
    s_mov_b32 s38, 4352
    v_cvt_pk_bf16_f32 v6, v14, v6
    v_mfma_f32_16x16x32_bf16 v[32:35], a[176:179], a[248:251], v[32:35]
    v_lshlrev_b32 v14, 16, v7
    v_lshlrev_b32 v15, 16, v11
    v_mfma_f32_16x16x32_bf16 v[36:39], a[180:183], a[248:251], v[36:39]
    s_waitcnt vmcnt(9) lgkmcnt(5)
    ds_read_b64_tr_b16 a[56:57], v20 offset:8192
    ds_read_b64_tr_b16 a[58:59], v20 offset:8448
    v_mfma_f32_16x16x32_bf16 v[36:39], a[164:167], a[240:243], v[36:39]
    buffer_load_dwordx4 v17, s[12:15], s38 offen offset:0 nt lds
    v_mfma_f32_16x16x32_bf16 v[36:39], a[148:151], a[244:247], v[36:39]
    ds_read_b64_tr_b16 a[60:61], v21 offset:8192
    ds_read_b64_tr_b16 a[62:63], v21 offset:8448
    v_mfma_f32_16x16x32_bf16 v[40:43], a[152:155], a[244:247], v[40:43]
    v_and_b32 v7, s34, v7
    v_and_b32 v11, s34, v11
    v_mfma_f32_16x16x32_bf16 v[40:43], a[168:171], a[240:243], v[40:43]
    v_add_f32 v14, v14, v15
    v_add_f32 v7, v7, v11
    v_mfma_f32_16x16x32_bf16 v[40:43], a[184:187], a[248:251], v[40:43]
    v_cvt_pk_bf16_f32 v7, v14, v7
    v_lshlrev_b32 v14, 16, v8
    v_mfma_f32_16x16x32_bf16 v[44:47], a[188:191], a[248:251], v[44:47]
    v_lshlrev_b32 v15, 16, v12
    v_and_b32 v8, s34, v8
    v_mfma_f32_16x16x32_bf16 v[44:47], a[172:175], a[240:243], v[44:47]
    ds_read_b128 a[216:219], v1 offset:53248
    v_and_b32 v12, s34, v12
    v_mfma_f32_16x16x32_bf16 v[44:47], a[156:159], a[244:247], v[44:47]
    v_add_f32 v14, v14, v15
    v_add_f32 v8, v8, v12
    v_mfma_f32_16x16x32_bf16 v[60:63], a[156:159], a[240:243], v[60:63]
    v_cvt_pk_bf16_f32 v8, v14, v8
    v_lshlrev_b32 v14, 16, v9
    v_mfma_f32_16x16x32_bf16 v[60:63], a[172:175], a[248:251], v[60:63]
    v_lshlrev_b32 v15, 16, v13
    v_and_b32 v9, s34, v9
    v_mfma_f32_16x16x32_bf16 v[60:63], a[188:191], a[208:211], v[60:63]
    v_and_b32 v13, s34, v13
    v_add_f32 v14, v14, v15
    v_mfma_f32_16x16x32_bf16 v[56:59], a[184:187], a[208:211], v[56:59]
    v_add_f32 v9, v9, v13
    v_cvt_pk_bf16_f32 v9, v14, v9
    v_mfma_f32_16x16x32_bf16 v[56:59], a[168:171], a[248:251], v[56:59]
    ds_write_b128 v2, v[6:9] offset:4096
    v_mfma_f32_16x16x32_bf16 v[56:59], a[152:155], a[240:243], v[56:59]
    ds_read_b128 v[6:9], v2 offset:47104
    ds_read_b128 v[10:13], v2 offset:6144
    v_mfma_f32_16x16x32_bf16 v[52:55], a[148:151], a[240:243], v[52:55]
    v_mfma_f32_16x16x32_bf16 v[52:55], a[164:167], a[248:251], v[52:55]
    v_mfma_f32_16x16x32_bf16 v[52:55], a[180:183], a[208:211], v[52:55]
    v_mfma_f32_16x16x32_bf16 v[48:51], a[176:179], a[208:211], v[48:51]
    v_mfma_f32_16x16x32_bf16 v[48:51], a[160:163], a[248:251], v[48:51]
    ds_read_b128 a[212:215], v1 offset:55296
    v_mfma_f32_16x16x32_bf16 v[48:51], a[144:147], a[240:243], v[48:51]
    v_mfma_f32_16x16x32_bf16 v[64:67], a[144:147], a[248:251], v[64:67]
    v_mfma_f32_16x16x32_bf16 v[64:67], a[160:163], a[208:211], v[64:67]
    v_mfma_f32_16x16x32_bf16 v[64:67], a[176:179], a[252:255], v[64:67]
    v_mfma_f32_16x16x32_bf16 v[68:71], a[180:183], a[252:255], v[68:71]
    s_waitcnt lgkmcnt(2)
    v_lshlrev_b32 v14, 16, v6
    v_mfma_f32_16x16x32_bf16 v[68:71], a[164:167], a[208:211], v[68:71]
    s_waitcnt lgkmcnt(1)
    v_lshlrev_b32 v15, 16, v10
    v_and_b32 v6, s34, v6
    v_mfma_f32_16x16x32_bf16 v[68:71], a[148:151], a[248:251], v[68:71]
    v_and_b32 v10, s34, v10
    v_add_f32 v14, v14, v15
    v_mfma_f32_16x16x32_bf16 v[72:75], a[152:155], a[248:251], v[72:75]
    v_add_f32 v6, v6, v10
    v_cvt_pk_bf16_f32 v6, v14, v6
    v_mfma_f32_16x16x32_bf16 v[72:75], a[168:171], a[208:211], v[72:75]
    v_lshlrev_b32 v14, 16, v7
    v_lshlrev_b32 v15, 16, v11
    v_mfma_f32_16x16x32_bf16 v[72:75], a[184:187], a[252:255], v[72:75]
    v_and_b32 v7, s34, v7
    v_and_b32 v11, s34, v11
    v_mfma_f32_16x16x32_bf16 v[76:79], a[188:191], a[252:255], v[76:79]
    v_add_f32 v14, v14, v15
    v_add_f32 v7, v7, v11
    v_mfma_f32_16x16x32_bf16 v[76:79], a[172:175], a[208:211], v[76:79]
    ds_read_b128 a[224:227], v1 offset:57344
    v_cvt_pk_bf16_f32 v7, v14, v7
    v_mfma_f32_16x16x32_bf16 v[76:79], a[156:159], a[248:251], v[76:79]
    v_lshlrev_b32 v14, 16, v8
    v_lshlrev_b32 v15, 16, v12
    v_mfma_f32_16x16x32_bf16 v[92:95], a[156:159], a[208:211], v[92:95]
    v_and_b32 v8, s34, v8
    v_and_b32 v12, s34, v12
    v_mfma_f32_16x16x32_bf16 v[92:95], a[172:175], a[252:255], v[92:95]
    v_add_f32 v14, v14, v15
    v_add_f32 v8, v8, v12
    v_mfma_f32_16x16x32_bf16 v[92:95], a[188:191], a[228:231], v[92:95]
    v_cvt_pk_bf16_f32 v8, v14, v8
    v_lshlrev_b32 v14, 16, v9
    v_mfma_f32_16x16x32_bf16 v[88:91], a[184:187], a[228:231], v[88:91]
    v_lshlrev_b32 v15, 16, v13
    v_and_b32 v9, s34, v9
    v_mfma_f32_16x16x32_bf16 v[88:91], a[168:171], a[252:255], v[88:91]
    v_and_b32 v13, s34, v13
    v_add_f32 v14, v14, v15
    v_mfma_f32_16x16x32_bf16 v[88:91], a[152:155], a[208:211], v[88:91]
    v_add_f32 v9, v9, v13
    v_cvt_pk_bf16_f32 v9, v14, v9
    v_mfma_f32_16x16x32_bf16 v[84:87], a[148:151], a[208:211], v[84:87]
    ds_write_b128 v2, v[6:9] offset:6144
    v_mfma_f32_16x16x32_bf16 v[84:87], a[164:167], a[252:255], v[84:87]
    ds_read_b128 v[6:9], v2 offset:49152
    ds_read_b128 v[10:13], v2 offset:8192
    v_mfma_f32_16x16x32_bf16 v[84:87], a[180:183], a[228:231], v[84:87]
    v_mfma_f32_16x16x32_bf16 v[80:83], a[176:179], a[228:231], v[80:83]
    v_mfma_f32_16x16x32_bf16 v[80:83], a[160:163], a[252:255], v[80:83]
    ds_read_b128 a[236:239], v1 offset:59392
    v_mfma_f32_16x16x32_bf16 v[80:83], a[144:147], a[208:211], v[80:83]
    v_mfma_f32_16x16x32_bf16 v[96:99], a[144:147], a[252:255], v[96:99]
    v_mfma_f32_16x16x32_bf16 v[96:99], a[160:163], a[228:231], v[96:99]
    v_mfma_f32_16x16x32_bf16 v[96:99], a[176:179], a[216:219], v[96:99]
    v_mfma_f32_16x16x32_bf16 v[100:103], a[180:183], a[216:219], v[100:103]
    v_mfma_f32_16x16x32_bf16 v[100:103], a[164:167], a[228:231], v[100:103]
    v_mfma_f32_16x16x32_bf16 v[100:103], a[148:151], a[252:255], v[100:103]
    s_waitcnt lgkmcnt(2)
    v_lshlrev_b32 v14, 16, v6
    v_mfma_f32_16x16x32_bf16 v[104:107], a[152:155], a[252:255], v[104:107]
    s_waitcnt lgkmcnt(1)
    v_lshlrev_b32 v15, 16, v10
    v_and_b32 v6, s34, v6
    v_mfma_f32_16x16x32_bf16 v[104:107], a[168:171], a[228:231], v[104:107]
    v_and_b32 v10, s34, v10
    v_add_f32 v14, v14, v15
    v_mfma_f32_16x16x32_bf16 v[104:107], a[184:187], a[216:219], v[104:107]
    v_add_f32 v6, v6, v10
    v_cvt_pk_bf16_f32 v6, v14, v6
    v_mfma_f32_16x16x32_bf16 v[108:111], a[188:191], a[216:219], v[108:111]
    v_lshlrev_b32 v14, 16, v7
    v_lshlrev_b32 v15, 16, v11
    v_mfma_f32_16x16x32_bf16 v[108:111], a[172:175], a[228:231], v[108:111]
    v_and_b32 v7, s34, v7
    v_and_b32 v11, s34, v11
    v_mfma_f32_16x16x32_bf16 v[108:111], a[156:159], a[252:255], v[108:111]
    v_add_f32 v14, v14, v15
    v_add_f32 v7, v7, v11
    v_mfma_f32_16x16x32_bf16 v[124:127], a[156:159], a[228:231], v[124:127]
    v_cvt_pk_bf16_f32 v7, v14, v7
    v_lshlrev_b32 v14, 16, v8
    v_mfma_f32_16x16x32_bf16 v[124:127], a[172:175], a[216:219], v[124:127]
    v_lshlrev_b32 v15, 16, v12
    v_and_b32 v8, s34, v8
    v_mfma_f32_16x16x32_bf16 v[124:127], a[188:191], a[212:215], v[124:127]
    v_and_b32 v12, s34, v12
    v_add_f32 v14, v14, v15
    v_mfma_f32_16x16x32_bf16 v[120:123], a[184:187], a[212:215], v[120:123]
    v_add_f32 v8, v8, v12
    v_cvt_pk_bf16_f32 v8, v14, v8
    v_mfma_f32_16x16x32_bf16 v[120:123], a[168:171], a[216:219], v[120:123]
    v_lshlrev_b32 v14, 16, v9
    v_lshlrev_b32 v15, 16, v13
    v_mfma_f32_16x16x32_bf16 v[120:123], a[152:155], a[228:231], v[120:123]
    s_add_u32 m0, s36, 122880
    s_mov_b32 s38, 425984
    v_and_b32 v9, s34, v9
    v_mfma_f32_16x16x32_bf16 v[116:119], a[148:151], a[228:231], v[116:119]
    buffer_load_dwordx4 v18, s[16:19], s38 offen offset:0 lds
    v_mfma_f32_16x16x32_bf16 v[116:119], a[164:167], a[216:219], v[116:119]
    v_and_b32 v13, s34, v13
    v_add_f32 v14, v14, v15
    v_mfma_f32_16x16x32_bf16 v[116:119], a[180:183], a[212:215], v[116:119]
    v_add_f32 v9, v9, v13
    v_cvt_pk_bf16_f32 v9, v14, v9
    v_mfma_f32_16x16x32_bf16 v[112:115], a[176:179], a[212:215], v[112:115]
    ds_write_b128 v2, v[6:9] offset:8192
    v_mfma_f32_16x16x32_bf16 v[112:115], a[160:163], a[216:219], v[112:115]
    v_mfma_f32_16x16x32_bf16 v[112:115], a[144:147], a[228:231], v[112:115]
    buffer_load_dwordx4 v19, s[16:19], s38 offen offset:1024 lds
    v_mfma_f32_16x16x32_bf16 v[128:131], a[144:147], a[216:219], v[128:131]
    v_mfma_f32_16x16x32_bf16 v[128:131], a[160:163], a[212:215], v[128:131]
    v_mfma_f32_16x16x32_bf16 v[128:131], a[176:179], a[224:227], v[128:131]
    s_add_u32 m0, s36, 131072
    s_mov_b32 s38, 950272
    v_mfma_f32_16x16x32_bf16 v[132:135], a[180:183], a[224:227], v[132:135]
    v_mfma_f32_16x16x32_bf16 v[132:135], a[164:167], a[212:215], v[132:135]
    buffer_load_dwordx4 v18, s[16:19], s38 offen offset:0 lds
    v_mfma_f32_16x16x32_bf16 v[132:135], a[148:151], a[216:219], v[132:135]
    v_mfma_f32_16x16x32_bf16 v[136:139], a[152:155], a[216:219], v[136:139]
    v_mfma_f32_16x16x32_bf16 v[136:139], a[168:171], a[212:215], v[136:139]
    v_mfma_f32_16x16x32_bf16 v[136:139], a[184:187], a[224:227], v[136:139]
    s_waitcnt vmcnt(8) lgkmcnt(1)
    s_barrier
    v_add_u32 v0, 0x5000, v0
    v_mfma_f32_16x16x32_bf16 v[140:143], a[188:191], a[224:227], v[140:143]
    buffer_load_dwordx4 v19, s[16:19], s38 offen offset:1024 lds
    v_mfma_f32_16x16x32_bf16 v[140:143], a[172:175], a[212:215], v[140:143]
    v_add_u32 v1, 0x5000, v1
    v_mfma_f32_16x16x32_bf16 v[140:143], a[156:159], a[216:219], v[140:143]
    ds_read_b128 a[232:235], v0 offset:40960
    ds_read_b128 a[220:223], v0 offset:43008
    v_mfma_f32_16x16x32_bf16 v[144:147], a[144:147], a[212:215], v[144:147]
    s_add_u32 m0, s36, 139264
    ds_read_b128 a[244:247], v0 offset:45056
    ds_read_b128 a[240:243], v0 offset:47104
    v_mfma_f32_16x16x32_bf16 v[144:147], a[160:163], a[224:227], v[144:147]
    s_mov_b32 s38, 426496
    ds_read_b128 a[248:251], v0 offset:49152
    v_mfma_f32_16x16x32_bf16 v[144:147], a[176:179], a[236:239], v[144:147]
    buffer_load_dwordx4 v18, s[16:19], s38 offen offset:0 lds
    v_mfma_f32_16x16x32_bf16 v[148:151], a[180:183], a[236:239], v[148:151]
    v_mfma_f32_16x16x32_bf16 v[148:151], a[164:167], a[224:227], v[148:151]
    v_mfma_f32_16x16x32_bf16 v[148:151], a[148:151], a[212:215], v[148:151]
    ds_read_b128 a[208:211], v0 offset:51200
    v_mfma_f32_16x16x32_bf16 v[152:155], a[152:155], a[212:215], v[152:155]
    v_mfma_f32_16x16x32_bf16 v[152:155], a[168:171], a[224:227], v[152:155]
    buffer_load_dwordx4 v19, s[16:19], s38 offen offset:1024 lds
    v_mfma_f32_16x16x32_bf16 v[152:155], a[184:187], a[236:239], v[152:155]
    v_mfma_f32_16x16x32_bf16 v[156:159], a[188:191], a[236:239], v[156:159]
    v_mfma_f32_16x16x32_bf16 v[156:159], a[172:175], a[224:227], v[156:159]
    s_add_u32 m0, s36, 147456
    s_mov_b32 s38, 950784
    v_mfma_f32_16x16x32_bf16 v[156:159], a[156:159], a[212:215], v[156:159]
    s_waitcnt lgkmcnt(5)
    v_mfma_f32_16x16x32_bf16 v[160:163], a[32:35], a[232:235], v[160:163]
    s_waitcnt lgkmcnt(4)
    buffer_load_dwordx4 v18, s[16:19], s38 offen offset:0 lds
    v_mfma_f32_16x16x32_bf16 v[160:163], a[48:51], a[220:223], v[160:163]
    ds_read_b128 a[252:255], v0 offset:53248
    v_mfma_f32_16x16x32_bf16 v[164:167], a[52:55], a[220:223], v[164:167]
    v_mfma_f32_16x16x32_bf16 v[164:167], a[36:39], a[232:235], v[164:167]
    v_mfma_f32_16x16x32_bf16 v[168:171], a[40:43], a[232:235], v[168:171]
    v_mfma_f32_16x16x32_bf16 v[168:171], a[56:59], a[220:223], v[168:171]
    buffer_load_dwordx4 v19, s[16:19], s38 offen offset:1024 lds
    v_mfma_f32_16x16x32_bf16 v[172:175], a[60:63], a[220:223], v[172:175]
    v_mfma_f32_16x16x32_bf16 v[172:175], a[44:47], a[232:235], v[172:175]
    s_waitcnt vmcnt(6) lgkmcnt(1)
    ds_read_b64_tr_b16 a[64:65], v20 offset:20480
    ds_read_b64_tr_b16 a[66:67], v20 offset:20736
    v_mfma_f32_16x16x32_bf16 v[188:191], a[44:47], a[220:223], v[188:191]
    s_add_u32 m0, s36, 155648
    ds_read_b64_tr_b16 a[68:69], v21 offset:20480
    ds_read_b64_tr_b16 a[70:71], v21 offset:20736
    v_mfma_f32_16x16x32_bf16 v[188:191], a[60:63], a[244:247], v[188:191]
    s_mov_b32 s38, 131072
    ds_read_b128 a[228:231], v0 offset:55296
    v_mfma_f32_16x16x32_bf16 v[184:187], a[56:59], a[244:247], v[184:187]
    buffer_load_dwordx4 v18, s[16:19], s38 offen offset:0 lds
    v_mfma_f32_16x16x32_bf16 v[184:187], a[40:43], a[220:223], v[184:187]
    v_mfma_f32_16x16x32_bf16 v[180:183], a[36:39], a[220:223], v[180:183]
    v_mfma_f32_16x16x32_bf16 v[180:183], a[52:55], a[244:247], v[180:183]
    v_mfma_f32_16x16x32_bf16 v[176:179], a[48:51], a[244:247], v[176:179]
    v_mfma_f32_16x16x32_bf16 v[176:179], a[32:35], a[220:223], v[176:179]
    buffer_load_dwordx4 v19, s[16:19], s38 offen offset:1024 lds
    v_mfma_f32_16x16x32_bf16 v[192:195], a[32:35], a[244:247], v[192:195]
    v_mfma_f32_16x16x32_bf16 v[192:195], a[48:51], a[240:243], v[192:195]
    s_waitcnt vmcnt(6) lgkmcnt(5)
    ds_read_b64_tr_b16 a[80:81], v20 offset:28672
    ds_read_b64_tr_b16 a[82:83], v20 offset:28928
    v_mfma_f32_16x16x32_bf16 v[196:199], a[52:55], a[240:243], v[196:199]
    s_add_u32 m0, s36, 122880
    ds_read_b64_tr_b16 a[84:85], v21 offset:28672
    ds_read_b64_tr_b16 a[86:87], v21 offset:28928
    v_mfma_f32_16x16x32_bf16 v[196:199], a[36:39], a[244:247], v[196:199]
    s_mov_b32 s38, 655360
    ds_read_b128 a[216:219], v0 offset:57344
    v_mfma_f32_16x16x32_bf16 v[200:203], a[40:43], a[244:247], v[200:203]
    s_waitcnt lgkmcnt(6)
    buffer_load_dwordx4 v18, s[16:19], s38 offen offset:0 lds
    v_mfma_f32_16x16x32_bf16 v[200:203], a[56:59], a[240:243], v[200:203]
    v_mfma_f32_16x16x32_bf16 v[204:207], a[60:63], a[240:243], v[204:207]
    v_mfma_f32_16x16x32_bf16 v[204:207], a[44:47], a[244:247], v[204:207]
    v_mfma_f32_16x16x32_bf16 v[220:223], a[44:47], a[240:243], v[220:223]
    ds_read_b128 a[236:239], v1 offset:40960
    v_mfma_f32_16x16x32_bf16 v[220:223], a[60:63], a[248:251], v[220:223]
    buffer_load_dwordx4 v19, s[16:19], s38 offen offset:1024 lds
    v_mfma_f32_16x16x32_bf16 v[216:219], a[56:59], a[248:251], v[216:219]
    ds_read_b128 a[224:227], v1 offset:43008
    v_mfma_f32_16x16x32_bf16 v[216:219], a[40:43], a[240:243], v[216:219]
    s_waitcnt vmcnt(6) lgkmcnt(7)
    ds_read_b64_tr_b16 a[72:73], v20 offset:36864
    ds_read_b64_tr_b16 a[74:75], v20 offset:37120
    v_mfma_f32_16x16x32_bf16 v[212:215], a[36:39], a[240:243], v[212:215]
    s_add_u32 m0, s36, 131072
    ds_read_b64_tr_b16 a[76:77], v21 offset:36864
    ds_read_b64_tr_b16 a[78:79], v21 offset:37120
    v_mfma_f32_16x16x32_bf16 v[212:215], a[52:55], a[248:251], v[212:215]
    s_mov_b32 s38, 1179648
    v_mfma_f32_16x16x32_bf16 v[208:211], a[48:51], a[248:251], v[208:211]
    s_waitcnt lgkmcnt(7)
    buffer_load_dwordx4 v18, s[16:19], s38 offen offset:0 lds
    v_mfma_f32_16x16x32_bf16 v[208:211], a[32:35], a[240:243], v[208:211]
    v_mfma_f32_16x16x32_bf16 v[224:227], a[32:35], a[248:251], v[224:227]
    v_mfma_f32_16x16x32_bf16 v[224:227], a[48:51], a[208:211], v[224:227]
    ds_read_b128 a[212:215], v1 offset:45056
    v_mfma_f32_16x16x32_bf16 v[228:231], a[52:55], a[208:211], v[228:231]
    v_mfma_f32_16x16x32_bf16 v[228:231], a[36:39], a[248:251], v[228:231]
    buffer_load_dwordx4 v19, s[16:19], s38 offen offset:1024 lds
    v_mfma_f32_16x16x32_bf16 v[232:235], a[40:43], a[248:251], v[232:235]
    v_mfma_f32_16x16x32_bf16 v[232:235], a[56:59], a[208:211], v[232:235]
    s_waitcnt vmcnt(6) lgkmcnt(6)
    ds_read_b64_tr_b16 a[88:89], v20 offset:45056
    ds_read_b64_tr_b16 a[90:91], v20 offset:45312
    v_mfma_f32_16x16x32_bf16 v[236:239], a[60:63], a[208:211], v[236:239]
    s_add_u32 m0, s36, 139264
    ds_read_b64_tr_b16 a[92:93], v21 offset:45056
    ds_read_b64_tr_b16 a[94:95], v21 offset:45312
    v_mfma_f32_16x16x32_bf16 v[236:239], a[44:47], a[248:251], v[236:239]
    s_mov_b32 s38, 131584
    v_mfma_f32_16x16x32_bf16 v[252:255], a[44:47], a[208:211], v[252:255]
    s_waitcnt lgkmcnt(5)
    buffer_load_dwordx4 v18, s[16:19], s38 offen offset:0 lds
    v_mfma_f32_16x16x32_bf16 v[252:255], a[60:63], a[252:255], v[252:255]
    ds_read_b128 a[232:235], v1 offset:47104
    v_mfma_f32_16x16x32_bf16 v[248:251], a[56:59], a[252:255], v[248:251]
    v_mfma_f32_16x16x32_bf16 v[248:251], a[40:43], a[208:211], v[248:251]
    v_mfma_f32_16x16x32_bf16 v[244:247], a[36:39], a[208:211], v[244:247]
    v_mfma_f32_16x16x32_bf16 v[244:247], a[52:55], a[252:255], v[244:247]
    buffer_load_dwordx4 v19, s[16:19], s38 offen offset:1024 lds
    v_mfma_f32_16x16x32_bf16 v[240:243], a[48:51], a[252:255], v[240:243]
    v_mfma_f32_16x16x32_bf16 v[240:243], a[32:35], a[208:211], v[240:243]
    s_waitcnt vmcnt(6) lgkmcnt(5)
    ds_read_b64_tr_b16 a[96:97], v20 offset:53248
    ds_read_b64_tr_b16 a[98:99], v20 offset:53504
    v_mfma_f32_16x16x32_bf16 a[0:3], a[32:35], a[252:255], a[0:3]
    s_add_u32 m0, s36, 147456
    ds_read_b64_tr_b16 a[100:101], v21 offset:53248
    ds_read_b64_tr_b16 a[102:103], v21 offset:53504
    v_mfma_f32_16x16x32_bf16 a[0:3], a[48:51], a[228:231], a[0:3]
    s_mov_b32 s38, 655872
    ds_read_b128 a[220:223], v1 offset:49152
    v_mfma_f32_16x16x32_bf16 a[4:7], a[52:55], a[228:231], a[4:7]
    s_waitcnt lgkmcnt(6)
    buffer_load_dwordx4 v18, s[16:19], s38 offen offset:0 lds
    v_mfma_f32_16x16x32_bf16 a[4:7], a[36:39], a[252:255], a[4:7]
    v_mfma_f32_16x16x32_bf16 a[8:11], a[40:43], a[252:255], a[8:11]
    v_mfma_f32_16x16x32_bf16 a[8:11], a[56:59], a[228:231], a[8:11]
    v_mfma_f32_16x16x32_bf16 a[12:15], a[60:63], a[228:231], a[12:15]
    v_mfma_f32_16x16x32_bf16 a[12:15], a[44:47], a[252:255], a[12:15]
    buffer_load_dwordx4 v19, s[16:19], s38 offen offset:1024 lds
    v_mfma_f32_16x16x32_bf16 a[16:19], a[32:35], a[228:231], a[16:19]
    v_mfma_f32_16x16x32_bf16 a[16:19], a[48:51], a[216:219], a[16:19]
    s_waitcnt vmcnt(6) lgkmcnt(5)
    ds_read_b64_tr_b16 a[112:113], v20 offset:20480
    ds_read_b64_tr_b16 a[114:115], v20 offset:20736
    v_mfma_f32_16x16x32_bf16 a[20:23], a[52:55], a[216:219], a[20:23]
    s_add_u32 m0, s36, 155648
    ds_read_b64_tr_b16 a[116:117], v21 offset:20480
    ds_read_b64_tr_b16 a[118:119], v21 offset:20736
    v_mfma_f32_16x16x32_bf16 a[20:23], a[36:39], a[228:231], a[20:23]
    s_mov_b32 s38, 1180160
    ds_read_b128 a[244:247], v1 offset:51200
    v_mfma_f32_16x16x32_bf16 a[24:27], a[40:43], a[228:231], a[24:27]
    s_waitcnt lgkmcnt(6)
    buffer_load_dwordx4 v18, s[16:19], s38 offen offset:0 lds
    v_mfma_f32_16x16x32_bf16 a[24:27], a[56:59], a[216:219], a[24:27]
    v_mfma_f32_16x16x32_bf16 a[28:31], a[60:63], a[216:219], a[28:31]
    v_mfma_f32_16x16x32_bf16 a[28:31], a[44:47], a[228:231], a[28:31]
    v_mfma_f32_16x16x32_bf16 v[160:163], a[64:67], a[236:239], v[160:163]
    v_mfma_f32_16x16x32_bf16 v[160:163], a[80:83], a[224:227], v[160:163]
    buffer_load_dwordx4 v19, s[16:19], s38 offen offset:1024 lds
    v_mfma_f32_16x16x32_bf16 v[164:167], a[84:87], a[224:227], v[164:167]
    ds_read_b128 a[240:243], v1 offset:53248
    v_mfma_f32_16x16x32_bf16 v[164:167], a[68:71], a[236:239], v[164:167]
    s_waitcnt vmcnt(6) lgkmcnt(6)
    ds_read_b64_tr_b16 a[128:129], v20 offset:28672
    ds_read_b64_tr_b16 a[130:131], v20 offset:28928
    v_mfma_f32_16x16x32_bf16 v[168:171], a[72:75], a[236:239], v[168:171]
    buffer_load_dword a204, off, s[48:51], 0 offset:0 sc1
    v_mfma_f32_16x16x32_bf16 v[168:171], a[88:91], a[224:227], v[168:171]
    ds_read_b64_tr_b16 a[132:133], v21 offset:28672
    ds_read_b64_tr_b16 a[134:135], v21 offset:28928
    v_mfma_f32_16x16x32_bf16 v[172:175], a[92:95], a[224:227], v[172:175]
    v_mfma_f32_16x16x32_bf16 v[172:175], a[76:79], a[236:239], v[172:175]
    s_add_u32 m0, s36, 122880
    v_mfma_f32_16x16x32_bf16 v[188:191], a[76:79], a[224:227], v[188:191]
    s_mov_b32 s38, 163840
    v_mfma_f32_16x16x32_bf16 v[188:191], a[92:95], a[212:215], v[188:191]
    s_waitcnt lgkmcnt(5)
    buffer_load_dwordx4 v18, s[16:19], s38 offen offset:0 lds
    v_mfma_f32_16x16x32_bf16 v[184:187], a[88:91], a[212:215], v[184:187]
    ds_read_b128 a[248:251], v1 offset:55296
    v_mfma_f32_16x16x32_bf16 v[184:187], a[72:75], a[224:227], v[184:187]
    v_mfma_f32_16x16x32_bf16 v[180:183], a[68:71], a[224:227], v[180:183]
    v_mfma_f32_16x16x32_bf16 v[180:183], a[84:87], a[212:215], v[180:183]
    s_waitcnt vmcnt(6)
    ds_read_b64_tr_b16 a[104:105], v20 offset:36864
    ds_read_b64_tr_b16 a[106:107], v20 offset:37120
    v_mfma_f32_16x16x32_bf16 v[176:179], a[80:83], a[212:215], v[176:179]
    buffer_load_dwordx4 v19, s[16:19], s38 offen offset:1024 lds
    v_mfma_f32_16x16x32_bf16 v[176:179], a[64:67], a[224:227], v[176:179]
    ds_read_b64_tr_b16 a[108:109], v21 offset:36864
    ds_read_b64_tr_b16 a[110:111], v21 offset:37120
    v_mfma_f32_16x16x32_bf16 v[192:195], a[64:67], a[212:215], v[192:195]
    v_mfma_f32_16x16x32_bf16 v[192:195], a[80:83], a[232:235], v[192:195]
    s_add_u32 m0, s36, 131072
    ds_read_b128 a[208:211], v1 offset:57344
    s_mov_b32 s38, 688128
    v_mfma_f32_16x16x32_bf16 v[196:199], a[84:87], a[232:235], v[196:199]
    v_mfma_f32_16x16x32_bf16 v[196:199], a[68:71], a[212:215], v[196:199]
    s_waitcnt lgkmcnt(6)
    buffer_load_dwordx4 v18, s[16:19], s38 offen offset:0 lds
    v_mfma_f32_16x16x32_bf16 v[200:203], a[72:75], a[212:215], v[200:203]
    v_mfma_f32_16x16x32_bf16 v[200:203], a[88:91], a[232:235], v[200:203]
    v_mfma_f32_16x16x32_bf16 v[204:207], a[92:95], a[232:235], v[204:207]
    v_mfma_f32_16x16x32_bf16 v[204:207], a[76:79], a[212:215], v[204:207]
    s_waitcnt vmcnt(6) lgkmcnt(5)
    ds_read_b64_tr_b16 a[120:121], v20 offset:45056
    ds_read_b64_tr_b16 a[122:123], v20 offset:45312
    v_mfma_f32_16x16x32_bf16 v[220:223], a[76:79], a[232:235], v[220:223]
    buffer_load_dwordx4 v19, s[16:19], s38 offen offset:1024 lds
    v_mfma_f32_16x16x32_bf16 v[220:223], a[92:95], a[220:223], v[220:223]
    ds_read_b64_tr_b16 a[124:125], v21 offset:45056
    ds_read_b64_tr_b16 a[126:127], v21 offset:45312
    v_mfma_f32_16x16x32_bf16 v[216:219], a[88:91], a[220:223], v[216:219]
    v_mfma_f32_16x16x32_bf16 v[216:219], a[72:75], a[232:235], v[216:219]
    s_add_u32 m0, s36, 139264
    s_mov_b32 s38, 1212416
    v_mfma_f32_16x16x32_bf16 v[212:215], a[68:71], a[232:235], v[212:215]
    v_mfma_f32_16x16x32_bf16 v[212:215], a[84:87], a[220:223], v[212:215]
    s_waitcnt lgkmcnt(5)
    buffer_load_dwordx4 v18, s[16:19], s38 offen offset:0 lds
    v_mfma_f32_16x16x32_bf16 v[208:211], a[80:83], a[220:223], v[208:211]
    v_mfma_f32_16x16x32_bf16 v[208:211], a[64:67], a[232:235], v[208:211]
    v_mfma_f32_16x16x32_bf16 v[224:227], a[64:67], a[220:223], v[224:227]
    v_mfma_f32_16x16x32_bf16 v[224:227], a[80:83], a[244:247], v[224:227]
    s_waitcnt vmcnt(6) lgkmcnt(4)
    ds_read_b64_tr_b16 a[136:137], v20 offset:53248
    ds_read_b64_tr_b16 a[138:139], v20 offset:53504
    v_mfma_f32_16x16x32_bf16 v[228:231], a[84:87], a[244:247], v[228:231]
    buffer_load_dwordx4 v19, s[16:19], s38 offen offset:1024 lds
    v_mfma_f32_16x16x32_bf16 v[228:231], a[68:71], a[220:223], v[228:231]
    ds_read_b64_tr_b16 a[140:141], v21 offset:53248
    ds_read_b64_tr_b16 a[142:143], v21 offset:53504
    v_mfma_f32_16x16x32_bf16 v[232:235], a[72:75], a[220:223], v[232:235]
    v_mfma_f32_16x16x32_bf16 v[232:235], a[88:91], a[244:247], v[232:235]
    s_add_u32 m0, s36, 147456
    s_mov_b32 s38, 164352
    v_mfma_f32_16x16x32_bf16 v[236:239], a[92:95], a[244:247], v[236:239]
    v_mfma_f32_16x16x32_bf16 v[236:239], a[76:79], a[220:223], v[236:239]
    s_waitcnt lgkmcnt(4)
    buffer_load_dwordx4 v18, s[16:19], s38 offen offset:0 lds
    v_mfma_f32_16x16x32_bf16 v[252:255], a[76:79], a[244:247], v[252:255]
    v_mfma_f32_16x16x32_bf16 v[252:255], a[92:95], a[240:243], v[252:255]
    v_mfma_f32_16x16x32_bf16 v[248:251], a[88:91], a[240:243], v[248:251]
    v_mfma_f32_16x16x32_bf16 v[248:251], a[72:75], a[244:247], v[248:251]
    v_mfma_f32_16x16x32_bf16 v[244:247], a[68:71], a[244:247], v[244:247]
    buffer_load_dwordx4 v19, s[16:19], s38 offen offset:1024 lds
    v_mfma_f32_16x16x32_bf16 v[244:247], a[84:87], a[240:243], v[244:247]
    v_mfma_f32_16x16x32_bf16 v[240:243], a[80:83], a[240:243], v[240:243]
    s_barrier
    s_waitcnt vmcnt(6) lgkmcnt(2)
    ds_read_b64_tr_b16 a[144:145], v20 offset:20480
    v_mfma_f32_16x16x32_bf16 v[240:243], a[64:67], a[244:247], v[240:243]
    s_add_u32 m0, s36, 155648
    ds_read_b64_tr_b16 a[146:147], v20 offset:20736
    ds_read_b64_tr_b16 a[148:149], v21 offset:20480
    v_mfma_f32_16x16x32_bf16 a[0:3], a[64:67], a[240:243], a[0:3]
    s_mov_b32 s38, 688640
    ds_read_b64_tr_b16 a[150:151], v21 offset:20736
    ds_read_b128 a[252:255], v0 offset:0
    v_mfma_f32_16x16x32_bf16 a[0:3], a[80:83], a[248:251], a[0:3]
    s_waitcnt lgkmcnt(5)
    buffer_load_dwordx4 v18, s[16:19], s38 offen offset:0 lds
    v_mfma_f32_16x16x32_bf16 a[4:7], a[84:87], a[248:251], a[4:7]
    ds_read_b128 a[216:219], v0 offset:2048
    ds_read_b128 a[228:231], v0 offset:4096
    v_mfma_f32_16x16x32_bf16 a[4:7], a[68:71], a[240:243], a[4:7]
    ds_read_b128 a[236:239], v0 offset:6144
    ds_read_b128 a[224:227], v0 offset:8192
    v_mfma_f32_16x16x32_bf16 a[8:11], a[72:75], a[240:243], a[8:11]
    v_mfma_f32_16x16x32_bf16 a[8:11], a[88:91], a[248:251], a[8:11]
    v_mfma_f32_16x16x32_bf16 a[12:15], a[92:95], a[248:251], a[12:15]
    buffer_load_dwordx4 v19, s[16:19], s38 offen offset:1024 lds
    v_mfma_f32_16x16x32_bf16 a[12:15], a[76:79], a[240:243], a[12:15]
    v_accvgpr_read_b32 v15, a204
    v_cmp_gt_u32 vcc, 4, v15
    v_mfma_f32_16x16x32_bf16 a[16:19], a[64:67], a[248:251], a[16:19]
    s_nop 0
    s_waitcnt vmcnt(6)
    ds_read_b64_tr_b16 a[160:161], v20 offset:28672
    v_mfma_f32_16x16x32_bf16 a[16:19], a[80:83], a[208:211], a[16:19]
    s_add_u32 m0, s36, 122880
    ds_read_b64_tr_b16 a[162:163], v20 offset:28928
    ds_read_b64_tr_b16 a[164:165], v21 offset:28672
    v_mfma_f32_16x16x32_bf16 a[20:23], a[84:87], a[208:211], a[20:23]
    s_mov_b32 s38, 1212928
    ds_read_b64_tr_b16 a[166:167], v21 offset:28928
    s_nop 0
    v_mfma_f32_16x16x32_bf16 a[20:23], a[68:71], a[248:251], a[20:23]
    s_cbranch_vccnz L_spin0
L_back0:
    v_mfma_f32_16x16x32_bf16 a[24:27], a[72:75], a[248:251], a[24:27]
    s_waitcnt lgkmcnt(9)
    buffer_load_dwordx4 v18, s[16:19], s38 offen offset:0 lds
    v_mfma_f32_16x16x32_bf16 a[24:27], a[88:91], a[208:211], a[24:27]
    v_mfma_f32_16x16x32_bf16 a[28:31], a[92:95], a[208:211], a[28:31]
    ds_read_b128 a[212:215], v0 offset:10240
    v_mfma_f32_16x16x32_bf16 a[28:31], a[76:79], a[248:251], a[28:31]
    s_waitcnt lgkmcnt(7)
    v_mfma_f32_16x16x32_bf16 v[32:35], a[96:99], a[252:255], v[32:35]
    buffer_load_dwordx4 v19, s[16:19], s38 offen offset:1024 lds
    v_mfma_f32_16x16x32_bf16 v[32:35], a[112:115], a[216:219], v[32:35]
    v_add_u32 v2, 20480, v2
    v_mfma_f32_16x16x32_bf16 v[32:35], a[128:131], a[228:231], v[32:35]
    s_waitcnt vmcnt(6) lgkmcnt(5)
    ds_read_b64_tr_b16 a[176:177], v20 offset:36864
    ds_read_b64_tr_b16 a[178:179], v20 offset:37120
    v_mfma_f32_16x16x32_bf16 v[36:39], a[132:135], a[228:231], v[36:39]
    s_mov_b32 s43, 1146880
    ds_read_b64_tr_b16 a[180:181], v21 offset:36864
    ds_read_b64_tr_b16 a[182:183], v21 offset:37120
    v_mfma_f32_16x16x32_bf16 v[36:39], a[116:119], a[216:219], v[36:39]
    ds_read_b128 v[6:9], v2 offset:0
    ds_read_b128 v[10:13], v2 offset:40960
    v_mfma_f32_16x16x32_bf16 v[36:39], a[100:103], a[252:255], v[36:39]
    buffer_load_dwordx4 a[32:35], v3, s[44:47], s43 offen offset:0 sc1
    v_mfma_f32_16x16x32_bf16 v[40:43], a[104:107], a[252:255], v[40:43]
    v_mfma_f32_16x16x32_bf16 v[40:43], a[120:123], a[216:219], v[40:43]
    v_mfma_f32_16x16x32_bf16 v[40:43], a[136:139], a[228:231], v[40:43]
    v_mfma_f32_16x16x32_bf16 v[44:47], a[140:143], a[228:231], v[44:47]
    v_mfma_f32_16x16x32_bf16 v[44:47], a[124:127], a[216:219], v[44:47]
    buffer_load_dwordx4 a[36:39], v3, s[44:47], s43 offen offset:1024 sc1
    v_mfma_f32_16x16x32_bf16 v[44:47], a[108:111], a[252:255], v[44:47]
    ds_read_b128 a[232:235], v0 offset:12288
    v_mfma_f32_16x16x32_bf16 v[60:63], a[108:111], a[216:219], v[60:63]
    s_waitcnt vmcnt(6) lgkmcnt(7)
    ds_read_b64_tr_b16 a[152:153], v20 offset:45056
    ds_read_b64_tr_b16 a[154:155], v20 offset:45312
    v_mfma_f32_16x16x32_bf16 v[60:63], a[124:127], a[228:231], v[60:63]
    ds_read_b64_tr_b16 a[156:157], v21 offset:45056
    ds_read_b64_tr_b16 a[158:159], v21 offset:45312
    v_mfma_f32_16x16x32_bf16 v[60:63], a[140:143], a[236:239], v[60:63]
    s_waitcnt lgkmcnt(6)
    v_lshlrev_b32 v14, 16, v6
    v_mfma_f32_16x16x32_bf16 v[56:59], a[136:139], a[236:239], v[56:59]
    buffer_load_dwordx4 a[40:43], v3, s[44:47], s43 offen offset:2048 sc1
    v_mfma_f32_16x16x32_bf16 v[56:59], a[120:123], a[228:231], v[56:59]
    s_waitcnt lgkmcnt(5)
    v_lshlrev_b32 v15, 16, v10
    v_and_b32 v6, s34, v6
    v_mfma_f32_16x16x32_bf16 v[56:59], a[104:107], a[216:219], v[56:59]
    v_and_b32 v10, s34, v10
    v_add_f32 v14, v14, v15
    v_mfma_f32_16x16x32_bf16 v[52:55], a[100:103], a[216:219], v[52:55]
    v_add_f32 v6, v6, v10
    v_cvt_pk_bf16_f32 v6, v14, v6
    v_mfma_f32_16x16x32_bf16 v[52:55], a[116:119], a[228:231], v[52:55]
    v_lshlrev_b32 v14, 16, v7
    v_lshlrev_b32 v15, 16, v11
    v_mfma_f32_16x16x32_bf16 v[52:55], a[132:135], a[236:239], v[52:55]
    buffer_load_dwordx4 a[44:47], v3, s[44:47], s43 offen offset:3072 sc1
    v_mfma_f32_16x16x32_bf16 v[48:51], a[128:131], a[236:239], v[48:51]
    v_and_b32 v7, s34, v7
    v_and_b32 v11, s34, v11
    v_mfma_f32_16x16x32_bf16 v[48:51], a[112:115], a[228:231], v[48:51]
    s_waitcnt vmcnt(6)
    ds_read_b64_tr_b16 a[168:169], v20 offset:53248
    ds_read_b64_tr_b16 a[170:171], v20 offset:53504
    v_mfma_f32_16x16x32_bf16 v[48:51], a[96:99], a[216:219], v[48:51]
    ds_read_b64_tr_b16 a[172:173], v21 offset:53248
    ds_read_b64_tr_b16 a[174:175], v21 offset:53504
    v_mfma_f32_16x16x32_bf16 v[64:67], a[96:99], a[228:231], v[64:67]
    s_add_u32 m0, s37, 102400
    ds_read_b128 a[220:223], v0 offset:14336
    s_mov_b32 s38, 1408
    v_mfma_f32_16x16x32_bf16 v[64:67], a[112:115], a[236:239], v[64:67]
    buffer_load_dwordx4 v16, s[12:15], s38 offen offset:0 nt lds
    v_mfma_f32_16x16x32_bf16 v[64:67], a[128:131], a[224:227], v[64:67]
    v_add_f32 v14, v14, v15
    v_add_f32 v7, v7, v11
    v_mfma_f32_16x16x32_bf16 v[68:71], a[132:135], a[224:227], v[68:71]
    v_cvt_pk_bf16_f32 v7, v14, v7
    v_lshlrev_b32 v14, 16, v8
    v_mfma_f32_16x16x32_bf16 v[68:71], a[116:119], a[236:239], v[68:71]
    buffer_load_dwordx4 v16, s[12:15], s38 offen offset:2048 nt lds
    v_mfma_f32_16x16x32_bf16 v[68:71], a[100:103], a[228:231], v[68:71]
    s_add_u32 m0, s37, 106496
    v_lshlrev_b32 v15, 16, v12
    v_and_b32 v8, s34, v8
    v_mfma_f32_16x16x32_bf16 v[72:75], a[104:107], a[228:231], v[72:75]
    v_and_b32 v12, s34, v12
    v_add_f32 v14, v14, v15
    v_mfma_f32_16x16x32_bf16 v[72:75], a[120:123], a[236:239], v[72:75]
    buffer_load_dwordx4 v17, s[12:15], s38 offen offset:0 nt lds
    v_mfma_f32_16x16x32_bf16 v[72:75], a[136:139], a[224:227], v[72:75]
    s_waitcnt vmcnt(7) lgkmcnt(5)
    ds_read_b64_tr_b16 a[184:185], v20 offset:20480
    ds_read_b64_tr_b16 a[186:187], v20 offset:20736
    v_mfma_f32_16x16x32_bf16 v[76:79], a[140:143], a[224:227], v[76:79]
    ds_read_b64_tr_b16 a[188:189], v21 offset:20480
    ds_read_b64_tr_b16 a[190:191], v21 offset:20736
    v_mfma_f32_16x16x32_bf16 v[76:79], a[124:127], a[236:239], v[76:79]
    buffer_load_dwordx4 v17, s[12:15], s38 offen offset:2048 nt lds
    v_mfma_f32_16x16x32_bf16 v[76:79], a[108:111], a[228:231], v[76:79]
    s_add_u32 m0, s37, 110592
    ds_read_b128 a[244:247], v0 offset:16384
    s_mov_b32 s38, 5504
    v_mfma_f32_16x16x32_bf16 v[92:95], a[108:111], a[236:239], v[92:95]
    v_add_f32 v8, v8, v12
    v_cvt_pk_bf16_f32 v8, v14, v8
    v_mfma_f32_16x16x32_bf16 v[92:95], a[124:127], a[224:227], v[92:95]
    buffer_load_dwordx4 v17, s[12:15], s38 offen offset:0 nt lds
    v_mfma_f32_16x16x32_bf16 v[92:95], a[140:143], a[212:215], v[92:95]
    s_add_u32 m0, s37, 61440
    s_mov_b32 s38, 384
    v_lshlrev_b32 v14, 16, v9
    v_mfma_f32_16x16x32_bf16 v[88:91], a[136:139], a[212:215], v[88:91]
    v_lshlrev_b32 v15, 16, v13
    v_and_b32 v9, s34, v9
    v_mfma_f32_16x16x32_bf16 v[88:91], a[120:123], a[224:227], v[88:91]
    buffer_load_dwordx4 v16, s[12:15], s38 offen offset:0 nt lds
    v_mfma_f32_16x16x32_bf16 v[88:91], a[104:107], a[236:239], v[88:91]
    v_and_b32 v13, s34, v13
    v_add_f32 v14, v14, v15
    v_mfma_f32_16x16x32_bf16 v[84:87], a[100:103], a[236:239], v[84:87]
    v_add_f32 v9, v9, v13
    v_cvt_pk_bf16_f32 v9, v14, v9
    v_mfma_f32_16x16x32_bf16 v[84:87], a[116:119], a[224:227], v[84:87]
    buffer_load_dwordx4 v16, s[12:15], s38 offen offset:2048 nt lds
    v_mfma_f32_16x16x32_bf16 v[84:87], a[132:135], a[212:215], v[84:87]
    s_add_u32 m0, s37, 65536
    ds_write_b128 v2, v[6:9] offset:40960
    v_mfma_f32_16x16x32_bf16 v[80:83], a[128:131], a[212:215], v[80:83]
    ds_read_b128 v[6:9], v2 offset:2048
    ds_read_b128 v[10:13], v2 offset:43008
    v_mfma_f32_16x16x32_bf16 v[80:83], a[112:115], a[224:227], v[80:83]
    buffer_load_dwordx4 v17, s[12:15], s38 offen offset:0 nt lds
    v_mfma_f32_16x16x32_bf16 v[80:83], a[96:99], a[236:239], v[80:83]
    ds_read_b128 a[240:243], v0 offset:18432
    v_mfma_f32_16x16x32_bf16 v[96:99], a[96:99], a[224:227], v[96:99]
    v_mfma_f32_16x16x32_bf16 v[96:99], a[112:115], a[212:215], v[96:99]
    buffer_load_dwordx4 v17, s[12:15], s38 offen offset:2048 nt lds
    v_mfma_f32_16x16x32_bf16 v[96:99], a[128:131], a[232:235], v[96:99]
    s_add_u32 m0, s37, 69632
    s_mov_b32 s38, 4480
    v_mfma_f32_16x16x32_bf16 v[100:103], a[132:135], a[232:235], v[100:103]
    v_mfma_f32_16x16x32_bf16 v[100:103], a[116:119], a[212:215], v[100:103]
    buffer_load_dwordx4 v17, s[12:15], s38 offen offset:0 nt lds
    v_mfma_f32_16x16x32_bf16 v[100:103], a[100:103], a[224:227], v[100:103]
    v_mfma_f32_16x16x32_bf16 v[104:107], a[104:107], a[224:227], v[104:107]
    v_mfma_f32_16x16x32_bf16 v[104:107], a[120:123], a[212:215], v[104:107]
    s_waitcnt lgkmcnt(2)
    v_lshlrev_b32 v14, 16, v6
    v_mfma_f32_16x16x32_bf16 v[104:107], a[136:139], a[232:235], v[104:107]
    ds_read_b128 a[208:211], v1 offset:0
    v_mfma_f32_16x16x32_bf16 v[108:111], a[140:143], a[232:235], v[108:111]
    ds_read_b128 a[248:251], v1 offset:2048
    v_mfma_f32_16x16x32_bf16 v[108:111], a[124:127], a[212:215], v[108:111]
    ds_read_b128 a[252:255], v1 offset:4096
    v_mfma_f32_16x16x32_bf16 v[108:111], a[108:111], a[224:227], v[108:111]
    s_waitcnt lgkmcnt(4)
    v_lshlrev_b32 v15, 16, v10
    v_and_b32 v6, s34, v6
    v_mfma_f32_16x16x32_bf16 v[124:127], a[108:111], a[212:215], v[124:127]
    v_and_b32 v10, s34, v10
    v_add_f32 v14, v14, v15
    v_mfma_f32_16x16x32_bf16 v[124:127], a[124:127], a[232:235], v[124:127]
    v_add_f32 v6, v6, v10
    v_cvt_pk_bf16_f32 v6, v14, v6
    v_mfma_f32_16x16x32_bf16 v[124:127], a[140:143], a[220:223], v[124:127]
    v_lshlrev_b32 v14, 16, v7
    v_lshlrev_b32 v15, 16, v11
    v_mfma_f32_16x16x32_bf16 v[120:123], a[136:139], a[220:223], v[120:123]
    v_and_b32 v7, s34, v7
    v_and_b32 v11, s34, v11
    v_mfma_f32_16x16x32_bf16 v[120:123], a[120:123], a[232:235], v[120:123]
    v_add_f32 v14, v14, v15
    v_add_f32 v7, v7, v11
    v_mfma_f32_16x16x32_bf16 v[120:123], a[104:107], a[212:215], v[120:123]
    v_cvt_pk_bf16_f32 v7, v14, v7
    v_lshlrev_b32 v14, 16, v8
    v_mfma_f32_16x16x32_bf16 v[116:119], a[100:103], a[212:215], v[116:119]
    v_lshlrev_b32 v15, 16, v12
    v_and_b32 v8, s34, v8
    v_mfma_f32_16x16x32_bf16 v[116:119], a[116:119], a[232:235], v[116:119]
    v_and_b32 v12, s34, v12
    v_add_f32 v14, v14, v15
    v_mfma_f32_16x16x32_bf16 v[116:119], a[132:135], a[220:223], v[116:119]
    v_add_f32 v8, v8, v12
    v_cvt_pk_bf16_f32 v8, v14, v8
    v_mfma_f32_16x16x32_bf16 v[112:115], a[128:131], a[220:223], v[112:115]
    v_lshlrev_b32 v14, 16, v9
    v_lshlrev_b32 v15, 16, v13
    v_mfma_f32_16x16x32_bf16 v[112:115], a[112:115], a[232:235], v[112:115]
    ds_read_b128 a[216:219], v1 offset:6144
    v_and_b32 v9, s34, v9
    v_mfma_f32_16x16x32_bf16 v[112:115], a[96:99], a[212:215], v[112:115]
    v_and_b32 v13, s34, v13
    v_add_f32 v14, v14, v15
    v_mfma_f32_16x16x32_bf16 v[128:131], a[96:99], a[232:235], v[128:131]
    v_add_f32 v9, v9, v13
    v_cvt_pk_bf16_f32 v9, v14, v9
    v_mfma_f32_16x16x32_bf16 v[128:131], a[112:115], a[220:223], v[128:131]
    ds_write_b128 v2, v[6:9] offset:43008
    v_mfma_f32_16x16x32_bf16 v[128:131], a[128:131], a[244:247], v[128:131]
    ds_read_b128 v[6:9], v2 offset:4096
    ds_read_b128 v[10:13], v2 offset:45056
    v_mfma_f32_16x16x32_bf16 v[132:135], a[132:135], a[244:247], v[132:135]
    v_mfma_f32_16x16x32_bf16 v[132:135], a[116:119], a[220:223], v[132:135]
    v_mfma_f32_16x16x32_bf16 v[132:135], a[100:103], a[232:235], v[132:135]
    v_mfma_f32_16x16x32_bf16 v[136:139], a[104:107], a[232:235], v[136:139]
    v_mfma_f32_16x16x32_bf16 v[136:139], a[120:123], a[220:223], v[136:139]
    v_mfma_f32_16x16x32_bf16 v[136:139], a[136:139], a[244:247], v[136:139]
    v_mfma_f32_16x16x32_bf16 v[140:143], a[140:143], a[244:247], v[140:143]
    v_mfma_f32_16x16x32_bf16 v[140:143], a[124:127], a[220:223], v[140:143]
    ds_read_b128 a[228:231], v1 offset:8192
    v_mfma_f32_16x16x32_bf16 v[140:143], a[108:111], a[232:235], v[140:143]
    v_mfma_f32_16x16x32_bf16 v[144:147], a[96:99], a[220:223], v[144:147]
    s_waitcnt lgkmcnt(2)
    v_lshlrev_b32 v14, 16, v6
    v_mfma_f32_16x16x32_bf16 v[144:147], a[112:115], a[244:247], v[144:147]
    s_waitcnt lgkmcnt(1)
    v_lshlrev_b32 v15, 16, v10
    v_and_b32 v6, s34, v6
    v_mfma_f32_16x16x32_bf16 v[144:147], a[128:131], a[240:243], v[144:147]
    v_and_b32 v10, s34, v10
    v_add_f32 v14, v14, v15
    v_mfma_f32_16x16x32_bf16 v[148:151], a[132:135], a[240:243], v[148:151]
    v_add_f32 v6, v6, v10
    v_cvt_pk_bf16_f32 v6, v14, v6
    v_mfma_f32_16x16x32_bf16 v[148:151], a[116:119], a[244:247], v[148:151]
    v_lshlrev_b32 v14, 16, v7
    v_lshlrev_b32 v15, 16, v11
    v_mfma_f32_16x16x32_bf16 v[148:151], a[100:103], a[220:223], v[148:151]
    v_and_b32 v7, s34, v7
    v_and_b32 v11, s34, v11
    v_mfma_f32_16x16x32_bf16 v[152:155], a[104:107], a[220:223], v[152:155]
    v_add_f32 v14, v14, v15
    v_add_f32 v7, v7, v11
    v_mfma_f32_16x16x32_bf16 v[152:155], a[120:123], a[244:247], v[152:155]
    v_cvt_pk_bf16_f32 v7, v14, v7
    v_lshlrev_b32 v14, 16, v8
    v_mfma_f32_16x16x32_bf16 v[152:155], a[136:139], a[240:243], v[152:155]
    v_lshlrev_b32 v15, 16, v12
    v_and_b32 v8, s34, v8
    v_mfma_f32_16x16x32_bf16 v[156:159], a[140:143], a[240:243], v[156:159]
    v_and_b32 v12, s34, v12
    v_add_f32 v14, v14, v15
    v_mfma_f32_16x16x32_bf16 v[156:159], a[124:127], a[244:247], v[156:159]
    ds_read_b128 a[236:239], v1 offset:10240
    v_add_f32 v8, v8, v12
    v_mfma_f32_16x16x32_bf16 v[156:159], a[108:111], a[220:223], v[156:159]
    v_cvt_pk_bf16_f32 v8, v14, v8
    v_lshlrev_b32 v14, 16, v9
    v_mfma_f32_16x16x32_bf16 v[32:35], a[144:147], a[208:211], v[32:35]
    v_lshlrev_b32 v15, 16, v13
    v_and_b32 v9, s34, v9
    v_mfma_f32_16x16x32_bf16 v[32:35], a[160:163], a[248:251], v[32:35]
    v_and_b32 v13, s34, v13
    v_add_f32 v14, v14, v15
    v_mfma_f32_16x16x32_bf16 v[32:35], a[176:179], a[252:255], v[32:35]
    v_add_f32 v9, v9, v13
    v_cvt_pk_bf16_f32 v9, v14, v9
    v_mfma_f32_16x16x32_bf16 v[36:39], a[180:183], a[252:255], v[36:39]
    ds_write_b128 v2, v[6:9] offset:45056
    v_mfma_f32_16x16x32_bf16 v[36:39], a[164:167], a[248:251], v[36:39]
    ds_read_b128 v[6:9], v2 offset:6144
    ds_read_b128 v[10:13], v2 offset:47104
    v_mfma_f32_16x16x32_bf16 v[36:39], a[148:151], a[208:211], v[36:39]
    v_mfma_f32_16x16x32_bf16 v[40:43], a[152:155], a[208:211], v[40:43]
    v_mfma_f32_16x16x32_bf16 v[40:43], a[168:171], a[248:251], v[40:43]
    v_mfma_f32_16x16x32_bf16 v[40:43], a[184:187], a[252:255], v[40:43]
    v_mfma_f32_16x16x32_bf16 v[44:47], a[188:191], a[252:255], v[44:47]
    v_mfma_f32_16x16x32_bf16 v[44:47], a[172:175], a[248:251], v[44:47]
    ds_read_b128 a[224:227], v1 offset:12288
    v_mfma_f32_16x16x32_bf16 v[44:47], a[156:159], a[208:211], v[44:47]
    v_mfma_f32_16x16x32_bf16 v[60:63], a[156:159], a[248:251], v[60:63]
    v_mfma_f32_16x16x32_bf16 v[60:63], a[172:175], a[252:255], v[60:63]
    v_mfma_f32_16x16x32_bf16 v[60:63], a[188:191], a[216:219], v[60:63]
    s_waitcnt lgkmcnt(2)
    v_lshlrev_b32 v14, 16, v6
    v_mfma_f32_16x16x32_bf16 v[56:59], a[184:187], a[216:219], v[56:59]
    s_waitcnt lgkmcnt(1)
    v_lshlrev_b32 v15, 16, v10
    v_and_b32 v6, s34, v6
    v_mfma_f32_16x16x32_bf16 v[56:59], a[168:171], a[252:255], v[56:59]
    v_and_b32 v10, s34, v10
    v_add_f32 v14, v14, v15
    v_mfma_f32_16x16x32_bf16 v[56:59], a[152:155], a[248:251], v[56:59]
    v_add_f32 v6, v6, v10
    v_cvt_pk_bf16_f32 v6, v14, v6
    v_mfma_f32_16x16x32_bf16 v[52:55], a[148:151], a[248:251], v[52:55]
    s_mov_b32 s43, 1212416
    v_lshlrev_b32 v14, 16, v7
    v_lshlrev_b32 v15, 16, v11
    v_mfma_f32_16x16x32_bf16 v[52:55], a[164:167], a[252:255], v[52:55]
    buffer_load_dwordx4 a[48:51], v3, s[44:47], s43 offen offset:0 sc1
    v_mfma_f32_16x16x32_bf16 v[52:55], a[180:183], a[216:219], v[52:55]
    v_and_b32 v7, s34, v7
    v_and_b32 v11, s34, v11
    v_mfma_f32_16x16x32_bf16 v[48:51], a[176:179], a[216:219], v[48:51]
    v_add_f32 v14, v14, v15
    v_add_f32 v7, v7, v11
    v_mfma_f32_16x16x32_bf16 v[48:51], a[160:163], a[252:255], v[48:51]
    ds_read_b128 a[212:215], v1 offset:14336
    v_cvt_pk_bf16_f32 v7, v14, v7
    v_mfma_f32_16x16x32_bf16 v[48:51], a[144:147], a[248:251], v[48:51]
    v_lshlrev_b32 v14, 16, v8
    v_lshlrev_b32 v15, 16, v12
    v_mfma_f32_16x16x32_bf16 v[64:67], a[144:147], a[252:255], v[64:67]
    buffer_load_dwordx4 a[52:55], v3, s[44:47], s43 offen offset:1024 sc1
    v_mfma_f32_16x16x32_bf16 v[64:67], a[160:163], a[216:219], v[64:67]
    v_and_b32 v8, s34, v8
    v_and_b32 v12, s34, v12
    v_mfma_f32_16x16x32_bf16 v[64:67], a[176:179], a[228:231], v[64:67]
    v_add_f32 v14, v14, v15
    v_add_f32 v8, v8, v12
    v_mfma_f32_16x16x32_bf16 v[68:71], a[180:183], a[228:231], v[68:71]
    v_cvt_pk_bf16_f32 v8, v14, v8
    v_lshlrev_b32 v14, 16, v9
    v_mfma_f32_16x16x32_bf16 v[68:71], a[164:167], a[216:219], v[68:71]
    v_lshlrev_b32 v15, 16, v13
    v_and_b32 v9, s34, v9
    v_mfma_f32_16x16x32_bf16 v[68:71], a[148:151], a[252:255], v[68:71]
    buffer_load_dwordx4 a[56:59], v3, s[44:47], s43 offen offset:2048 sc1
    v_mfma_f32_16x16x32_bf16 v[72:75], a[152:155], a[252:255], v[72:75]
    v_and_b32 v13, s34, v13
    v_add_f32 v14, v14, v15
    v_mfma_f32_16x16x32_bf16 v[72:75], a[168:171], a[216:219], v[72:75]
    v_add_f32 v9, v9, v13
    v_cvt_pk_bf16_f32 v9, v14, v9
    v_mfma_f32_16x16x32_bf16 v[72:75], a[184:187], a[228:231], v[72:75]
    ds_write_b128 v2, v[6:9] offset:47104
    v_mfma_f32_16x16x32_bf16 v[76:79], a[188:191], a[228:231], v[76:79]
    ds_read_b128 v[6:9], v2 offset:8192
    ds_read_b128 v[10:13], v2 offset:49152
    v_mfma_f32_16x16x32_bf16 v[76:79], a[172:175], a[216:219], v[76:79]
    buffer_load_dwordx4 a[60:63], v3, s[44:47], s43 offen offset:3072 sc1
    v_mfma_f32_16x16x32_bf16 v[76:79], a[156:159], a[252:255], v[76:79]
    ds_read_b128 a[232:235], v1 offset:16384
    v_mfma_f32_16x16x32_bf16 v[92:95], a[156:159], a[216:219], v[92:95]
    v_mfma_f32_16x16x32_bf16 v[92:95], a[172:175], a[228:231], v[92:95]
    s_mov_b32 s43, 1310720
    v_mfma_f32_16x16x32_bf16 v[92:95], a[188:191], a[236:239], v[92:95]
    v_mfma_f32_16x16x32_bf16 v[88:91], a[184:187], a[236:239], v[88:91]
    buffer_load_dwordx4 a[64:67], v3, s[44:47], s43 offen offset:0 sc1
    v_mfma_f32_16x16x32_bf16 v[88:91], a[168:171], a[228:231], v[88:91]
    v_mfma_f32_16x16x32_bf16 v[88:91], a[152:155], a[216:219], v[88:91]
    v_mfma_f32_16x16x32_bf16 v[84:87], a[148:151], a[216:219], v[84:87]
    v_mfma_f32_16x16x32_bf16 v[84:87], a[164:167], a[228:231], v[84:87]
    s_waitcnt lgkmcnt(2)
    v_lshlrev_b32 v14, 16, v6
    v_mfma_f32_16x16x32_bf16 v[84:87], a[180:183], a[236:239], v[84:87]
    buffer_load_dwordx4 a[68:71], v3, s[44:47], s43 offen offset:1024 sc1
    v_mfma_f32_16x16x32_bf16 v[80:83], a[176:179], a[236:239], v[80:83]
    s_waitcnt lgkmcnt(1)
    v_lshlrev_b32 v15, 16, v10
    v_and_b32 v6, s34, v6
    v_mfma_f32_16x16x32_bf16 v[80:83], a[160:163], a[228:231], v[80:83]
    ds_read_b128 a[240:243], v1 offset:18432
    v_and_b32 v10, s34, v10
    v_mfma_f32_16x16x32_bf16 v[80:83], a[144:147], a[216:219], v[80:83]
    v_add_f32 v14, v14, v15
    v_add_f32 v6, v6, v10
    v_mfma_f32_16x16x32_bf16 v[96:99], a[144:147], a[228:231], v[96:99]
    v_cvt_pk_bf16_f32 v6, v14, v6
    v_lshlrev_b32 v14, 16, v7
    v_mfma_f32_16x16x32_bf16 v[96:99], a[160:163], a[236:239], v[96:99]
    buffer_load_dwordx4 a[72:75], v3, s[44:47], s43 offen offset:2048 sc1
    v_mfma_f32_16x16x32_bf16 v[96:99], a[176:179], a[224:227], v[96:99]
    v_lshlrev_b32 v15, 16, v11
    v_and_b32 v7, s34, v7
    v_mfma_f32_16x16x32_bf16 v[100:103], a[180:183], a[224:227], v[100:103]
    v_and_b32 v11, s34, v11
    v_add_f32 v14, v14, v15
    v_mfma_f32_16x16x32_bf16 v[100:103], a[164:167], a[236:239], v[100:103]
    v_add_f32 v7, v7, v11
    v_cvt_pk_bf16_f32 v7, v14, v7
    v_mfma_f32_16x16x32_bf16 v[100:103], a[148:151], a[228:231], v[100:103]
    v_lshlrev_b32 v14, 16, v8
    v_lshlrev_b32 v15, 16, v12
    v_mfma_f32_16x16x32_bf16 v[104:107], a[152:155], a[228:231], v[104:107]
    buffer_load_dwordx4 a[76:79], v3, s[44:47], s43 offen offset:3072 sc1
    v_mfma_f32_16x16x32_bf16 v[104:107], a[168:171], a[236:239], v[104:107]
    v_and_b32 v8, s34, v8
    v_and_b32 v12, s34, v12
    v_mfma_f32_16x16x32_bf16 v[104:107], a[184:187], a[224:227], v[104:107]
    v_add_f32 v14, v14, v15
    v_add_f32 v8, v8, v12
    v_mfma_f32_16x16x32_bf16 v[108:111], a[188:191], a[224:227], v[108:111]
    s_mov_b32 s43, 1376256
    v_cvt_pk_bf16_f32 v8, v14, v8
    v_lshlrev_b32 v14, 16, v9
    v_mfma_f32_16x16x32_bf16 v[108:111], a[172:175], a[236:239], v[108:111]
    v_lshlrev_b32 v15, 16, v13
    v_and_b32 v9, s34, v9
    v_mfma_f32_16x16x32_bf16 v[108:111], a[156:159], a[228:231], v[108:111]
    buffer_load_dwordx4 a[80:83], v3, s[44:47], s43 offen offset:0 sc1
    v_mfma_f32_16x16x32_bf16 v[124:127], a[156:159], a[236:239], v[124:127]
    v_and_b32 v13, s34, v13
    v_add_f32 v14, v14, v15
    v_mfma_f32_16x16x32_bf16 v[124:127], a[172:175], a[224:227], v[124:127]
    v_add_f32 v9, v9, v13
    v_cvt_pk_bf16_f32 v9, v14, v9
    v_mfma_f32_16x16x32_bf16 v[124:127], a[188:191], a[212:215], v[124:127]
    ds_write_b128 v2, v[6:9] offset:49152
    v_mfma_f32_16x16x32_bf16 v[120:123], a[184:187], a[212:215], v[120:123]
    v_mfma_f32_16x16x32_bf16 v[120:123], a[168:171], a[224:227], v[120:123]
    buffer_load_dwordx4 a[84:87], v3, s[44:47], s43 offen offset:1024 sc1
    v_mfma_f32_16x16x32_bf16 v[120:123], a[152:155], a[236:239], v[120:123]
    v_mfma_f32_16x16x32_bf16 v[116:119], a[148:151], a[236:239], v[116:119]
    v_mfma_f32_16x16x32_bf16 v[116:119], a[164:167], a[224:227], v[116:119]
    v_mfma_f32_16x16x32_bf16 v[116:119], a[180:183], a[212:215], v[116:119]
    v_mfma_f32_16x16x32_bf16 v[112:115], a[176:179], a[212:215], v[112:115]
    buffer_load_dwordx4 a[88:91], v3, s[44:47], s43 offen offset:2048 sc1
    v_mfma_f32_16x16x32_bf16 v[112:115], a[160:163], a[224:227], v[112:115]
    v_mfma_f32_16x16x32_bf16 v[112:115], a[144:147], a[236:239], v[112:115]
    v_mfma_f32_16x16x32_bf16 v[128:131], a[144:147], a[224:227], v[128:131]
    v_mfma_f32_16x16x32_bf16 v[128:131], a[160:163], a[212:215], v[128:131]
    s_waitcnt lgkmcnt(1)
    v_mfma_f32_16x16x32_bf16 v[128:131], a[176:179], a[232:235], v[128:131]
    buffer_load_dwordx4 a[92:95], v3, s[44:47], s43 offen offset:3072 sc1
    v_mfma_f32_16x16x32_bf16 v[132:135], a[180:183], a[232:235], v[132:135]
    v_mfma_f32_16x16x32_bf16 v[132:135], a[164:167], a[212:215], v[132:135]
    v_mfma_f32_16x16x32_bf16 v[132:135], a[148:151], a[224:227], v[132:135]
    s_mov_b32 s43, 1114112
    v_mfma_f32_16x16x32_bf16 v[136:139], a[152:155], a[224:227], v[136:139]
    v_mfma_f32_16x16x32_bf16 v[136:139], a[168:171], a[212:215], v[136:139]
    buffer_load_dwordx4 a[96:99], v3, s[44:47], s43 offen offset:0 sc1
    v_mfma_f32_16x16x32_bf16 v[136:139], a[184:187], a[232:235], v[136:139]
    s_waitcnt vmcnt(13) lgkmcnt(0)
    s_barrier
    v_add_u32 v0, 0x5000, v0
    v_mfma_f32_16x16x32_bf16 v[140:143], a[188:191], a[232:235], v[140:143]
    v_add_u32 v1, 0x5000, v1
    v_mfma_f32_16x16x32_bf16 v[140:143], a[172:175], a[212:215], v[140:143]
    ds_read_b128 a[244:247], v0 offset:40960
    ds_read_b128 a[220:223], v0 offset:43008
    v_mfma_f32_16x16x32_bf16 v[140:143], a[156:159], a[224:227], v[140:143]
    ds_read_b128 a[208:211], v0 offset:45056
    ds_read_b128 a[248:251], v0 offset:47104
    v_mfma_f32_16x16x32_bf16 v[144:147], a[144:147], a[212:215], v[144:147]
    buffer_load_dwordx4 a[100:103], v3, s[44:47], s43 offen offset:1024 sc1
    v_mfma_f32_16x16x32_bf16 v[144:147], a[160:163], a[232:235], v[144:147]
    ds_read_b128 a[252:255], v0 offset:49152
    v_mfma_f32_16x16x32_bf16 v[144:147], a[176:179], a[240:243], v[144:147]
    v_mfma_f32_16x16x32_bf16 v[148:151], a[180:183], a[240:243], v[148:151]
    v_mfma_f32_16x16x32_bf16 v[148:151], a[164:167], a[232:235], v[148:151]
    v_mfma_f32_16x16x32_bf16 v[148:151], a[148:151], a[212:215], v[148:151]
    buffer_load_dwordx4 a[104:107], v3, s[44:47], s43 offen offset:2048 sc1
    v_mfma_f32_16x16x32_bf16 v[152:155], a[152:155], a[212:215], v[152:155]
    ds_read_b128 a[216:219], v0 offset:51200
    v_mfma_f32_16x16x32_bf16 v[152:155], a[168:171], a[232:235], v[152:155]
    v_mfma_f32_16x16x32_bf16 v[152:155], a[184:187], a[240:243], v[152:155]
    v_mfma_f32_16x16x32_bf16 v[156:159], a[188:191], a[240:243], v[156:159]
    v_mfma_f32_16x16x32_bf16 v[156:159], a[172:175], a[232:235], v[156:159]
    buffer_load_dwordx4 a[108:111], v3, s[44:47], s43 offen offset:3072 sc1
    v_mfma_f32_16x16x32_bf16 v[156:159], a[156:159], a[212:215], v[156:159]
    s_waitcnt lgkmcnt(4)
    v_mfma_f32_16x16x32_bf16 v[160:163], a[32:35], a[244:247], v[160:163]
    s_waitcnt vmcnt(15) lgkmcnt(2)
    ds_read_b128 v[6:9], v2 offset:20480
    ds_read_b128 v[10:13], v2 offset:61440
    v_mfma_f32_16x16x32_bf16 v[160:163], a[48:51], a[220:223], v[160:163]
    s_waitcnt vmcnt(14)
    ds_read_b128 a[228:231], v0 offset:53248
    s_mov_b32 s43, 1179648
    v_mfma_f32_16x16x32_bf16 v[164:167], a[52:55], a[220:223], v[164:167]
    v_mfma_f32_16x16x32_bf16 v[164:167], a[36:39], a[244:247], v[164:167]
    buffer_load_dwordx4 a[112:115], v3, s[44:47], s43 offen offset:0 sc1
    v_mfma_f32_16x16x32_bf16 v[168:171], a[40:43], a[244:247], v[168:171]
    s_waitcnt vmcnt(14) lgkmcnt(4)
    v_mfma_f32_16x16x32_bf16 v[168:171], a[56:59], a[220:223], v[168:171]
    s_waitcnt vmcnt(13)
    v_mfma_f32_16x16x32_bf16 v[172:175], a[60:63], a[220:223], v[172:175]
    v_mfma_f32_16x16x32_bf16 v[172:175], a[44:47], a[244:247], v[172:175]
    v_mfma_f32_16x16x32_bf16 v[188:191], a[44:47], a[220:223], v[188:191]
    v_mfma_f32_16x16x32_bf16 v[188:191], a[60:63], a[208:211], v[188:191]
    v_mfma_f32_16x16x32_bf16 v[184:187], a[56:59], a[208:211], v[184:187]
    buffer_load_dwordx4 a[116:119], v3, s[44:47], s43 offen offset:1024 sc1
    v_mfma_f32_16x16x32_bf16 v[184:187], a[40:43], a[220:223], v[184:187]
    ds_read_b128 a[236:239], v0 offset:55296
    v_mfma_f32_16x16x32_bf16 v[180:183], a[36:39], a[220:223], v[180:183]
    s_waitcnt lgkmcnt(3)
    v_lshlrev_b32 v14, 16, v6
    v_mfma_f32_16x16x32_bf16 v[180:183], a[52:55], a[208:211], v[180:183]
    buffer_load_dwordx4 a[120:123], v3, s[44:47], s43 offen offset:2048 sc1
    v_mfma_f32_16x16x32_bf16 v[176:179], a[48:51], a[208:211], v[176:179]
    s_waitcnt lgkmcnt(1)
    v_lshlrev_b32 v15, 16, v10
    v_and_b32 v6, s34, v6
    v_mfma_f32_16x16x32_bf16 v[176:179], a[32:35], a[220:223], v[176:179]
    v_and_b32 v10, s34, v10
    v_add_f32 v14, v14, v15
    v_mfma_f32_16x16x32_bf16 v[192:195], a[32:35], a[208:211], v[192:195]
    v_add_f32 v6, v6, v10
    v_cvt_pk_bf16_f32 v6, v14, v6
    v_mfma_f32_16x16x32_bf16 v[192:195], a[48:51], a[248:251], v[192:195]
    ds_read_b128 a[224:227], v0 offset:57344
    v_lshlrev_b32 v14, 16, v7
    v_mfma_f32_16x16x32_bf16 v[196:199], a[52:55], a[248:251], v[196:199]
    buffer_load_dwordx4 a[124:127], v3, s[44:47], s43 offen offset:3072 sc1
    v_mfma_f32_16x16x32_bf16 v[196:199], a[36:39], a[208:211], v[196:199]
    v_lshlrev_b32 v15, 16, v11
    v_and_b32 v7, s34, v7
    v_mfma_f32_16x16x32_bf16 v[200:203], a[40:43], a[208:211], v[200:203]
    v_and_b32 v11, s34, v11
    v_add_f32 v14, v14, v15
    v_mfma_f32_16x16x32_bf16 v[200:203], a[56:59], a[248:251], v[200:203]
    buffer_load_dword a205, off, s[48:51], 0 offset:4 sc1
    v_mfma_f32_16x16x32_bf16 v[204:207], a[60:63], a[248:251], v[204:207]
    v_add_f32 v7, v7, v11
    v_cvt_pk_bf16_f32 v7, v14, v7
    v_mfma_f32_16x16x32_bf16 v[204:207], a[44:47], a[208:211], v[204:207]
    v_lshlrev_b32 v14, 16, v8
    v_lshlrev_b32 v15, 16, v12
    v_mfma_f32_16x16x32_bf16 v[220:223], a[44:47], a[248:251], v[220:223]
    s_mov_b32 s43, 1245184
    ds_read_b128 a[240:243], v1 offset:40960
    v_and_b32 v8, s34, v8
    v_mfma_f32_16x16x32_bf16 v[220:223], a[60:63], a[252:255], v[220:223]
    ds_read_b128 a[232:235], v1 offset:43008
    v_and_b32 v12, s34, v12
    v_mfma_f32_16x16x32_bf16 v[216:219], a[56:59], a[252:255], v[216:219]
    buffer_load_dwordx4 a[128:131], v3, s[44:47], s43 offen offset:0 sc1
    v_mfma_f32_16x16x32_bf16 v[216:219], a[40:43], a[248:251], v[216:219]
    v_add_f32 v14, v14, v15
    v_add_f32 v8, v8, v12
    v_mfma_f32_16x16x32_bf16 v[212:215], a[36:39], a[248:251], v[212:215]
    v_cvt_pk_bf16_f32 v8, v14, v8
    v_lshlrev_b32 v14, 16, v9
    v_mfma_f32_16x16x32_bf16 v[212:215], a[52:55], a[252:255], v[212:215]
    v_lshlrev_b32 v15, 16, v13
    v_and_b32 v9, s34, v9
    v_mfma_f32_16x16x32_bf16 v[208:211], a[48:51], a[252:255], v[208:211]
    v_and_b32 v13, s34, v13
    v_add_f32 v14, v14, v15
    v_mfma_f32_16x16x32_bf16 v[208:211], a[32:35], a[248:251], v[208:211]
    buffer_load_dwordx4 a[132:135], v3, s[44:47], s43 offen offset:1024 sc1
    v_mfma_f32_16x16x32_bf16 v[224:227], a[32:35], a[252:255], v[224:227]
    v_add_f32 v9, v9, v13
    v_cvt_pk_bf16_f32 v9, v14, v9
    v_mfma_f32_16x16x32_bf16 v[224:227], a[48:51], a[216:219], v[224:227]
    ds_read_b128 a[212:215], v1 offset:45056
    v_mfma_f32_16x16x32_bf16 v[228:231], a[52:55], a[216:219], v[228:231]
    ds_write_b128 v2, v[6:9] offset:0
    v_mfma_f32_16x16x32_bf16 v[228:231], a[36:39], a[252:255], v[228:231]
    ds_read_b128 v[6:9], v2 offset:22528
    ds_read_b128 v[10:13], v2 offset:63488
    v_mfma_f32_16x16x32_bf16 v[232:235], a[40:43], a[252:255], v[232:235]
    buffer_load_dwordx4 a[136:139], v3, s[44:47], s43 offen offset:2048 sc1
    v_mfma_f32_16x16x32_bf16 v[232:235], a[56:59], a[216:219], v[232:235]
    v_mfma_f32_16x16x32_bf16 v[236:239], a[60:63], a[216:219], v[236:239]
    v_mfma_f32_16x16x32_bf16 v[236:239], a[44:47], a[252:255], v[236:239]
    v_mfma_f32_16x16x32_bf16 v[252:255], a[44:47], a[216:219], v[252:255]
    v_mfma_f32_16x16x32_bf16 v[252:255], a[60:63], a[228:231], v[252:255]
    buffer_load_dwordx4 a[140:143], v3, s[44:47], s43 offen offset:3072 sc1
    v_mfma_f32_16x16x32_bf16 v[248:251], a[56:59], a[228:231], v[248:251]
    ds_read_b128 a[244:247], v1 offset:47104
    v_mfma_f32_16x16x32_bf16 v[248:251], a[40:43], a[216:219], v[248:251]
    v_mfma_f32_16x16x32_bf16 v[244:247], a[36:39], a[216:219], v[244:247]
    s_mov_b32 s43, 1409024
    v_mfma_f32_16x16x32_bf16 v[244:247], a[52:55], a[228:231], v[244:247]
    s_waitcnt lgkmcnt(2)
    v_lshlrev_b32 v14, 16, v6
    v_mfma_f32_16x16x32_bf16 v[240:243], a[48:51], a[228:231], v[240:243]
    buffer_load_dwordx4 a[176:179], v3, s[44:47], s43 offen offset:0 sc1
    v_mfma_f32_16x16x32_bf16 v[240:243], a[32:35], a[216:219], v[240:243]
    s_waitcnt lgkmcnt(1)
    v_lshlrev_b32 v15, 16, v10
    v_and_b32 v6, s34, v6
    v_mfma_f32_16x16x32_bf16 a[0:3], a[32:35], a[228:231], a[0:3]
    v_and_b32 v10, s34, v10
    v_add_f32 v14, v14, v15
    v_mfma_f32_16x16x32_bf16 a[0:3], a[48:51], a[236:239], a[0:3]
    ds_read_b128 a[220:223], v1 offset:49152
    v_add_f32 v6, v6, v10
    v_mfma_f32_16x16x32_bf16 a[4:7], a[52:55], a[236:239], a[4:7]
    v_cvt_pk_bf16_f32 v6, v14, v6
    v_lshlrev_b32 v14, 16, v7
    v_mfma_f32_16x16x32_bf16 a[4:7], a[36:39], a[228:231], a[4:7]
    buffer_load_dwordx4 a[180:183], v3, s[44:47], s43 offen offset:1024 sc1
    v_mfma_f32_16x16x32_bf16 a[8:11], a[40:43], a[228:231], a[8:11]
    v_lshlrev_b32 v15, 16, v11
    v_and_b32 v7, s34, v7
    v_mfma_f32_16x16x32_bf16 a[8:11], a[56:59], a[236:239], a[8:11]
    v_and_b32 v11, s34, v11
    v_add_f32 v14, v14, v15
    v_mfma_f32_16x16x32_bf16 a[12:15], a[60:63], a[236:239], a[12:15]
    v_add_f32 v7, v7, v11
    v_cvt_pk_bf16_f32 v7, v14, v7
    v_mfma_f32_16x16x32_bf16 a[12:15], a[44:47], a[228:231], a[12:15]
    v_lshlrev_b32 v14, 16, v8
    v_lshlrev_b32 v15, 16, v12
    v_mfma_f32_16x16x32_bf16 a[16:19], a[32:35], a[236:239], a[16:19]
    buffer_load_dwordx4 a[184:187], v3, s[44:47], s43 offen offset:2048 sc1
    v_mfma_f32_16x16x32_bf16 a[16:19], a[48:51], a[224:227], a[16:19]
    ds_read_b128 a[208:211], v1 offset:51200
    v_and_b32 v8, s34, v8
    v_mfma_f32_16x16x32_bf16 a[20:23], a[52:55], a[224:227], a[20:23]
    v_and_b32 v12, s34, v12
    v_add_f32 v14, v14, v15
    v_mfma_f32_16x16x32_bf16 a[20:23], a[36:39], a[236:239], a[20:23]
    v_add_f32 v8, v8, v12
    v_cvt_pk_bf16_f32 v8, v14, v8
    v_mfma_f32_16x16x32_bf16 a[24:27], a[40:43], a[236:239], a[24:27]
    v_lshlrev_b32 v14, 16, v9
    v_lshlrev_b32 v15, 16, v13
    v_mfma_f32_16x16x32_bf16 a[24:27], a[56:59], a[224:227], a[24:27]
    buffer_load_dwordx4 a[188:191], v3, s[44:47], s43 offen offset:3072 sc1
    v_mfma_f32_16x16x32_bf16 a[28:31], a[60:63], a[224:227], a[28:31]
    v_and_b32 v9, s34, v9
    v_and_b32 v13, s34, v13
    v_mfma_f32_16x16x32_bf16 a[28:31], a[44:47], a[236:239], a[28:31]
    s_waitcnt vmcnt(20) lgkmcnt(1)
    v_add_f32 v14, v14, v15
    v_add_f32 v9, v9, v13
    v_mfma_f32_16x16x32_bf16 v[160:163], a[64:67], a[240:243], v[160:163]
    s_mov_b32 s43, 1343488
    v_cvt_pk_bf16_f32 v9, v14, v9
    v_mfma_f32_16x16x32_bf16 v[160:163], a[80:83], a[232:235], v[160:163]
    s_waitcnt vmcnt(19)
    ds_read_b128 a[248:251], v1 offset:53248
    v_mfma_f32_16x16x32_bf16 v[164:167], a[84:87], a[232:235], v[164:167]
    buffer_load_dwordx4 a[160:163], v3, s[44:47], s43 offen offset:0 sc1
    v_mfma_f32_16x16x32_bf16 v[164:167], a[68:71], a[240:243], v[164:167]
    ds_write_b128 v2, v[6:9] offset:2048
    v_mfma_f32_16x16x32_bf16 v[168:171], a[72:75], a[240:243], v[168:171]
    s_waitcnt vmcnt(19)
    v_fma_f32 v160, s31, v160, v5
    v_fma_f32 v161, s31, v161, v5
    v_mfma_f32_16x16x32_bf16 v[168:171], a[88:91], a[232:235], v[168:171]
    s_waitcnt vmcnt(18)
    v_fma_f32 v162, s31, v162, v5
    v_fma_f32 v163, s31, v163, v5
    v_mfma_f32_16x16x32_bf16 v[172:175], a[92:95], a[232:235], v[172:175]
    v_fma_f32 v164, s31, v164, v5
    v_fma_f32 v165, s31, v165, v5
    v_mfma_f32_16x16x32_bf16 v[172:175], a[76:79], a[240:243], v[172:175]
    buffer_load_dwordx4 a[164:167], v3, s[44:47], s43 offen offset:1024 sc1
    v_mfma_f32_16x16x32_bf16 v[188:191], a[76:79], a[232:235], v[188:191]
    s_waitcnt vmcnt(10) lgkmcnt(2)
    v_accvgpr_read_b32 v15, a205
    v_cmp_gt_u32 vcc, 4, v15
    v_mfma_f32_16x16x32_bf16 v[188:191], a[92:95], a[212:215], v[188:191]
    s_nop 0
    ds_read_b128 a[252:255], v1 offset:55296
    s_nop 0
    v_mfma_f32_16x16x32_bf16 v[184:187], a[88:91], a[212:215], v[184:187]
    s_cbranch_vccnz L_spin1
L_back1:
    v_add_u32 v2, 4096, v2
    v_fma_f32 v166, s31, v166, v5
    v_mfma_f32_16x16x32_bf16 v[184:187], a[72:75], a[232:235], v[184:187]
    ds_read_b128 v[6:9], v2 offset:20480
    ds_read_b128 v[10:13], v2 offset:61440
    v_mfma_f32_16x16x32_bf16 v[180:183], a[68:71], a[232:235], v[180:183]
    buffer_load_dwordx4 a[168:171], v3, s[44:47], s43 offen offset:2048 sc1
    v_mfma_f32_16x16x32_bf16 v[180:183], a[84:87], a[212:215], v[180:183]
    v_fma_f32 v167, s31, v167, v5
    v_mul_f32 v168, s32, v168
    v_mfma_f32_16x16x32_bf16 v[176:179], a[80:83], a[212:215], v[176:179]
    v_mul_f32 v169, s32, v169
    v_mul_f32 v170, s32, v170
    v_mfma_f32_16x16x32_bf16 v[176:179], a[64:67], a[232:235], v[176:179]
    v_mul_f32 v171, s32, v171
    v_mul_f32 v172, s32, v172
    v_mfma_f32_16x16x32_bf16 v[192:195], a[64:67], a[212:215], v[192:195]
    v_mul_f32 v173, s32, v173
    v_mul_f32 v174, s32, v174
    v_mfma_f32_16x16x32_bf16 v[192:195], a[80:83], a[244:247], v[192:195]
    buffer_load_dwordx4 a[172:175], v3, s[44:47], s43 offen offset:3072 sc1
    v_mfma_f32_16x16x32_bf16 v[196:199], a[84:87], a[244:247], v[196:199]
    ds_read_b128 a[216:219], v1 offset:57344
    v_mul_f32 v175, s32, v175
    v_mfma_f32_16x16x32_bf16 v[196:199], a[68:71], a[212:215], v[196:199]
    v_mov_b32_dpp v16, v160 row_shl:2 row_mask:0xf bank_mask:0xf bound_ctrl:0
    v_mov_b32_dpp v17, v161 row_shl:2 row_mask:0xf bank_mask:0xf bound_ctrl:0
    v_mfma_f32_16x16x32_bf16 v[200:203], a[72:75], a[212:215], v[200:203]
    s_mov_b32 s43, 1277952
    v_mov_b32_dpp v18, v162 row_shl:2 row_mask:0xf bank_mask:0xf bound_ctrl:0
    v_mov_b32_dpp v19, v163 row_shl:2 row_mask:0xf bank_mask:0xf bound_ctrl:0
    v_mfma_f32_16x16x32_bf16 v[200:203], a[88:91], a[244:247], v[200:203]
    s_waitcnt lgkmcnt(2)
    v_lshlrev_b32 v14, 16, v6
    v_mov_b32_dpp v20, v164 row_shl:2 row_mask:0xf bank_mask:0xf bound_ctrl:0
    v_mfma_f32_16x16x32_bf16 v[204:207], a[92:95], a[244:247], v[204:207]
    buffer_load_dwordx4 a[144:147], v3, s[44:47], s43 offen offset:0 sc1
    v_mfma_f32_16x16x32_bf16 v[204:207], a[76:79], a[212:215], v[204:207]
    s_waitcnt lgkmcnt(1)
    v_lshlrev_b32 v15, 16, v10
    v_and_b32 v6, s34, v6
    v_mfma_f32_16x16x32_bf16 v[220:223], a[76:79], a[244:247], v[220:223]
    v_and_b32 v10, s34, v10
    v_add_f32 v14, v14, v15
    v_mfma_f32_16x16x32_bf16 v[220:223], a[92:95], a[220:223], v[220:223]
    v_add_f32 v6, v6, v10
    v_cvt_pk_bf16_f32 v6, v14, v6
    v_mfma_f32_16x16x32_bf16 v[216:219], a[88:91], a[220:223], v[216:219]
    v_lshlrev_b32 v14, 16, v7
    v_lshlrev_b32 v15, 16, v11
    v_mfma_f32_16x16x32_bf16 v[216:219], a[72:75], a[244:247], v[216:219]
    buffer_load_dwordx4 a[148:151], v3, s[44:47], s43 offen offset:1024 sc1
    v_mfma_f32_16x16x32_bf16 v[212:215], a[68:71], a[244:247], v[212:215]
    v_and_b32 v7, s34, v7
    v_and_b32 v11, s34, v11
    v_mfma_f32_16x16x32_bf16 v[212:215], a[84:87], a[220:223], v[212:215]
    v_add_f32 v14, v14, v15
    v_add_f32 v7, v7, v11
    v_mfma_f32_16x16x32_bf16 v[208:211], a[80:83], a[220:223], v[208:211]
    v_cvt_pk_bf16_f32 v7, v14, v7
    v_lshlrev_b32 v14, 16, v8
    v_mfma_f32_16x16x32_bf16 v[208:211], a[64:67], a[244:247], v[208:211]
    v_lshlrev_b32 v15, 16, v12
    v_and_b32 v8, s34, v8
    v_mfma_f32_16x16x32_bf16 v[224:227], a[64:67], a[220:223], v[224:227]
    buffer_load_dwordx4 a[152:155], v3, s[44:47], s43 offen offset:2048 sc1
    v_mfma_f32_16x16x32_bf16 v[224:227], a[80:83], a[208:211], v[224:227]
    v_and_b32 v12, s34, v12
    v_add_f32 v14, v14, v15
    v_mfma_f32_16x16x32_bf16 v[228:231], a[84:87], a[208:211], v[228:231]
    v_add_f32 v8, v8, v12
    v_cvt_pk_bf16_f32 v8, v14, v8
    v_mfma_f32_16x16x32_bf16 v[228:231], a[68:71], a[220:223], v[228:231]
    v_lshlrev_b32 v14, 16, v9
    v_lshlrev_b32 v15, 16, v13
    v_mfma_f32_16x16x32_bf16 v[232:235], a[72:75], a[220:223], v[232:235]
    v_and_b32 v9, s34, v9
    v_and_b32 v13, s34, v13
    v_mfma_f32_16x16x32_bf16 v[232:235], a[88:91], a[208:211], v[232:235]
    buffer_load_dwordx4 a[156:159], v3, s[44:47], s43 offen offset:3072 sc1
    v_mfma_f32_16x16x32_bf16 v[236:239], a[92:95], a[208:211], v[236:239]
    v_add_f32 v14, v14, v15
    v_add_f32 v9, v9, v13
    v_mfma_f32_16x16x32_bf16 v[236:239], a[76:79], a[220:223], v[236:239]
    v_cvt_pk_bf16_f32 v9, v14, v9
    v_mov_b32_dpp v21, v165 row_shl:2 row_mask:0xf bank_mask:0xf bound_ctrl:0
    v_mfma_f32_16x16x32_bf16 v[252:255], a[76:79], a[208:211], v[252:255]
    ds_write_b128 v2, v[6:9] offset:0
    v_mfma_f32_16x16x32_bf16 v[252:255], a[92:95], a[248:251], v[252:255]
    ds_read_b128 v[6:9], v2 offset:22528
    ds_read_b128 v[10:13], v2 offset:63488
    v_mfma_f32_16x16x32_bf16 v[248:251], a[88:91], a[248:251], v[248:251]
    buffer_load_dwordx4 a[192:195], v3, s[44:47], 0 offen offset:0 sc1
    v_mov_b32_dpp v22, v166 row_shl:2 row_mask:0xf bank_mask:0xf bound_ctrl:0
    v_mfma_f32_16x16x32_bf16 v[248:251], a[72:75], a[208:211], v[248:251]
    v_mov_b32_dpp v23, v167 row_shl:2 row_mask:0xf bank_mask:0xf bound_ctrl:0
    v_mov_b32_dpp v24, v168 row_shl:2 row_mask:0xf bank_mask:0xf bound_ctrl:0
    v_mfma_f32_16x16x32_bf16 v[244:247], a[68:71], a[208:211], v[244:247]
    v_mov_b32_dpp v25, v169 row_shl:2 row_mask:0xf bank_mask:0xf bound_ctrl:0
    v_mov_b32_dpp v26, v170 row_shl:2 row_mask:0xf bank_mask:0xf bound_ctrl:0
    v_mfma_f32_16x16x32_bf16 v[244:247], a[84:87], a[248:251], v[244:247]
    v_mov_b32_dpp v27, v171 row_shl:2 row_mask:0xf bank_mask:0xf bound_ctrl:0
    v_mov_b32_dpp v28, v172 row_shl:2 row_mask:0xf bank_mask:0xf bound_ctrl:0
    v_mfma_f32_16x16x32_bf16 v[240:243], a[80:83], a[248:251], v[240:243]
    s_waitcnt lgkmcnt(3)
    s_barrier
    ds_read_b128 a[228:231], v0 offset:0
    v_mfma_f32_16x16x32_bf16 v[240:243], a[64:67], a[208:211], v[240:243]
    ds_read_b128 a[224:227], v0 offset:2048
    ds_read_b128 a[236:239], v0 offset:4096
    v_mfma_f32_16x16x32_bf16 a[0:3], a[64:67], a[248:251], a[0:3]
    buffer_load_dwordx4 a[196:199], v3, s[44:47], 0 offen offset:2048 sc1
    ds_read_b128 a[240:243], v1 offset:4096
    v_mfma_f32_16x16x32_bf16 a[0:3], a[80:83], a[252:255], a[0:3]
    ds_read_b128 a[232:235], v1 offset:2048
    ds_read_b128 a[212:215], v1 offset:0
    v_mfma_f32_16x16x32_bf16 a[4:7], a[84:87], a[252:255], a[4:7]
    ds_read_b128 a[244:247], v0 offset:6144
    v_mov_b32_dpp v29, v173 row_shl:2 row_mask:0xf bank_mask:0xf bound_ctrl:0
    v_mfma_f32_16x16x32_bf16 a[4:7], a[68:71], a[248:251], a[4:7]
    ds_read_b128 a[220:223], v1 offset:6144
    v_mov_b32_dpp v30, v174 row_shl:2 row_mask:0xf bank_mask:0xf bound_ctrl:0
    v_mfma_f32_16x16x32_bf16 a[8:11], a[72:75], a[248:251], a[8:11]
    s_waitcnt lgkmcnt(9)
    v_lshlrev_b32 v14, 16, v6
    v_mov_b32_dpp v31, v175 row_shl:2 row_mask:0xf bank_mask:0xf bound_ctrl:0
    v_mfma_f32_16x16x32_bf16 a[8:11], a[88:91], a[252:255], a[8:11]
    buffer_load_dwordx4 a[200:203], v3, s[44:47], 0 offen offset:1024 sc1
    v_fma_f32 v176, s31, v176, v5
    v_mfma_f32_16x16x32_bf16 a[12:15], a[92:95], a[252:255], a[12:15]
    s_waitcnt lgkmcnt(8)
    v_lshlrev_b32 v15, 16, v10
    v_and_b32 v6, s34, v6
    v_mfma_f32_16x16x32_bf16 a[12:15], a[76:79], a[248:251], a[12:15]
    v_and_b32 v10, s34, v10
    v_add_f32 v14, v14, v15
    v_mfma_f32_16x16x32_bf16 a[16:19], a[64:67], a[252:255], a[16:19]
    v_add_f32 v6, v6, v10
    v_cvt_pk_bf16_f32 v6, v14, v6
    v_mfma_f32_16x16x32_bf16 a[16:19], a[80:83], a[216:219], a[16:19]
    v_lshlrev_b32 v14, 16, v7
    v_lshlrev_b32 v15, 16, v11
    v_mfma_f32_16x16x32_bf16 a[20:23], a[84:87], a[216:219], a[20:23]
    v_and_b32 v7, s34, v7
    v_and_b32 v11, s34, v11
    v_mfma_f32_16x16x32_bf16 a[20:23], a[68:71], a[252:255], a[20:23]
    buffer_load_dwordx4 a[32:35], v3, s[44:47], 0 offen offset:3072 sc1
    v_add_f32 v14, v14, v15
    v_mfma_f32_16x16x32_bf16 a[24:27], a[72:75], a[252:255], a[24:27]
    v_add_f32 v7, v7, v11
    v_cvt_pk_bf16_f32 v7, v14, v7
    v_mfma_f32_16x16x32_bf16 a[24:27], a[88:91], a[216:219], a[24:27]
    v_lshlrev_b32 v14, 16, v8
    v_lshlrev_b32 v15, 16, v12
    v_mfma_f32_16x16x32_bf16 a[28:31], a[92:95], a[216:219], a[28:31]
    v_add_u32 v3, 0x8000, v3
    v_and_b32 v8, s34, v8
    v_mfma_f32_16x16x32_bf16 a[28:31], a[76:79], a[252:255], a[28:31]
    s_waitcnt lgkmcnt(1)
    v_and_b32 v12, s34, v12
    v_add_f32 v14, v14, v15
    v_mfma_f32_16x16x32_bf16 v[32:35], a[96:99], a[228:231], v[32:35]
    buffer_load_dwordx4 a[48:51], v3, s[44:47], 0 offen offset:0 sc1
    v_add_f32 v8, v8, v12
    v_mfma_f32_16x16x32_bf16 v[32:35], a[112:115], a[224:227], v[32:35]
    s_waitcnt vmcnt(20) lgkmcnt(0)
    v_cvt_pk_bf16_f32 v8, v14, v8
    v_lshlrev_b32 v14, 16, v9
    v_mfma_f32_16x16x32_bf16 v[32:35], a[128:131], a[236:239], v[32:35]
    s_waitcnt vmcnt(16)
    v_lshlrev_b32 v15, 16, v13
    v_and_b32 v9, s34, v9
    v_mfma_f32_16x16x32_bf16 v[32:35], a[176:179], a[240:243], v[32:35]
    s_waitcnt vmcnt(12)
    v_and_b32 v13, s34, v13
    v_add_f32 v14, v14, v15
    v_mfma_f32_16x16x32_bf16 v[32:35], a[160:163], a[232:235], v[32:35]
    s_waitcnt vmcnt(8)
    v_add_f32 v9, v9, v13
    v_cvt_pk_bf16_f32 v9, v14, v9
    v_mfma_f32_16x16x32_bf16 v[32:35], a[144:147], a[212:215], v[32:35]
    s_waitcnt vmcnt(7)
    ds_write_b128 v2, v[6:9] offset:2048
    v_mfma_f32_16x16x32_bf16 v[36:39], a[148:151], a[212:215], v[36:39]
    buffer_load_dwordx4 a[52:55], v3, s[44:47], 0 offen offset:2048 sc1
    v_add_u32 v2, 4096, v2
    v_mfma_f32_16x16x32_bf16 v[36:39], a[164:167], a[232:235], v[36:39]
    ds_read_b128 v[6:9], v2 offset:20480
    ds_read_b128 v[10:13], v2 offset:61440
    v_mfma_f32_16x16x32_bf16 v[36:39], a[180:183], a[240:243], v[36:39]
    v_fma_f32 v177, s31, v177, v5
    v_fma_f32 v178, s31, v178, v5
    v_mfma_f32_16x16x32_bf16 v[36:39], a[132:135], a[236:239], v[36:39]
    v_fma_f32 v179, s31, v179, v5
    v_fma_f32 v180, s31, v180, v5
    v_mfma_f32_16x16x32_bf16 v[36:39], a[116:119], a[224:227], v[36:39]
    ds_read_b128 a[208:211], v0 offset:8192
    v_fma_f32 v181, s31, v181, v5
    v_mfma_f32_16x16x32_bf16 v[36:39], a[100:103], a[228:231], v[36:39]
    buffer_load_dwordx4 a[36:39], v3, s[44:47], 0 offen offset:1024 sc1
    ds_read_b128 a[248:251], v1 offset:8192
    v_mfma_f32_16x16x32_bf16 v[40:43], a[104:107], a[228:231], v[40:43]
    v_fma_f32 v182, s31, v182, v5
    v_fma_f32 v183, s31, v183, v5
    v_mfma_f32_16x16x32_bf16 v[40:43], a[120:123], a[224:227], v[40:43]
    v_mul_f32 v184, s32, v184
    v_mul_f32 v185, s32, v185
    v_mfma_f32_16x16x32_bf16 v[40:43], a[136:139], a[236:239], v[40:43]
    v_mul_f32 v186, s32, v186
    v_mul_f32 v187, s32, v187
    v_mfma_f32_16x16x32_bf16 v[40:43], a[184:187], a[240:243], v[40:43]
    v_mul_f32 v188, s32, v188
    v_mul_f32 v189, s32, v189
    v_mfma_f32_16x16x32_bf16 v[40:43], a[168:171], a[232:235], v[40:43]
    s_waitcnt vmcnt(8)
    v_mul_f32 v190, s32, v190
    v_mul_f32 v191, s32, v191
    v_mfma_f32_16x16x32_bf16 v[40:43], a[152:155], a[212:215], v[40:43]
    s_waitcnt vmcnt(7)
    buffer_load_dwordx4 a[40:43], v3, s[44:47], 0 offen offset:3072 sc1
    v_fma_f32 v192, s31, v192, v5
    v_mfma_f32_16x16x32_bf16 v[44:47], a[156:159], a[212:215], v[44:47]
    s_waitcnt lgkmcnt(3)
    v_lshlrev_b32 v14, 16, v6
    v_fma_f32 v193, s31, v193, v5
    v_mfma_f32_16x16x32_bf16 v[44:47], a[172:175], a[232:235], v[44:47]
    s_waitcnt lgkmcnt(2)
    v_lshlrev_b32 v15, 16, v10
    v_and_b32 v6, s34, v6
    v_mfma_f32_16x16x32_bf16 v[44:47], a[188:191], a[240:243], v[44:47]
    v_add_u32 v3, 0x8000, v3
    v_and_b32 v10, s34, v10
    v_mfma_f32_16x16x32_bf16 v[44:47], a[140:143], a[236:239], v[44:47]
    v_add_f32 v14, v14, v15
    v_add_f32 v6, v6, v10
    v_mfma_f32_16x16x32_bf16 v[44:47], a[124:127], a[224:227], v[44:47]
    buffer_load_dwordx4 a[56:59], v3, s[44:47], 0 offen offset:0 sc1
    v_cvt_pk_bf16_f32 v6, v14, v6
    v_mfma_f32_16x16x32_bf16 v[44:47], a[108:111], a[228:231], v[44:47]
    v_lshlrev_b32 v14, 16, v7
    v_lshlrev_b32 v15, 16, v11
    v_mfma_f32_16x16x32_bf16 v[60:63], a[108:111], a[224:227], v[60:63]
    v_and_b32 v7, s34, v7
    v_and_b32 v11, s34, v11
    v_mfma_f32_16x16x32_bf16 v[60:63], a[124:127], a[236:239], v[60:63]
    v_add_f32 v14, v14, v15
    v_add_f32 v7, v7, v11
    v_mfma_f32_16x16x32_bf16 v[60:63], a[140:143], a[244:247], v[60:63]
    v_cvt_pk_bf16_f32 v7, v14, v7
    v_lshlrev_b32 v14, 16, v8
    v_mfma_f32_16x16x32_bf16 v[60:63], a[188:191], a[220:223], v[60:63]
    v_lshlrev_b32 v15, 16, v12
    v_and_b32 v8, s34, v8
    v_mfma_f32_16x16x32_bf16 v[60:63], a[172:175], a[240:243], v[60:63]
    buffer_load_dwordx4 a[60:63], v3, s[44:47], 0 offen offset:2048 sc1
    v_and_b32 v12, s34, v12
    v_mfma_f32_16x16x32_bf16 v[60:63], a[156:159], a[232:235], v[60:63]
    v_add_f32 v14, v14, v15
    v_add_f32 v8, v8, v12
    v_mfma_f32_16x16x32_bf16 v[56:59], a[152:155], a[232:235], v[56:59]
    v_cvt_pk_bf16_f32 v8, v14, v8
    v_lshlrev_b32 v14, 16, v9
    v_mfma_f32_16x16x32_bf16 v[56:59], a[168:171], a[240:243], v[56:59]
    v_lshlrev_b32 v15, 16, v13
    v_and_b32 v9, s34, v9
    v_mfma_f32_16x16x32_bf16 v[56:59], a[184:187], a[220:223], v[56:59]
    v_and_b32 v13, s34, v13
    v_add_f32 v14, v14, v15
    v_mfma_f32_16x16x32_bf16 v[56:59], a[136:139], a[244:247], v[56:59]
    buffer_load_dwordx4 a[44:47], v3, s[44:47], 0 offen offset:1024 sc1
    v_add_f32 v9, v9, v13
    v_mfma_f32_16x16x32_bf16 v[56:59], a[120:123], a[236:239], v[56:59]
    ds_read_b128 a[216:219], v0 offset:10240
    v_cvt_pk_bf16_f32 v9, v14, v9
    v_mfma_f32_16x16x32_bf16 v[56:59], a[104:107], a[224:227], v[56:59]
    ds_read_b128 a[252:255], v1 offset:10240
    v_fma_f32 v194, s31, v194, v5
    v_mfma_f32_16x16x32_bf16 v[52:55], a[100:103], a[224:227], v[52:55]
    ds_write_b128 v2, v[6:9] offset:0
    v_mfma_f32_16x16x32_bf16 v[52:55], a[116:119], a[236:239], v[52:55]
    v_fma_f32 v195, s31, v195, v5
    v_fma_f32 v196, s31, v196, v5
    v_mfma_f32_16x16x32_bf16 v[52:55], a[132:135], a[244:247], v[52:55]
    v_fma_f32 v197, s31, v197, v5
    v_fma_f32 v198, s31, v198, v5
    v_mfma_f32_16x16x32_bf16 v[52:55], a[180:183], a[220:223], v[52:55]
    buffer_load_dwordx4 a[64:67], v3, s[44:47], 0 offen offset:3072 sc1
    v_fma_f32 v199, s31, v199, v5
    v_mfma_f32_16x16x32_bf16 v[52:55], a[164:167], a[240:243], v[52:55]
    v_mul_f32 v200, s32, v200
    v_mul_f32 v201, s32, v201
    v_mfma_f32_16x16x32_bf16 v[52:55], a[148:151], a[232:235], v[52:55]
    v_mul_f32 v202, s32, v202
    v_mul_f32 v203, s32, v203
    v_mfma_f32_16x16x32_bf16 v[48:51], a[144:147], a[232:235], v[48:51]
    v_mul_f32 v204, s32, v204
    v_mul_f32 v205, s32, v205
    v_mfma_f32_16x16x32_bf16 v[48:51], a[160:163], a[240:243], v[48:51]
    v_mul_f32 v206, s32, v206
    v_mul_f32 v207, s32, v207
    v_mfma_f32_16x16x32_bf16 v[48:51], a[176:179], a[220:223], v[48:51]
    buffer_load_dword a206, off, s[48:51], 0 offset:8 sc1
    v_mfma_f32_16x16x32_bf16 v[48:51], a[128:131], a[244:247], v[48:51]
    v_fma_f32 v208, s31, v208, v5
    v_fma_f32 v209, s31, v209, v5
    v_mfma_f32_16x16x32_bf16 v[48:51], a[112:115], a[236:239], v[48:51]
    v_fma_f32 v210, s31, v210, v5
    v_fma_f32 v211, s31, v211, v5
    v_mfma_f32_16x16x32_bf16 v[48:51], a[96:99], a[224:227], v[48:51]
    v_add_u32 v3, 0x8000, v3
    v_fma_f32 v212, s31, v212, v5
    v_mfma_f32_16x16x32_bf16 v[64:67], a[96:99], a[236:239], v[64:67]
    v_fma_f32 v213, s31, v213, v5
    v_fma_f32 v214, s31, v214, v5
    v_mfma_f32_16x16x32_bf16 v[64:67], a[112:115], a[244:247], v[64:67]
    s_waitcnt lgkmcnt(0)
    buffer_load_dwordx4 a[80:83], v3, s[44:47], 0 offen offset:0 sc1
    v_fma_f32 v215, s31, v215, v5
    v_mfma_f32_16x16x32_bf16 v[64:67], a[128:131], a[208:211], v[64:67]
    v_mul_f32 v216, s32, v216
    v_mul_f32 v217, s32, v217
    v_mfma_f32_16x16x32_bf16 v[64:67], a[176:179], a[248:251], v[64:67]
    v_mul_f32 v218, s32, v218
    v_mul_f32 v219, s32, v219
    v_mfma_f32_16x16x32_bf16 v[64:67], a[160:163], a[220:223], v[64:67]
    v_mul_f32 v220, s32, v220
    v_mul_f32 v221, s32, v221
    v_mfma_f32_16x16x32_bf16 v[64:67], a[144:147], a[240:243], v[64:67]
    v_mul_f32 v222, s32, v222
    v_mul_f32 v223, s32, v223
    v_mfma_f32_16x16x32_bf16 v[68:71], a[148:151], a[240:243], v[68:71]
    v_fma_f32 v224, s31, v224, v5
    v_fma_f32 v225, s31, v225, v5
    v_mfma_f32_16x16x32_bf16 v[68:71], a[164:167], a[220:223], v[68:71]
    buffer_load_dwordx4 a[84:87], v3, s[44:47], 0 offen offset:2048 sc1
    v_fma_f32 v226, s31, v226, v5
    v_mfma_f32_16x16x32_bf16 v[68:71], a[180:183], a[248:251], v[68:71]
    v_fma_f32 v227, s31, v227, v5
    v_fma_f32 v228, s31, v228, v5
    v_mfma_f32_16x16x32_bf16 v[68:71], a[132:135], a[208:211], v[68:71]
    v_fma_f32 v229, s31, v229, v5
    v_fma_f32 v230, s31, v230, v5
    v_mfma_f32_16x16x32_bf16 v[68:71], a[116:119], a[244:247], v[68:71]
    ds_read_b128 a[212:215], v0 offset:12288
    v_fma_f32 v231, s31, v231, v5
    v_mfma_f32_16x16x32_bf16 v[68:71], a[100:103], a[236:239], v[68:71]
    ds_read_b128 a[228:231], v1 offset:12288
    v_mul_f32 v232, s32, v232
    v_mfma_f32_16x16x32_bf16 v[72:75], a[104:107], a[236:239], v[72:75]
    buffer_load_dwordx4 a[68:71], v3, s[44:47], 0 offen offset:1024 sc1
    v_mul_f32 v233, s32, v233
    v_mfma_f32_16x16x32_bf16 v[72:75], a[120:123], a[244:247], v[72:75]
    v_mul_f32 v234, s32, v234
    v_mul_f32 v235, s32, v235
    v_mfma_f32_16x16x32_bf16 v[72:75], a[136:139], a[208:211], v[72:75]
    v_mul_f32 v236, s32, v236
    v_mul_f32 v237, s32, v237
    v_mfma_f32_16x16x32_bf16 v[72:75], a[184:187], a[248:251], v[72:75]
    v_mul_f32 v238, s32, v238
    v_mul_f32 v239, s32, v239
    v_mfma_f32_16x16x32_bf16 v[72:75], a[168:171], a[220:223], v[72:75]
    v_fma_f32 v240, s31, v240, v5
    v_fma_f32 v241, s31, v241, v5
    v_mfma_f32_16x16x32_bf16 v[72:75], a[152:155], a[240:243], v[72:75]
    v_fma_f32 v242, s31, v242, v5
    v_fma_f32 v243, s31, v243, v5
    v_mfma_f32_16x16x32_bf16 v[76:79], a[156:159], a[240:243], v[76:79]
    buffer_load_dwordx4 a[72:75], v3, s[44:47], 0 offen offset:3072 sc1
    v_fma_f32 v244, s31, v244, v5
    v_mfma_f32_16x16x32_bf16 v[76:79], a[172:175], a[220:223], v[76:79]
    v_fma_f32 v245, s31, v245, v5
    v_fma_f32 v246, s31, v246, v5
    v_mfma_f32_16x16x32_bf16 v[76:79], a[188:191], a[248:251], v[76:79]
    v_fma_f32 v247, s31, v247, v5
    v_mul_f32 v248, s32, v248
    v_mfma_f32_16x16x32_bf16 v[76:79], a[140:143], a[208:211], v[76:79]
    v_add_u32 v3, 0x8000, v3
    v_mul_f32 v249, s32, v249
    v_mfma_f32_16x16x32_bf16 v[76:79], a[124:127], a[244:247], v[76:79]
    v_mul_f32 v250, s32, v250
    v_mul_f32 v251, s32, v251
    v_mfma_f32_16x16x32_bf16 v[76:79], a[108:111], a[236:239], v[76:79]
    buffer_load_dwordx4 a[88:91], v3, s[44:47], 0 offen offset:0 sc1
    v_mul_f32 v252, s32, v252
    v_mfma_f32_16x16x32_bf16 v[92:95], a[108:111], a[244:247], v[92:95]
    v_mul_f32 v253, s32, v253
    v_mul_f32 v254, s32, v254
    v_mfma_f32_16x16x32_bf16 v[92:95], a[124:127], a[208:211], v[92:95]
    v_mul_f32 v255, s32, v255
    v_fmac_f32 v160, s31, v32
    v_mfma_f32_16x16x32_bf16 v[92:95], a[140:143], a[216:219], v[92:95]
    v_fmac_f32 v161, s31, v33
    v_fmac_f32 v162, s31, v34
    v_mfma_f32_16x16x32_bf16 v[92:95], a[188:191], a[252:255], v[92:95]
    v_fmac_f32 v163, s31, v35
    v_fma_f32 v32, s31, v32, v176
    v_mfma_f32_16x16x32_bf16 v[92:95], a[172:175], a[248:251], v[92:95]
    v_fma_f32 v33, s31, v33, v177
    v_fma_f32 v34, s31, v34, v178
    v_mfma_f32_16x16x32_bf16 v[92:95], a[156:159], a[220:223], v[92:95]
    buffer_load_dwordx4 a[92:95], v3, s[44:47], 0 offen offset:2048 sc1
    v_fma_f32 v35, s31, v35, v179
    v_mfma_f32_16x16x32_bf16 v[88:91], a[152:155], a[220:223], v[88:91]
    v_fmac_f32 v168, s32, v40
    v_fmac_f32 v169, s32, v41
    v_mfma_f32_16x16x32_bf16 v[88:91], a[168:171], a[248:251], v[88:91]
    v_fmac_f32 v170, s32, v42
    v_fmac_f32 v171, s32, v43
    v_mfma_f32_16x16x32_bf16 v[88:91], a[184:187], a[252:255], v[88:91]
    v_fma_f32 v40, -s32, v40, -v184
    v_fma_f32 v41, -s32, v41, -v185
    v_mfma_f32_16x16x32_bf16 v[88:91], a[136:139], a[216:219], v[88:91]
    v_fma_f32 v42, -s32, v42, -v186
    v_fma_f32 v43, -s32, v43, -v187
    v_mfma_f32_16x16x32_bf16 v[88:91], a[120:123], a[208:211], v[88:91]
    buffer_load_dwordx4 a[76:79], v3, s[44:47], 0 offen offset:1024 sc1
    ds_read_b128 a[232:235], v0 offset:14336
    v_mfma_f32_16x16x32_bf16 v[88:91], a[104:107], a[244:247], v[88:91]
    ds_read_b128 a[224:227], v1 offset:14336
    v_fmac_f32 v164, s31, v36
    v_mfma_f32_16x16x32_bf16 v[84:87], a[100:103], a[244:247], v[84:87]
    v_fmac_f32 v165, s31, v37
    v_fmac_f32 v166, s31, v38
    v_mfma_f32_16x16x32_bf16 v[84:87], a[116:119], a[208:211], v[84:87]
    v_fmac_f32 v167, s31, v39
    v_fma_f32 v36, s31, v36, v180
    v_mfma_f32_16x16x32_bf16 v[84:87], a[132:135], a[216:219], v[84:87]
    v_fma_f32 v37, s31, v37, v181
    v_fma_f32 v38, s31, v38, v182
    v_mfma_f32_16x16x32_bf16 v[84:87], a[180:183], a[252:255], v[84:87]
    v_fma_f32 v39, s31, v39, v183
    v_fmac_f32 v172, s32, v44
    v_mfma_f32_16x16x32_bf16 v[84:87], a[164:167], a[248:251], v[84:87]
    v_fmac_f32 v173, s32, v45
    v_fmac_f32 v174, s32, v46
    v_mfma_f32_16x16x32_bf16 v[84:87], a[148:151], a[220:223], v[84:87]
    v_fmac_f32 v175, s32, v47
    v_fma_f32 v44, -s32, v44, -v188
    v_mfma_f32_16x16x32_bf16 v[80:83], a[144:147], a[220:223], v[80:83]
    v_fma_f32 v45, -s32, v45, -v189
    v_fma_f32 v46, -s32, v46, -v190
    v_mfma_f32_16x16x32_bf16 v[80:83], a[160:163], a[248:251], v[80:83]
    v_fma_f32 v47, -s32, v47, -v191
    v_fmac_f32 v176, s31, v48
    v_mfma_f32_16x16x32_bf16 v[80:83], a[176:179], a[252:255], v[80:83]
    v_mfma_f32_16x16x32_bf16 v[80:83], a[128:131], a[216:219], v[80:83]
    v_mfma_f32_16x16x32_bf16 v[80:83], a[112:115], a[208:211], v[80:83]
    v_mfma_f32_16x16x32_bf16 v[80:83], a[96:99], a[244:247], v[80:83]
    s_waitcnt vmcnt(7) lgkmcnt(1)
    v_accvgpr_read_b32 v15, a206
    v_cmp_gt_u32 vcc, 4, v15
    v_mfma_f32_16x16x32_bf16 v[96:99], a[96:99], a[208:211], v[96:99]
    s_nop 0
    s_nop 0
    s_cbranch_vccnz L_spin2
L_back2:
    v_mfma_f32_16x16x32_bf16 v[96:99], a[112:115], a[216:219], v[96:99]
    v_fmac_f32 v177, s31, v49
    v_fmac_f32 v178, s31, v50
    v_mfma_f32_16x16x32_bf16 v[96:99], a[128:131], a[212:215], v[96:99]
    v_fmac_f32 v179, s31, v51
    v_fma_f32 v48, s31, v48, v192
    v_mfma_f32_16x16x32_bf16 v[96:99], a[176:179], a[228:231], v[96:99]
    v_fma_f32 v49, s31, v49, v193
    v_fma_f32 v50, s31, v50, v194
    v_mfma_f32_16x16x32_bf16 v[96:99], a[160:163], a[252:255], v[96:99]
    v_fma_f32 v51, s31, v51, v195
    v_fmac_f32 v184, s32, v56
    v_mfma_f32_16x16x32_bf16 v[96:99], a[144:147], a[248:251], v[96:99]
    v_fmac_f32 v185, s32, v57
    v_fmac_f32 v186, s32, v58
    v_mfma_f32_16x16x32_bf16 v[100:103], a[148:151], a[248:251], v[100:103]
    v_fmac_f32 v187, s32, v59
    v_fma_f32 v56, -s32, v56, -v200
    v_mfma_f32_16x16x32_bf16 v[100:103], a[164:167], a[252:255], v[100:103]
    v_fma_f32 v57, -s32, v57, -v201
    v_fma_f32 v58, -s32, v58, -v202
    v_mfma_f32_16x16x32_bf16 v[100:103], a[180:183], a[228:231], v[100:103]
    v_fma_f32 v59, -s32, v59, -v203
    v_fmac_f32 v180, s31, v52
    v_mfma_f32_16x16x32_bf16 v[100:103], a[132:135], a[212:215], v[100:103]
    v_fmac_f32 v181, s31, v53
    v_fmac_f32 v182, s31, v54
    v_mfma_f32_16x16x32_bf16 v[100:103], a[116:119], a[216:219], v[100:103]
    ds_read_b128 a[240:243], v0 offset:16384
    v_fmac_f32 v183, s31, v55
    v_mfma_f32_16x16x32_bf16 v[100:103], a[100:103], a[208:211], v[100:103]
    ds_read_b128 a[236:239], v1 offset:16384
    v_fma_f32 v52, s31, v52, v196
    v_mfma_f32_16x16x32_bf16 v[104:107], a[104:107], a[208:211], v[104:107]
    v_fma_f32 v53, s31, v53, v197
    v_fma_f32 v54, s31, v54, v198
    v_mfma_f32_16x16x32_bf16 v[104:107], a[120:123], a[216:219], v[104:107]
    v_fma_f32 v55, s31, v55, v199
    v_fmac_f32 v188, s32, v60
    v_mfma_f32_16x16x32_bf16 v[104:107], a[136:139], a[212:215], v[104:107]
    v_fmac_f32 v189, s32, v61
    v_fmac_f32 v190, s32, v62
    v_mfma_f32_16x16x32_bf16 v[104:107], a[184:187], a[228:231], v[104:107]
    v_fmac_f32 v191, s32, v63
    v_fma_f32 v60, -s32, v60, -v204
    v_mfma_f32_16x16x32_bf16 v[104:107], a[168:171], a[252:255], v[104:107]
    v_fma_f32 v61, -s32, v61, -v205
    v_fma_f32 v62, -s32, v62, -v206
    v_mfma_f32_16x16x32_bf16 v[104:107], a[152:155], a[248:251], v[104:107]
    v_fma_f32 v63, -s32, v63, -v207
    v_fmac_f32 v192, s31, v64
    v_mfma_f32_16x16x32_bf16 v[108:111], a[156:159], a[248:251], v[108:111]
    v_fmac_f32 v193, s31, v65
    v_fmac_f32 v194, s31, v66
    v_mfma_f32_16x16x32_bf16 v[108:111], a[172:175], a[252:255], v[108:111]
    v_fmac_f32 v195, s31, v67
    v_fma_f32 v64, s31, v64, v208
    v_mfma_f32_16x16x32_bf16 v[108:111], a[188:191], a[228:231], v[108:111]
    v_fma_f32 v65, s31, v65, v209
    v_fma_f32 v66, s31, v66, v210
    v_mfma_f32_16x16x32_bf16 v[108:111], a[140:143], a[212:215], v[108:111]
    v_fma_f32 v67, s31, v67, v211
    v_fmac_f32 v200, s32, v72
    v_mfma_f32_16x16x32_bf16 v[108:111], a[124:127], a[216:219], v[108:111]
    v_fmac_f32 v201, s32, v73
    v_fmac_f32 v202, s32, v74
    v_mfma_f32_16x16x32_bf16 v[108:111], a[108:111], a[208:211], v[108:111]
    v_fmac_f32 v203, s32, v75
    v_fma_f32 v72, -s32, v72, -v216
    v_mfma_f32_16x16x32_bf16 v[124:127], a[108:111], a[216:219], v[124:127]
    v_fma_f32 v73, -s32, v73, -v217
    v_fma_f32 v74, -s32, v74, -v218
    v_mfma_f32_16x16x32_bf16 v[124:127], a[124:127], a[212:215], v[124:127]
    v_fma_f32 v75, -s32, v75, -v219
    v_fmac_f32 v196, s31, v68
    v_mfma_f32_16x16x32_bf16 v[124:127], a[140:143], a[232:235], v[124:127]
    s_waitcnt lgkmcnt(0)
    v_fmac_f32 v197, s31, v69
    v_fmac_f32 v198, s31, v70
    v_mfma_f32_16x16x32_bf16 v[124:127], a[188:191], a[224:227], v[124:127]
    v_fmac_f32 v199, s31, v71
    v_fma_f32 v68, s31, v68, v212
    v_mfma_f32_16x16x32_bf16 v[124:127], a[172:175], a[228:231], v[124:127]
    v_fma_f32 v69, s31, v69, v213
    v_fma_f32 v70, s31, v70, v214
    v_mfma_f32_16x16x32_bf16 v[124:127], a[156:159], a[252:255], v[124:127]
    v_fma_f32 v71, s31, v71, v215
    v_fmac_f32 v204, s32, v76
    v_mfma_f32_16x16x32_bf16 v[120:123], a[152:155], a[252:255], v[120:123]
    v_fmac_f32 v205, s32, v77
    v_fmac_f32 v206, s32, v78
    v_mfma_f32_16x16x32_bf16 v[120:123], a[168:171], a[228:231], v[120:123]
    v_fmac_f32 v207, s32, v79
    v_fma_f32 v76, -s32, v76, -v220
    v_mfma_f32_16x16x32_bf16 v[120:123], a[184:187], a[224:227], v[120:123]
    v_fma_f32 v77, -s32, v77, -v221
    v_fma_f32 v78, -s32, v78, -v222
    v_mfma_f32_16x16x32_bf16 v[120:123], a[136:139], a[232:235], v[120:123]
    v_fma_f32 v79, -s32, v79, -v223
    v_fmac_f32 v208, s31, v80
    v_mfma_f32_16x16x32_bf16 v[120:123], a[120:123], a[212:215], v[120:123]
    ds_read_b128 a[220:223], v0 offset:18432
    v_fmac_f32 v209, s31, v81
    v_mfma_f32_16x16x32_bf16 v[120:123], a[104:107], a[216:219], v[120:123]
    ds_read_b128 a[244:247], v1 offset:18432
    v_fmac_f32 v210, s31, v82
    v_mfma_f32_16x16x32_bf16 v[116:119], a[100:103], a[216:219], v[116:119]
    v_fmac_f32 v211, s31, v83
    v_fma_f32 v80, s31, v80, v224
    v_mfma_f32_16x16x32_bf16 v[116:119], a[116:119], a[212:215], v[116:119]
    v_fma_f32 v81, s31, v81, v225
    v_fma_f32 v82, s31, v82, v226
    v_mfma_f32_16x16x32_bf16 v[116:119], a[132:135], a[232:235], v[116:119]
    v_fma_f32 v83, s31, v83, v227
    v_fmac_f32 v216, s32, v88
    v_mfma_f32_16x16x32_bf16 v[116:119], a[180:183], a[224:227], v[116:119]
    v_fmac_f32 v217, s32, v89
    v_fmac_f32 v218, s32, v90
    v_mfma_f32_16x16x32_bf16 v[116:119], a[164:167], a[228:231], v[116:119]
    v_fmac_f32 v219, s32, v91
    v_fma_f32 v88, -s32, v88, -v232
    v_mfma_f32_16x16x32_bf16 v[116:119], a[148:151], a[252:255], v[116:119]
    v_fma_f32 v89, -s32, v89, -v233
    v_fma_f32 v90, -s32, v90, -v234
    v_mfma_f32_16x16x32_bf16 v[112:115], a[144:147], a[252:255], v[112:115]
    v_fma_f32 v91, -s32, v91, -v235
    v_fmac_f32 v212, s31, v84
    v_mfma_f32_16x16x32_bf16 v[112:115], a[160:163], a[228:231], v[112:115]
    v_fmac_f32 v213, s31, v85
    v_fmac_f32 v214, s31, v86
    v_mfma_f32_16x16x32_bf16 v[112:115], a[176:179], a[224:227], v[112:115]
    v_fmac_f32 v215, s31, v87
    v_fma_f32 v84, s31, v84, v228
    v_mfma_f32_16x16x32_bf16 v[112:115], a[128:131], a[232:235], v[112:115]
    v_fma_f32 v85, s31, v85, v229
    v_fma_f32 v86, s31, v86, v230
    v_mfma_f32_16x16x32_bf16 v[112:115], a[112:115], a[212:215], v[112:115]
    v_fma_f32 v87, s31, v87, v231
    v_fmac_f32 v220, s32, v92
    v_mfma_f32_16x16x32_bf16 v[112:115], a[96:99], a[216:219], v[112:115]
    v_fmac_f32 v221, s32, v93
    v_fmac_f32 v222, s32, v94
    v_mfma_f32_16x16x32_bf16 v[128:131], a[96:99], a[212:215], v[128:131]
    v_fmac_f32 v223, s32, v95
    v_fma_f32 v92, -s32, v92, -v236
    v_mfma_f32_16x16x32_bf16 v[128:131], a[112:115], a[232:235], v[128:131]
    v_fma_f32 v93, -s32, v93, -v237
    v_fma_f32 v94, -s32, v94, -v238
    v_mfma_f32_16x16x32_bf16 v[128:131], a[128:131], a[240:243], v[128:131]
    v_fma_f32 v95, -s32, v95, -v239
    v_fmac_f32 v224, s31, v96
    v_mfma_f32_16x16x32_bf16 v[128:131], a[176:179], a[236:239], v[128:131]
    v_fmac_f32 v225, s31, v97
    v_fmac_f32 v226, s31, v98
    v_mfma_f32_16x16x32_bf16 v[128:131], a[160:163], a[224:227], v[128:131]
    v_fmac_f32 v227, s31, v99
    v_fma_f32 v96, s31, v96, v240
    v_mfma_f32_16x16x32_bf16 v[128:131], a[144:147], a[228:231], v[128:131]
    v_fma_f32 v97, s31, v97, v241
    v_fma_f32 v98, s31, v98, v242
    v_mfma_f32_16x16x32_bf16 v[132:135], a[148:151], a[228:231], v[132:135]
    v_fma_f32 v99, s31, v99, v243
    v_fmac_f32 v232, s32, v104
    v_mfma_f32_16x16x32_bf16 v[132:135], a[164:167], a[224:227], v[132:135]
    v_add_u32 v0, 0xffff1000, v0
    v_add_u32 v1, 0xffff1000, v1
    v_mfma_f32_16x16x32_bf16 v[132:135], a[180:183], a[236:239], v[132:135]
    ds_read_b128 a[248:251], v0 offset:0
    v_fmac_f32 v233, s32, v105
    v_mfma_f32_16x16x32_bf16 v[132:135], a[132:135], a[240:243], v[132:135]
    ds_read_b128 a[208:211], v0 offset:2048
    v_fmac_f32 v234, s32, v106
    v_mfma_f32_16x16x32_bf16 v[132:135], a[116:119], a[232:235], v[132:135]
    ds_read_b128 a[252:255], v0 offset:4096
    v_fmac_f32 v235, s32, v107
    v_mfma_f32_16x16x32_bf16 v[132:135], a[100:103], a[212:215], v[132:135]
    v_fma_f32 v104, -s32, v104, -v248
    v_fma_f32 v105, -s32, v105, -v249
    v_mfma_f32_16x16x32_bf16 v[136:139], a[104:107], a[212:215], v[136:139]
    v_fma_f32 v106, -s32, v106, -v250
    v_fma_f32 v107, -s32, v107, -v251
    v_mfma_f32_16x16x32_bf16 v[136:139], a[120:123], a[232:235], v[136:139]
    v_fmac_f32 v228, s31, v100
    v_fmac_f32 v229, s31, v101
    v_mfma_f32_16x16x32_bf16 v[136:139], a[136:139], a[240:243], v[136:139]
    v_fmac_f32 v230, s31, v102
    v_fmac_f32 v231, s31, v103
    v_mfma_f32_16x16x32_bf16 v[136:139], a[184:187], a[236:239], v[136:139]
    v_fma_f32 v100, s31, v100, v244
    v_fma_f32 v101, s31, v101, v245
    v_mfma_f32_16x16x32_bf16 v[136:139], a[168:171], a[224:227], v[136:139]
    v_fma_f32 v102, s31, v102, v246
    v_fma_f32 v103, s31, v103, v247
    v_mfma_f32_16x16x32_bf16 v[136:139], a[152:155], a[228:231], v[136:139]
    v_fmac_f32 v236, s32, v108
    v_fmac_f32 v237, s32, v109
    v_mfma_f32_16x16x32_bf16 v[140:143], a[156:159], a[228:231], v[140:143]
    v_fmac_f32 v238, s32, v110
    v_fmac_f32 v239, s32, v111
    v_mfma_f32_16x16x32_bf16 v[140:143], a[172:175], a[224:227], v[140:143]
    v_fma_f32 v108, -s32, v108, -v252
    v_fma_f32 v109, -s32, v109, -v253
    v_mfma_f32_16x16x32_bf16 v[140:143], a[188:191], a[236:239], v[140:143]
    ds_read_b128 a[216:219], v1 offset:0
    v_fma_f32 v110, -s32, v110, -v254
    v_mfma_f32_16x16x32_bf16 v[140:143], a[140:143], a[240:243], v[140:143]
    ds_read_b128 a[228:231], v1 offset:2048
    v_fma_f32 v111, -s32, v111, -v255
    v_mfma_f32_16x16x32_bf16 v[140:143], a[124:127], a[232:235], v[140:143]
    v_exp_f32 v168, v168
    v_mfma_f32_16x16x32_bf16 v[140:143], a[108:111], a[212:215], v[140:143]
    ds_read_b128 a[212:215], v1 offset:4096
    v_mfma_f32_16x16x32_bf16 v[144:147], a[96:99], a[232:235], v[144:147]
    buffer_load_dwordx4 a[96:99], v3, s[44:47], 0 offen offset:3072 sc1
    v_mfma_f32_16x16x32_bf16 v[144:147], a[112:115], a[240:243], v[144:147]
    s_waitcnt lgkmcnt(3)
    v_exp_f32 v169, v169
    v_mfma_f32_16x16x32_bf16 v[144:147], a[128:131], a[220:223], v[144:147]
    v_exp_f32 v160, v160 clamp
    v_mfma_f32_16x16x32_bf16 v[144:147], a[176:179], a[244:247], v[144:147]
    v_add_u32 v3, 0x8000, v3
    v_mfma_f32_16x16x32_bf16 v[144:147], a[160:163], a[236:239], v[144:147]
    v_exp_f32 v161, v161 clamp
    v_mfma_f32_16x16x32_bf16 v[144:147], a[144:147], a[224:227], v[144:147]
    buffer_load_dwordx4 a[112:115], v3, s[44:47], 0 offen offset:0 sc1
    v_fma_f32 v160, v160, s33, 0.5
    v_mfma_f32_16x16x32_bf16 v[148:151], a[148:151], a[224:227], v[148:151]
    v_exp_f32 v170, v170
    v_mfma_f32_16x16x32_bf16 v[148:151], a[164:167], a[236:239], v[148:151]
    v_exp_f32 v171, v171
    v_mfma_f32_16x16x32_bf16 v[148:151], a[180:183], a[244:247], v[148:151]
    v_exp_f32 v162, v162 clamp
    v_mfma_f32_16x16x32_bf16 v[148:151], a[132:135], a[220:223], v[148:151]
    v_exp_f32 v163, v163 clamp
    v_mfma_f32_16x16x32_bf16 v[148:151], a[116:119], a[240:243], v[148:151]
    v_exp_f32 v172, v172
    v_mfma_f32_16x16x32_bf16 v[148:151], a[100:103], a[232:235], v[148:151]
    buffer_load_dwordx4 a[128:131], v3, s[44:47], 0 offen offset:2048 sc1
    v_fma_f32 v161, v161, s33, 0.5
    v_mfma_f32_16x16x32_bf16 v[152:155], a[104:107], a[232:235], v[152:155]
    v_exp_f32 v173, v173
    v_mfma_f32_16x16x32_bf16 v[152:155], a[120:123], a[240:243], v[152:155]
    v_exp_f32 v164, v164 clamp
    v_mfma_f32_16x16x32_bf16 v[152:155], a[136:139], a[220:223], v[152:155]
    v_exp_f32 v165, v165 clamp
    v_mfma_f32_16x16x32_bf16 v[152:155], a[184:187], a[244:247], v[152:155]
    v_exp_f32 v174, v174
    v_mfma_f32_16x16x32_bf16 v[152:155], a[168:171], a[236:239], v[152:155]
    buffer_load_dwordx4 a[176:179], v3, s[44:47], 0 offen offset:1024 sc1
    v_fma_f32 v168, v160, v168, v160
    v_mfma_f32_16x16x32_bf16 v[152:155], a[152:155], a[224:227], v[152:155]
    v_exp_f32 v175, v175
    v_mfma_f32_16x16x32_bf16 v[156:159], a[156:159], a[224:227], v[156:159]
    ds_read_b128 a[224:227], v0 offset:6144
    v_fma_f32 v169, v161, v169, v161
    v_mfma_f32_16x16x32_bf16 v[156:159], a[172:175], a[236:239], v[156:159]
    ds_read_b128 a[236:239], v1 offset:6144
    v_fma_f32 v162, v162, s33, 0.5
    v_mfma_f32_16x16x32_bf16 v[156:159], a[188:191], a[244:247], v[156:159]
    v_rcp_f32 v168, v168
    v_mfma_f32_16x16x32_bf16 v[156:159], a[140:143], a[220:223], v[156:159]
    v_rcp_f32 v169, v169
    v_mfma_f32_16x16x32_bf16 v[156:159], a[124:127], a[240:243], v[156:159]
    buffer_load_dwordx4 a[160:163], v3, s[44:47], 0 offen offset:3072 sc1
    v_fma_f32 v168, -v160, v168, v168
    v_mfma_f32_16x16x32_bf16 v[156:159], a[108:111], a[232:235], v[156:159]
    v_exp_f32 v166, v166 clamp
    v_mfma_f32_16x16x32_bf16 v[32:35], a[192:195], a[248:251], v[32:35]
    v_exp_f32 v167, v167 clamp
    v_mfma_f32_16x16x32_bf16 v[32:35], a[48:51], a[208:211], v[32:35]
    v_add_u32 v3, 0x8000, v3
    v_fma_f32 v169, -v161, v169, v169
    v_mfma_f32_16x16x32_bf16 v[32:35], a[56:59], a[252:255], v[32:35]
    v_fma_f32 v163, v163, s33, 0.5
    v_fma_f32 v170, v162, v170, v162
    v_mfma_f32_16x16x32_bf16 v[40:43], a[196:199], a[248:251], v[40:43]
    buffer_load_dwordx4 a[144:147], v3, s[44:47], 0 offen offset:0 sc1
    v_fma_f32 v171, v163, v171, v163
    v_mfma_f32_16x16x32_bf16 v[40:43], a[52:55], a[208:211], v[40:43]
    v_rcp_f32 v170, v170
    v_mfma_f32_16x16x32_bf16 v[40:43], a[60:63], a[252:255], v[40:43]
    v_rcp_f32 v171, v171
    v_mfma_f32_16x16x32_bf16 v[36:39], a[200:203], a[248:251], v[36:39]
    v_fma_f32 v170, -v162, v170, v170
    v_fma_f32 v171, -v163, v171, v171
    v_mfma_f32_16x16x32_bf16 v[36:39], a[36:39], a[208:211], v[36:39]
    v_cvt_pk_bf16_f32 v160, v168, v169
    v_cvt_pk_bf16_f32 v161, v170, v171
    v_mfma_f32_16x16x32_bf16 v[36:39], a[44:47], a[252:255], v[36:39]
    v_exp_f32 v184, v184
    v_mfma_f32_16x16x32_bf16 v[44:47], a[32:35], a[248:251], v[44:47]
    buffer_load_dwordx4 a[148:151], v3, s[44:47], 0 offen offset:2048 sc1
    v_fma_f32 v164, v164, s33, 0.5
    v_mfma_f32_16x16x32_bf16 v[44:47], a[40:43], a[208:211], v[44:47]
    ds_read_b128 a[244:247], v0 offset:8192
    v_fma_f32 v165, v165, s33, 0.5
    v_mfma_f32_16x16x32_bf16 v[44:47], a[64:67], a[252:255], v[44:47]
    s_waitcnt vmcnt(7) lgkmcnt(1)
    ds_read_b128 a[220:223], v1 offset:8192
    v_fma_f32 v172, v164, v172, v164
    v_mfma_f32_16x16x32_bf16 v[32:35], a[80:83], a[216:219], v[32:35]
    v_exp_f32 v185, v185
    v_mfma_f32_16x16x32_bf16 v[32:35], a[88:91], a[228:231], v[32:35]
    s_waitcnt vmcnt(5)
    v_exp_f32 v176, v176 clamp
    v_mfma_f32_16x16x32_bf16 v[32:35], a[112:115], a[212:215], v[32:35]
    buffer_load_dwordx4 a[164:167], v3, s[44:47], 0 offen offset:1024 sc1
    v_fma_f32 v173, v165, v173, v165
    v_mfma_f32_16x16x32_bf16 v[40:43], a[84:87], a[216:219], v[40:43]
    v_rcp_f32 v172, v172
    v_mfma_f32_16x16x32_bf16 v[40:43], a[92:95], a[228:231], v[40:43]
    s_waitcnt vmcnt(5)
    v_rcp_f32 v173, v173
    v_mfma_f32_16x16x32_bf16 v[40:43], a[128:131], a[212:215], v[40:43]
    v_exp_f32 v177, v177 clamp
    v_mfma_f32_16x16x32_bf16 v[36:39], a[68:71], a[216:219], v[36:39]
    v_exp_f32 v186, v186
    v_mfma_f32_16x16x32_bf16 v[36:39], a[76:79], a[228:231], v[36:39]
    s_waitcnt vmcnt(4)
    v_exp_f32 v187, v187
    v_mfma_f32_16x16x32_bf16 v[36:39], a[176:179], a[212:215], v[36:39]
    buffer_load_dwordx4 a[180:183], v3, s[44:47], 0 offen offset:3072 sc1
    v_fma_f32 v172, -v164, v172, v172
    v_mfma_f32_16x16x32_bf16 v[44:47], a[72:75], a[216:219], v[44:47]
    v_exp_f32 v178, v178 clamp
    v_mfma_f32_16x16x32_bf16 v[44:47], a[96:99], a[228:231], v[44:47]
    s_waitcnt vmcnt(4)
    v_exp_f32 v179, v179 clamp
    v_mfma_f32_16x16x32_bf16 v[44:47], a[160:163], a[212:215], v[44:47]
    v_add_u32 v3, 0x8000, v3
    v_fma_f32 v173, -v165, v173, v173
    v_mfma_f32_16x16x32_bf16 v[60:63], a[32:35], a[208:211], v[60:63]
    v_cvt_pk_bf16_f32 v162, v172, v173
    v_fma_f32 v166, v166, s33, 0.5
    v_mfma_f32_16x16x32_bf16 v[60:63], a[40:43], a[252:255], v[60:63]
    buffer_load_dwordx4 a[132:135], v3, s[44:47], 0 offen offset:0 sc1
    v_fma_f32 v167, v167, s33, 0.5
    v_mfma_f32_16x16x32_bf16 v[60:63], a[64:67], a[224:227], v[60:63]
    v_exp_f32 v188, v188
    v_mfma_f32_16x16x32_bf16 v[60:63], a[160:163], a[236:239], v[60:63]
    v_exp_f32 v189, v189
    v_mfma_f32_16x16x32_bf16 v[60:63], a[96:99], a[212:215], v[60:63]
    v_exp_f32 v180, v180 clamp
    v_mfma_f32_16x16x32_bf16 v[60:63], a[72:75], a[228:231], v[60:63]
    v_exp_f32 v181, v181 clamp
    v_mfma_f32_16x16x32_bf16 v[52:55], a[68:71], a[228:231], v[52:55]
    v_fma_f32 v174, v166, v174, v166
    v_fma_f32 v175, v167, v175, v167
    v_mfma_f32_16x16x32_bf16 v[52:55], a[76:79], a[212:215], v[52:55]
    buffer_load_dwordx4 a[116:119], v3, s[44:47], 0 offen offset:2048 sc1
    v_fma_f32 v176, v176, s33, 0.5
    v_mfma_f32_16x16x32_bf16 v[52:55], a[176:179], a[236:239], v[52:55]
    v_rcp_f32 v174, v174
    v_mfma_f32_16x16x32_bf16 v[52:55], a[44:47], a[224:227], v[52:55]
    v_rcp_f32 v175, v175
    v_mfma_f32_16x16x32_bf16 v[52:55], a[36:39], a[252:255], v[52:55]
    ds_read_b128 a[240:243], v0 offset:10240
    v_fma_f32 v174, -v166, v174, v174
    v_mfma_f32_16x16x32_bf16 v[52:55], a[200:203], a[208:211], v[52:55]
    ds_read_b128 a[232:235], v1 offset:10240
    v_fma_f32 v175, -v167, v175, v175
    v_mfma_f32_16x16x32_bf16 v[56:59], a[196:199], a[208:211], v[56:59]
    buffer_load_dwordx4 a[100:103], v3, s[44:47], 0 offen offset:1024 sc1
    v_cvt_pk_bf16_f32 v163, v174, v175
    v_mfma_f32_16x16x32_bf16 v[56:59], a[52:55], a[252:255], v[56:59]
    v_permlane16_swap_b32 v160, v162
    v_mfma_f32_16x16x32_bf16 v[56:59], a[60:63], a[224:227], v[56:59]
    v_permlane16_swap_b32 v161, v163
    v_mfma_f32_16x16x32_bf16 v[56:59], a[128:131], a[236:239], v[56:59]
    buffer_store_dwordx4 v[160:163], v4, s[20:23], 0 offen offset:0 sc1
    v_mfma_f32_16x16x32_bf16 v[56:59], a[92:95], a[212:215], v[56:59]
    v_exp_f32 v190, v190
    v_mfma_f32_16x16x32_bf16 v[56:59], a[84:87], a[228:231], v[56:59]
    v_accvgpr_read_b32 v160, a0
    v_accvgpr_read_b32 v161, a1
    v_mfma_f32_16x16x32_bf16 v[48:51], a[80:83], a[228:231], v[48:51]
    buffer_load_dwordx4 a[104:107], v3, s[44:47], 0 offen offset:3072 sc1
    v_accvgpr_read_b32 v162, a2
    v_mfma_f32_16x16x32_bf16 v[48:51], a[88:91], a[212:215], v[48:51]
    v_accvgpr_read_b32 v163, a3
    v_fma_f32 v160, s31, v160, v5
    v_mfma_f32_16x16x32_bf16 v[48:51], a[112:115], a[236:239], v[48:51]
    v_fma_f32 v161, s31, v161, v5
    v_fma_f32 v162, s31, v162, v5
    v_mfma_f32_16x16x32_bf16 v[48:51], a[56:59], a[224:227], v[48:51]
    v_add_u32 v3, 0x8000, v3
    v_fma_f32 v163, s31, v163, v5
    v_mfma_f32_16x16x32_bf16 v[48:51], a[48:51], a[252:255], v[48:51]
    v_accvgpr_read_b32 v164, a4
    v_accvgpr_read_b32 v165, a5
    v_mfma_f32_16x16x32_bf16 v[48:51], a[192:195], a[208:211], v[48:51]
    buffer_load_dwordx4 a[120:123], v3, s[44:47], 0 offen offset:0 sc1
    v_accvgpr_read_b32 v166, a6
    v_mfma_f32_16x16x32_bf16 v[64:67], a[192:195], a[252:255], v[64:67]
    v_accvgpr_read_b32 v167, a7
    v_fma_f32 v164, s31, v164, v5
    v_mfma_f32_16x16x32_bf16 v[64:67], a[48:51], a[224:227], v[64:67]
    s_waitcnt lgkmcnt(0)
    v_fma_f32 v165, s31, v165, v5
    v_fma_f32 v166, s31, v166, v5
    v_mfma_f32_16x16x32_bf16 v[64:67], a[56:59], a[244:247], v[64:67]
    v_fma_f32 v167, s31, v167, v5
    v_accvgpr_read_b32 v168, a8
    v_mfma_f32_16x16x32_bf16 v[64:67], a[112:115], a[220:223], v[64:67]
    v_accvgpr_read_b32 v169, a9
    v_accvgpr_read_b32 v170, a10
    v_mfma_f32_16x16x32_bf16 v[64:67], a[88:91], a[236:239], v[64:67]
    v_accvgpr_read_b32 v171, a11
    v_mul_f32 v168, s32, v168
    v_mfma_f32_16x16x32_bf16 v[64:67], a[80:83], a[212:215], v[64:67]
    buffer_load_dwordx4 a[136:139], v3, s[44:47], 0 offen offset:2048 sc1
    v_mul_f32 v169, s32, v169
    v_mfma_f32_16x16x32_bf16 v[72:75], a[84:87], a[212:215], v[72:75]
    v_mul_f32 v170, s32, v170
    v_mul_f32 v171, s32, v171
    v_mfma_f32_16x16x32_bf16 v[72:75], a[92:95], a[236:239], v[72:75]
    v_accvgpr_read_b32 v172, a12
    v_accvgpr_read_b32 v173, a13
    v_mfma_f32_16x16x32_bf16 v[72:75], a[128:131], a[220:223], v[72:75]
    v_accvgpr_read_b32 v174, a14
    v_accvgpr_read_b32 v175, a15
    v_mfma_f32_16x16x32_bf16 v[72:75], a[60:63], a[244:247], v[72:75]
    v_mul_f32 v172, s32, v172
    v_mul_f32 v173, s32, v173
    v_mfma_f32_16x16x32_bf16 v[72:75], a[52:55], a[224:227], v[72:75]
    buffer_load_dwordx4 a[184:187], v3, s[44:47], 0 offen offset:1024 sc1
    ds_read_b128 a[248:251], v0 offset:12288
    v_mfma_f32_16x16x32_bf16 v[72:75], a[196:199], a[252:255], v[72:75]
    ds_read_b128 a[216:219], v1 offset:12288
    v_mul_f32 v174, s32, v174
    v_mfma_f32_16x16x32_bf16 v[68:71], a[200:203], a[252:255], v[68:71]
    v_mul_f32 v175, s32, v175
    v_fmac_f32 v240, s31, v112
    v_mfma_f32_16x16x32_bf16 v[68:71], a[36:39], a[224:227], v[68:71]
    v_fmac_f32 v241, s31, v113
    v_fmac_f32 v242, s31, v114
    v_mfma_f32_16x16x32_bf16 v[68:71], a[44:47], a[244:247], v[68:71]
    v_fmac_f32 v243, s31, v115
    v_fma_f32 v112, s31, v112, v160
    v_mfma_f32_16x16x32_bf16 v[68:71], a[176:179], a[220:223], v[68:71]
    v_fma_f32 v113, s31, v113, v161
    v_fma_f32 v114, s31, v114, v162
    v_mfma_f32_16x16x32_bf16 v[68:71], a[76:79], a[236:239], v[68:71]
    buffer_load_dwordx4 a[168:171], v3, s[44:47], 0 offen offset:3072 sc1
    v_fma_f32 v115, s31, v115, v163
    v_mfma_f32_16x16x32_bf16 v[68:71], a[68:71], a[212:215], v[68:71]
    v_fmac_f32 v248, s32, v120
    v_fmac_f32 v249, s32, v121
    v_mfma_f32_16x16x32_bf16 v[76:79], a[72:75], a[212:215], v[76:79]
    v_fmac_f32 v250, s32, v122
    v_fmac_f32 v251, s32, v123
    v_mfma_f32_16x16x32_bf16 v[76:79], a[96:99], a[236:239], v[76:79]
    v_fma_f32 v120, -s32, v120, -v168
    v_fma_f32 v121, -s32, v121, -v169
    v_mfma_f32_16x16x32_bf16 v[76:79], a[160:163], a[220:223], v[76:79]
    v_fma_f32 v122, -s32, v122, -v170
    v_fma_f32 v123, -s32, v123, -v171
    v_mfma_f32_16x16x32_bf16 v[76:79], a[64:67], a[244:247], v[76:79]
    buffer_load_dword a207, off, s[48:51], 0 offset:12 sc1
    v_mfma_f32_16x16x32_bf16 v[76:79], a[40:43], a[224:227], v[76:79]
    v_fmac_f32 v244, s31, v116
    v_fmac_f32 v245, s31, v117
    v_mfma_f32_16x16x32_bf16 v[76:79], a[32:35], a[252:255], v[76:79]
    v_fmac_f32 v246, s31, v118
    v_fmac_f32 v247, s31, v119
    v_mfma_f32_16x16x32_bf16 v[92:95], a[32:35], a[224:227], v[92:95]
    v_add_u32 v3, 0x8000, v3
    v_fma_f32 v116, s31, v116, v164
    v_mfma_f32_16x16x32_bf16 v[92:95], a[40:43], a[244:247], v[92:95]
    v_fma_f32 v117, s31, v117, v165
    v_fma_f32 v118, s31, v118, v166
    v_mfma_f32_16x16x32_bf16 v[92:95], a[64:67], a[240:243], v[92:95]
    buffer_load_dwordx4 a[152:155], v3, s[44:47], 0 offen offset:0 sc1
    v_fma_f32 v119, s31, v119, v167
    v_mfma_f32_16x16x32_bf16 v[92:95], a[160:163], a[232:235], v[92:95]
    v_fmac_f32 v252, s32, v124
    v_fmac_f32 v253, s32, v125
    v_mfma_f32_16x16x32_bf16 v[92:95], a[96:99], a[220:223], v[92:95]
    v_fmac_f32 v254, s32, v126
    v_fmac_f32 v255, s32, v127
    v_mfma_f32_16x16x32_bf16 v[92:95], a[72:75], a[236:239], v[92:95]
    v_fma_f32 v124, -s32, v124, -v172
    v_fma_f32 v125, -s32, v125, -v173
    v_mfma_f32_16x16x32_bf16 v[84:87], a[68:71], a[236:239], v[84:87]
    v_fma_f32 v126, -s32, v126, -v174
    v_fma_f32 v127, -s32, v127, -v175
    v_mfma_f32_16x16x32_bf16 v[84:87], a[76:79], a[220:223], v[84:87]
    v_exp_f32 v191, v191
    v_mfma_f32_16x16x32_bf16 v[84:87], a[176:179], a[232:235], v[84:87]
    buffer_load_dwordx4 a[156:159], v3, s[44:47], 0 offen offset:2048 sc1
    v_fma_f32 v177, v177, s33, 0.5
    v_mfma_f32_16x16x32_bf16 v[84:87], a[44:47], a[240:243], v[84:87]
    v_exp_f32 v182, v182 clamp
    v_mfma_f32_16x16x32_bf16 v[84:87], a[36:39], a[244:247], v[84:87]
    ds_read_b128 a[228:231], v0 offset:14336
    v_fma_f32 v184, v176, v184, v176
    v_mfma_f32_16x16x32_bf16 v[84:87], a[200:203], a[224:227], v[84:87]
    ds_read_b128 a[208:211], v1 offset:14336
    v_fma_f32 v185, v177, v185, v177
    v_mfma_f32_16x16x32_bf16 v[88:91], a[196:199], a[224:227], v[88:91]
    v_rcp_f32 v184, v184
    v_mfma_f32_16x16x32_bf16 v[88:91], a[52:55], a[244:247], v[88:91]
    buffer_load_dwordx4 a[172:175], v3, s[44:47], 0 offen offset:1024 sc1
    v_fma_f32 v178, v178, s33, 0.5
    v_mfma_f32_16x16x32_bf16 v[88:91], a[60:63], a[240:243], v[88:91]
    v_rcp_f32 v185, v185
    v_mfma_f32_16x16x32_bf16 v[88:91], a[128:131], a[232:235], v[88:91]
    v_exp_f32 v183, v183 clamp
    v_mfma_f32_16x16x32_bf16 v[88:91], a[92:95], a[220:223], v[88:91]
    v_fma_f32 v184, -v176, v184, v184
    v_fma_f32 v185, -v177, v185, v185
    v_mfma_f32_16x16x32_bf16 v[88:91], a[84:87], a[236:239], v[88:91]
    v_fma_f32 v179, v179, s33, 0.5
    v_fma_f32 v186, v178, v186, v178
    v_mfma_f32_16x16x32_bf16 v[80:83], a[80:83], a[236:239], v[80:83]
    v_fma_f32 v187, v179, v187, v179
    v_fma_f32 v180, v180, s33, 0.5
    v_mfma_f32_16x16x32_bf16 v[80:83], a[88:91], a[220:223], v[80:83]
    buffer_load_dwordx4 a[188:191], v3, s[44:47], 0 offen offset:3072 sc1
    v_fma_f32 v181, v181, s33, 0.5
    v_mfma_f32_16x16x32_bf16 v[80:83], a[112:115], a[232:235], v[80:83]
    v_rcp_f32 v186, v186
    v_mfma_f32_16x16x32_bf16 v[80:83], a[56:59], a[240:243], v[80:83]
    v_rcp_f32 v187, v187
    v_mfma_f32_16x16x32_bf16 v[80:83], a[48:51], a[244:247], v[80:83]
    v_add_u32 v3, 0x8000, v3
    v_fma_f32 v186, -v178, v186, v186
    v_mfma_f32_16x16x32_bf16 v[80:83], a[192:195], a[224:227], v[80:83]
    v_fma_f32 v187, -v179, v187, v187
    v_cvt_pk_bf16_f32 v176, v184, v185
    v_mfma_f32_16x16x32_bf16 v[96:99], a[192:195], a[244:247], v[96:99]
    buffer_load_dwordx4 a[140:143], v3, s[44:47], 0 offen offset:0 sc1
    v_cvt_pk_bf16_f32 v177, v186, v187
    v_mfma_f32_16x16x32_bf16 v[96:99], a[48:51], a[240:243], v[96:99]
    s_waitcnt lgkmcnt(0)
    v_fma_f32 v188, v180, v188, v180
    v_fma_f32 v189, v181, v189, v181
    v_mfma_f32_16x16x32_bf16 v[96:99], a[56:59], a[248:251], v[96:99]
    v_rcp_f32 v188, v188
    v_mfma_f32_16x16x32_bf16 v[96:99], a[112:115], a[216:219], v[96:99]
    v_rcp_f32 v189, v189
    v_mfma_f32_16x16x32_bf16 v[96:99], a[88:91], a[232:235], v[96:99]
    v_fma_f32 v188, -v180, v188, v188
    v_fma_f32 v189, -v181, v189, v189
    v_mfma_f32_16x16x32_bf16 v[96:99], a[80:83], a[220:223], v[96:99]
    v_cvt_pk_bf16_f32 v178, v188, v189
    v_fma_f32 v182, v182, s33, 0.5
    v_mfma_f32_16x16x32_bf16 v[104:107], a[84:87], a[220:223], v[104:107]
    buffer_load_dwordx4 a[124:127], v3, s[44:47], 0 offen offset:2048 sc1
    v_fma_f32 v183, v183, s33, 0.5
    v_mfma_f32_16x16x32_bf16 v[104:107], a[92:95], a[232:235], v[104:107]
    v_fma_f32 v190, v182, v190, v182
    v_fma_f32 v191, v183, v191, v183
    v_mfma_f32_16x16x32_bf16 v[104:107], a[128:131], a[216:219], v[104:107]
    v_rcp_f32 v190, v190
    v_mfma_f32_16x16x32_bf16 v[104:107], a[60:63], a[248:251], v[104:107]
    v_rcp_f32 v191, v191
    v_mfma_f32_16x16x32_bf16 v[104:107], a[52:55], a[240:243], v[104:107]
    ds_read_b128 a[212:215], v0 offset:16384
    v_fma_f32 v190, -v182, v190, v190
    v_mfma_f32_16x16x32_bf16 v[104:107], a[196:199], a[244:247], v[104:107]
    buffer_load_dwordx4 a[108:111], v3, s[44:47], 0 offen offset:1024 sc1
    ds_read_b128 a[252:255], v1 offset:16384
    v_mfma_f32_16x16x32_bf16 v[100:103], a[200:203], a[244:247], v[100:103]
    v_fma_f32 v191, -v183, v191, v191
    v_cvt_pk_bf16_f32 v179, v190, v191
    v_mfma_f32_16x16x32_bf16 v[100:103], a[36:39], a[240:243], v[100:103]
    v_permlane16_swap_b32 v176, v178
    v_mfma_f32_16x16x32_bf16 v[100:103], a[44:47], a[248:251], v[100:103]
    v_mfma_f32_16x16x32_bf16 v[100:103], a[176:179], a[216:219], v[100:103]
    v_mfma_f32_16x16x32_bf16 v[100:103], a[76:79], a[232:235], v[100:103]
    v_mfma_f32_16x16x32_bf16 v[100:103], a[68:71], a[220:223], v[100:103]
    v_mfma_f32_16x16x32_bf16 v[108:111], a[72:75], a[220:223], v[108:111]
    v_permlane16_swap_b32 v177, v179
    v_mfma_f32_16x16x32_bf16 v[108:111], a[96:99], a[232:235], v[108:111]
    buffer_store_dwordx4 v[176:179], v4, s[20:23], 0 offen offset:2048 sc1
    v_mfma_f32_16x16x32_bf16 v[108:111], a[160:163], a[216:219], v[108:111]
    v_exp_f32 v200, v200
    v_mfma_f32_16x16x32_bf16 v[108:111], a[64:67], a[248:251], v[108:111]
    v_accvgpr_read_b32 v176, a16
    v_accvgpr_read_b32 v177, a17
    v_mfma_f32_16x16x32_bf16 v[108:111], a[40:43], a[240:243], v[108:111]
    v_accvgpr_read_b32 v178, a18
    v_accvgpr_read_b32 v179, a19
    v_mfma_f32_16x16x32_bf16 v[108:111], a[32:35], a[244:247], v[108:111]
    s_waitcnt vmcnt(8) lgkmcnt(1)
    v_accvgpr_read_b32 v15, a207
    v_fma_f32 v176, s31, v176, v5
    v_mfma_f32_16x16x32_bf16 v[124:127], a[32:35], a[240:243], v[124:127]
    v_fma_f32 v177, s31, v177, v5
    v_fma_f32 v178, s31, v178, v5
    v_mfma_f32_16x16x32_bf16 v[124:127], a[40:43], a[248:251], v[124:127]
    v_fma_f32 v179, s31, v179, v5
    v_accvgpr_read_b32 v180, a20
    v_mfma_f32_16x16x32_bf16 v[124:127], a[64:67], a[228:231], v[124:127]
    v_accvgpr_read_b32 v181, a21
    v_accvgpr_read_b32 v182, a22
    v_mfma_f32_16x16x32_bf16 v[124:127], a[160:163], a[208:211], v[124:127]
    v_accvgpr_read_b32 v183, a23
    v_fma_f32 v180, s31, v180, v5
    v_mfma_f32_16x16x32_bf16 v[124:127], a[96:99], a[216:219], v[124:127]
    v_fma_f32 v181, s31, v181, v5
    v_fma_f32 v182, s31, v182, v5
    v_mfma_f32_16x16x32_bf16 v[124:127], a[72:75], a[232:235], v[124:127]
    v_fma_f32 v183, s31, v183, v5
    v_accvgpr_read_b32 v184, a24
    v_mfma_f32_16x16x32_bf16 v[116:119], a[68:71], a[232:235], v[116:119]
    v_accvgpr_read_b32 v185, a25
    v_accvgpr_read_b32 v186, a26
    v_mfma_f32_16x16x32_bf16 v[116:119], a[76:79], a[216:219], v[116:119]
    v_accvgpr_read_b32 v187, a27
    v_mul_f32 v184, s32, v184
    v_mfma_f32_16x16x32_bf16 v[116:119], a[176:179], a[208:211], v[116:119]
    v_mul_f32 v185, s32, v185
    v_mul_f32 v186, s32, v186
    v_mfma_f32_16x16x32_bf16 v[116:119], a[44:47], a[228:231], v[116:119]
    v_mul_f32 v187, s32, v187
    v_accvgpr_read_b32 v188, a28
    v_mfma_f32_16x16x32_bf16 v[116:119], a[36:39], a[248:251], v[116:119]
    ds_read_b128 a[236:239], v0 offset:18432
    v_accvgpr_read_b32 v189, a29
    v_mfma_f32_16x16x32_bf16 v[116:119], a[200:203], a[240:243], v[116:119]
    ds_read_b128 a[224:227], v1 offset:18432
    v_accvgpr_read_b32 v190, a30
    v_mfma_f32_16x16x32_bf16 v[120:123], a[196:199], a[240:243], v[120:123]
    v_accvgpr_read_b32 v191, a31
    v_mul_f32 v188, s32, v188
    v_mfma_f32_16x16x32_bf16 v[120:123], a[52:55], a[248:251], v[120:123]
    v_mul_f32 v189, s32, v189
    v_mul_f32 v190, s32, v190
    v_mfma_f32_16x16x32_bf16 v[120:123], a[60:63], a[228:231], v[120:123]
    v_mul_f32 v191, s32, v191
    v_fmac_f32 v160, s31, v128
    v_mfma_f32_16x16x32_bf16 v[120:123], a[128:131], a[208:211], v[120:123]
    v_fmac_f32 v161, s31, v129
    v_fmac_f32 v162, s31, v130
    v_mfma_f32_16x16x32_bf16 v[120:123], a[92:95], a[216:219], v[120:123]
    v_fmac_f32 v163, s31, v131
    v_fma_f32 v128, s31, v128, v176
    v_mfma_f32_16x16x32_bf16 v[120:123], a[84:87], a[232:235], v[120:123]
    v_fma_f32 v129, s31, v129, v177
    v_fma_f32 v130, s31, v130, v178
    v_mfma_f32_16x16x32_bf16 v[112:115], a[80:83], a[232:235], v[112:115]
    v_fma_f32 v131, s31, v131, v179
    v_fmac_f32 v168, s32, v136
    v_mfma_f32_16x16x32_bf16 v[112:115], a[88:91], a[216:219], v[112:115]
    v_fmac_f32 v169, s32, v137
    v_fmac_f32 v170, s32, v138
    v_mfma_f32_16x16x32_bf16 v[112:115], a[112:115], a[208:211], v[112:115]
    buffer_load_dwordx4 a[0:3], v3, s[44:47], 0 offen offset:3072 sc1
    v_fmac_f32 v171, s32, v139
    v_mfma_f32_16x16x32_bf16 v[112:115], a[56:59], a[228:231], v[112:115]
    v_fma_f32 v136, -s32, v136, -v184
    v_fma_f32 v137, -s32, v137, -v185
    v_mfma_f32_16x16x32_bf16 v[112:115], a[48:51], a[248:251], v[112:115]
    v_fma_f32 v138, -s32, v138, -v186
    v_fma_f32 v139, -s32, v139, -v187
    v_mfma_f32_16x16x32_bf16 v[112:115], a[192:195], a[240:243], v[112:115]
    v_add_u32 v3, 0x8000, v3
    v_cmp_gt_u32 vcc, 4, v15
    v_mfma_f32_16x16x32_bf16 v[128:131], a[192:195], a[248:251], v[128:131]
    s_nop 0
    s_nop 0
    s_cbranch_vccnz L_spin3
L_back3:
    v_mfma_f32_16x16x32_bf16 v[128:131], a[48:51], a[228:231], v[128:131]
    buffer_load_dwordx4 a[4:7], v3, s[44:47], 0 offen offset:0 sc1
    v_fmac_f32 v164, s31, v132
    v_mfma_f32_16x16x32_bf16 v[128:131], a[56:59], a[212:215], v[128:131]
    s_waitcnt lgkmcnt(0)
    v_fmac_f32 v165, s31, v133
    v_fmac_f32 v166, s31, v134
    v_mfma_f32_16x16x32_bf16 v[128:131], a[112:115], a[252:255], v[128:131]
    v_fmac_f32 v167, s31, v135
    v_fma_f32 v132, s31, v132, v180
    v_mfma_f32_16x16x32_bf16 v[128:131], a[88:91], a[208:211], v[128:131]
    v_fma_f32 v133, s31, v133, v181
    v_fma_f32 v134, s31, v134, v182
    v_mfma_f32_16x16x32_bf16 v[128:131], a[80:83], a[216:219], v[128:131]
    v_fma_f32 v135, s31, v135, v183
    v_fmac_f32 v172, s32, v140
    v_mfma_f32_16x16x32_bf16 v[136:139], a[84:87], a[216:219], v[136:139]
    v_fmac_f32 v173, s32, v141
    v_fmac_f32 v174, s32, v142
    v_mfma_f32_16x16x32_bf16 v[136:139], a[92:95], a[208:211], v[136:139]
    buffer_load_dwordx4 a[8:11], v3, s[44:47], 0 offen offset:2048 sc1
    v_fmac_f32 v175, s32, v143
    v_mfma_f32_16x16x32_bf16 v[136:139], a[128:131], a[252:255], v[136:139]
    ds_read_b128 a[220:223], v0 offset:20480
    v_fma_f32 v140, -s32, v140, -v188
    v_mfma_f32_16x16x32_bf16 v[136:139], a[60:63], a[212:215], v[136:139]
    ds_read_b128 a[244:247], v0 offset:22528
    v_fma_f32 v141, -s32, v141, -v189
    v_mfma_f32_16x16x32_bf16 v[136:139], a[52:55], a[228:231], v[136:139]
    ds_read_b128 a[232:235], v0 offset:24576
    v_fma_f32 v142, -s32, v142, -v190
    v_mfma_f32_16x16x32_bf16 v[136:139], a[196:199], a[248:251], v[136:139]
    v_fma_f32 v143, -s32, v143, -v191
    v_fmac_f32 v176, s31, v144
    v_mfma_f32_16x16x32_bf16 v[132:135], a[200:203], a[248:251], v[132:135]
    buffer_load_dwordx4 a[12:15], v3, s[44:47], 0 offen offset:1024 sc1
    v_fmac_f32 v177, s31, v145
    v_mfma_f32_16x16x32_bf16 v[132:135], a[36:39], a[228:231], v[132:135]
    v_fmac_f32 v178, s31, v146
    v_fmac_f32 v179, s31, v147
    v_mfma_f32_16x16x32_bf16 v[132:135], a[44:47], a[212:215], v[132:135]
    v_fma_f32 v144, s31, v144, v16
    v_fma_f32 v145, s31, v145, v17
    v_mfma_f32_16x16x32_bf16 v[132:135], a[176:179], a[252:255], v[132:135]
    v_fma_f32 v146, s31, v146, v18
    v_fma_f32 v147, s31, v147, v19
    v_mfma_f32_16x16x32_bf16 v[132:135], a[76:79], a[208:211], v[132:135]
    v_fmac_f32 v184, s32, v152
    v_fmac_f32 v185, s32, v153
    v_mfma_f32_16x16x32_bf16 v[132:135], a[68:71], a[216:219], v[132:135]
    v_fmac_f32 v186, s32, v154
    v_fmac_f32 v187, s32, v155
    v_mfma_f32_16x16x32_bf16 v[140:143], a[72:75], a[216:219], v[140:143]
    buffer_load_dwordx4 a[16:19], v3, s[44:47], 0 offen offset:3072 sc1
    v_fma_f32 v152, -s32, v152, -v24
    v_mfma_f32_16x16x32_bf16 v[140:143], a[96:99], a[208:211], v[140:143]
    v_fma_f32 v153, -s32, v153, -v25
    v_fma_f32 v154, -s32, v154, -v26
    v_mfma_f32_16x16x32_bf16 v[140:143], a[160:163], a[252:255], v[140:143]
    v_fma_f32 v155, -s32, v155, -v27
    v_fmac_f32 v180, s31, v148
    v_mfma_f32_16x16x32_bf16 v[140:143], a[64:67], a[212:215], v[140:143]
    v_add_u32 v3, 0x8000, v3
    v_fmac_f32 v181, s31, v149
    v_mfma_f32_16x16x32_bf16 v[140:143], a[40:43], a[228:231], v[140:143]
    ds_read_b128 a[240:243], v0 offset:26624
    v_fmac_f32 v182, s31, v150
    v_mfma_f32_16x16x32_bf16 v[140:143], a[32:35], a[248:251], v[140:143]
    buffer_load_dwordx4 a[20:23], v3, s[44:47], 0 offen offset:0 sc1
    v_fmac_f32 v183, s31, v151
    v_mfma_f32_16x16x32_bf16 v[144:147], a[192:195], a[228:231], v[144:147]
    v_fma_f32 v148, s31, v148, v20
    v_fma_f32 v149, s31, v149, v21
    v_mfma_f32_16x16x32_bf16 v[144:147], a[48:51], a[212:215], v[144:147]
    v_fma_f32 v150, s31, v150, v22
    v_fma_f32 v151, s31, v151, v23
    v_mfma_f32_16x16x32_bf16 v[144:147], a[56:59], a[236:239], v[144:147]
    v_fmac_f32 v188, s32, v156
    v_fmac_f32 v189, s32, v157
    v_mfma_f32_16x16x32_bf16 v[144:147], a[112:115], a[224:227], v[144:147]
    v_fmac_f32 v190, s32, v158
    v_fmac_f32 v191, s32, v159
    v_mfma_f32_16x16x32_bf16 v[144:147], a[88:91], a[252:255], v[144:147]
    v_fma_f32 v156, -s32, v156, -v28
    v_fma_f32 v157, -s32, v157, -v29
    v_mfma_f32_16x16x32_bf16 v[144:147], a[80:83], a[208:211], v[144:147]
    buffer_load_dwordx4 a[24:27], v3, s[44:47], 0 offen offset:2048 sc1
    v_fma_f32 v158, -s32, v158, -v30
    v_mfma_f32_16x16x32_bf16 v[152:155], a[84:87], a[208:211], v[152:155]
    v_fma_f32 v159, -s32, v159, -v31
    v_mbcnt_lo_u32_b32 v5, -1, 0
    v_mfma_f32_16x16x32_bf16 v[152:155], a[92:95], a[252:255], v[152:155]
    v_exp_f32 v201, v201
    v_mfma_f32_16x16x32_bf16 v[152:155], a[128:131], a[224:227], v[152:155]
    v_exp_f32 v192, v192 clamp
    v_mfma_f32_16x16x32_bf16 v[152:155], a[60:63], a[236:239], v[152:155]
    v_exp_f32 v193, v193 clamp
    v_mfma_f32_16x16x32_bf16 v[152:155], a[52:55], a[212:215], v[152:155]
    buffer_load_dwordx4 a[28:31], v3, s[44:47], 0 offen offset:1024 sc1
    ds_read_b128 a[216:219], v0 offset:28672
    v_mfma_f32_16x16x32_bf16 v[152:155], a[196:199], a[228:231], v[152:155]
    v_exp_f32 v202, v202
    v_mfma_f32_16x16x32_bf16 v[148:151], a[200:203], a[228:231], v[148:151]
    v_exp_f32 v203, v203
    v_mfma_f32_16x16x32_bf16 v[148:151], a[36:39], a[212:215], v[148:151]
    v_exp_f32 v194, v194 clamp
    v_mfma_f32_16x16x32_bf16 v[148:151], a[44:47], a[236:239], v[148:151]
    v_exp_f32 v195, v195 clamp
    v_mfma_f32_16x16x32_bf16 v[148:151], a[176:179], a[224:227], v[148:151]
    v_exp_f32 v204, v204
    v_mfma_f32_16x16x32_bf16 v[148:151], a[76:79], a[252:255], v[148:151]
    buffer_load_dwordx4 a[192:195], v3, s[44:47], 0 offen offset:3072 sc1
    v_fma_f32 v192, v192, s33, 0.5
    v_mfma_f32_16x16x32_bf16 v[148:151], a[68:71], a[208:211], v[148:151]
    v_exp_f32 v205, v205
    v_mfma_f32_16x16x32_bf16 v[156:159], a[72:75], a[208:211], v[156:159]
    v_exp_f32 v196, v196 clamp
    v_mfma_f32_16x16x32_bf16 v[156:159], a[96:99], a[252:255], v[156:159]
    v_add_u32 v3, 0x8000, v3
    v_fma_f32 v193, v193, s33, 0.5
    v_mfma_f32_16x16x32_bf16 v[156:159], a[160:163], a[224:227], v[156:159]
    v_exp_f32 v197, v197 clamp
    v_mfma_f32_16x16x32_bf16 v[156:159], a[64:67], a[236:239], v[156:159]
    buffer_load_dwordx4 a[48:51], v3, s[44:47], 0 offen offset:0 sc1
    v_fma_f32 v200, v192, v200, v192
    v_mfma_f32_16x16x32_bf16 v[156:159], a[40:43], a[212:215], v[156:159]
    ds_read_b128 a[248:251], v0 offset:30720
    v_fma_f32 v201, v193, v201, v193
    v_mfma_f32_16x16x32_bf16 v[156:159], a[32:35], a[228:231], v[156:159]
    s_waitcnt lgkmcnt(1)
    v_rcp_f32 v200, v200
    v_mfma_f32_16x16x32_bf16 v[32:35], a[144:147], a[220:223], v[32:35]
    v_rcp_f32 v201, v201
    v_mfma_f32_16x16x32_bf16 v[32:35], a[132:135], a[244:247], v[32:35]
    v_exp_f32 v206, v206
    v_mfma_f32_16x16x32_bf16 v[32:35], a[120:123], a[232:235], v[32:35]
    v_exp_f32 v207, v207
    v_mfma_f32_16x16x32_bf16 v[40:43], a[136:139], a[232:235], v[40:43]
    buffer_load_dwordx4 a[56:59], v3, s[44:47], 0 offen offset:2048 sc1
    v_fma_f32 v200, -v192, v200, v200
    v_mfma_f32_16x16x32_bf16 v[40:43], a[116:119], a[244:247], v[40:43]
    v_exp_f32 v198, v198 clamp
    v_mfma_f32_16x16x32_bf16 v[40:43], a[148:151], a[220:223], v[40:43]
    v_exp_f32 v199, v199 clamp
    v_mfma_f32_16x16x32_bf16 v[36:39], a[164:167], a[220:223], v[36:39]
    v_fma_f32 v201, -v193, v201, v201
    v_fma_f32 v194, v194, s33, 0.5
    v_mfma_f32_16x16x32_bf16 v[36:39], a[100:103], a[244:247], v[36:39]
    v_fma_f32 v195, v195, s33, 0.5
    v_fma_f32 v202, v194, v202, v194
    v_mfma_f32_16x16x32_bf16 v[36:39], a[184:187], a[232:235], v[36:39]
    buffer_load_dwordx4 a[112:115], v3, s[44:47], 0 offen offset:1024 sc1
    v_fma_f32 v203, v195, v203, v195
    v_mfma_f32_16x16x32_bf16 v[44:47], a[168:171], a[232:235], v[44:47]
    v_rcp_f32 v202, v202
    v_mfma_f32_16x16x32_bf16 v[44:47], a[104:107], a[244:247], v[44:47]
    ds_read_b128 a[208:211], v0 offset:32768
    v_fma_f32 v196, v196, s33, 0.5
    v_mfma_f32_16x16x32_bf16 v[44:47], a[180:183], a[220:223], v[44:47]
    v_rcp_f32 v203, v203
    v_mfma_f32_16x16x32_bf16 v[60:63], a[180:183], a[244:247], v[60:63]
    v_fma_f32 v202, -v194, v202, v202
    v_fma_f32 v203, -v195, v203, v203
    v_mfma_f32_16x16x32_bf16 v[60:63], a[104:107], a[232:235], v[60:63]
    v_cvt_pk_bf16_f32 v192, v200, v201
    v_cvt_pk_bf16_f32 v193, v202, v203
    v_mfma_f32_16x16x32_bf16 v[60:63], a[168:171], a[240:243], v[60:63]
    buffer_load_dwordx4 a[88:91], v3, s[44:47], 0 offen offset:3072 sc1
    v_fma_f32 v197, v197, s33, 0.5
    v_mfma_f32_16x16x32_bf16 v[52:55], a[184:187], a[240:243], v[52:55]
    v_exp_f32 v216, v216
    v_mfma_f32_16x16x32_bf16 v[52:55], a[100:103], a[232:235], v[52:55]
    v_exp_f32 v217, v217
    v_mfma_f32_16x16x32_bf16 v[52:55], a[164:167], a[244:247], v[52:55]
    v_add_u32 v3, 0x8000, v3
    v_fma_f32 v204, v196, v204, v196
    v_mfma_f32_16x16x32_bf16 v[56:59], a[148:151], a[244:247], v[56:59]
    v_exp_f32 v208, v208 clamp
    v_mfma_f32_16x16x32_bf16 v[56:59], a[116:119], a[232:235], v[56:59]
    buffer_load_dwordx4 a[80:83], v3, s[44:47], 0 offen offset:0 sc1
    v_fma_f32 v205, v197, v205, v197
    v_mfma_f32_16x16x32_bf16 v[56:59], a[136:139], a[240:243], v[56:59]
    v_rcp_f32 v204, v204
    v_mfma_f32_16x16x32_bf16 v[48:51], a[120:123], a[240:243], v[48:51]
    v_rcp_f32 v205, v205
    v_mfma_f32_16x16x32_bf16 v[48:51], a[132:135], a[232:235], v[48:51]
    ds_read_b128 a[252:255], v0 offset:34816
    v_fma_f32 v204, -v196, v204, v204
    v_mfma_f32_16x16x32_bf16 v[48:51], a[144:147], a[244:247], v[48:51]
    v_exp_f32 v209, v209 clamp
    v_mfma_f32_16x16x32_bf16 v[64:67], a[144:147], a[232:235], v[64:67]
    v_exp_f32 v218, v218
    v_mfma_f32_16x16x32_bf16 v[64:67], a[132:135], a[240:243], v[64:67]
    buffer_load_dwordx4 a[84:87], v3, s[44:47], 0 offen offset:2048 sc1
    v_fma_f32 v205, -v197, v205, v205
    v_mfma_f32_16x16x32_bf16 v[64:67], a[120:123], a[216:219], v[64:67]
    v_exp_f32 v219, v219
    v_mfma_f32_16x16x32_bf16 v[72:75], a[136:139], a[216:219], v[72:75]
    v_exp_f32 v210, v210 clamp
    v_mfma_f32_16x16x32_bf16 v[72:75], a[116:119], a[240:243], v[72:75]
    v_exp_f32 v211, v211 clamp
    v_mfma_f32_16x16x32_bf16 v[72:75], a[148:151], a[232:235], v[72:75]
    v_cvt_pk_bf16_f32 v194, v204, v205
    v_fma_f32 v198, v198, s33, 0.5
    v_mfma_f32_16x16x32_bf16 v[68:71], a[164:167], a[232:235], v[68:71]
    buffer_load_dwordx4 a[92:95], v3, s[44:47], 0 offen offset:1024 sc1
    v_fma_f32 v199, v199, s33, 0.5
    v_mfma_f32_16x16x32_bf16 v[68:71], a[100:103], a[240:243], v[68:71]
    v_exp_f32 v220, v220
    v_mfma_f32_16x16x32_bf16 v[68:71], a[184:187], a[216:219], v[68:71]
    v_exp_f32 v221, v221
    v_mfma_f32_16x16x32_bf16 v[76:79], a[168:171], a[216:219], v[76:79]
    v_exp_f32 v212, v212 clamp
    v_mfma_f32_16x16x32_bf16 v[76:79], a[104:107], a[240:243], v[76:79]
    ds_read_b128 a[224:227], v0 offset:36864
    v_fma_f32 v206, v198, v206, v198
    v_mfma_f32_16x16x32_bf16 v[76:79], a[180:183], a[232:235], v[76:79]
    v_exp_f32 v213, v213 clamp
    v_mfma_f32_16x16x32_bf16 v[92:95], a[180:183], a[240:243], v[92:95]
    buffer_load_dwordx4 a[128:131], v3, s[44:47], 0 offen offset:3072 sc1
    v_fma_f32 v207, v199, v207, v199
    v_mfma_f32_16x16x32_bf16 v[92:95], a[104:107], a[216:219], v[92:95]
    s_waitcnt lgkmcnt(1)
    v_rcp_f32 v206, v206
    v_mfma_f32_16x16x32_bf16 v[92:95], a[168:171], a[248:251], v[92:95]
    v_rcp_f32 v207, v207
    v_mfma_f32_16x16x32_bf16 v[84:87], a[184:187], a[248:251], v[84:87]
    v_add_u32 v3, 0x8000, v3
    v_fma_f32 v206, -v198, v206, v206
    v_mfma_f32_16x16x32_bf16 v[84:87], a[100:103], a[216:219], v[84:87]
    v_fma_f32 v207, -v199, v207, v207
    v_cvt_pk_bf16_f32 v195, v206, v207
    v_mfma_f32_16x16x32_bf16 v[84:87], a[164:167], a[240:243], v[84:87]
    buffer_load_dwordx4 a[60:63], v3, s[44:47], 0 offen offset:0 sc1
    v_fma_f32 v208, v208, s33, 0.5
    v_mfma_f32_16x16x32_bf16 v[88:91], a[148:151], a[240:243], v[88:91]
    v_permlane16_swap_b32 v192, v194
    v_mfma_f32_16x16x32_bf16 v[88:91], a[116:119], a[216:219], v[88:91]
    v_permlane16_swap_b32 v193, v195
    v_mfma_f32_16x16x32_bf16 v[88:91], a[136:139], a[248:251], v[88:91]
    buffer_store_dwordx4 v[192:195], v4, s[20:23], s52 offen offset:0 sc1
    v_mfma_f32_16x16x32_bf16 v[80:83], a[120:123], a[248:251], v[80:83]
    v_exp_f32 v222, v222
    v_mfma_f32_16x16x32_bf16 v[80:83], a[132:135], a[216:219], v[80:83]
    ds_read_b128 a[236:239], v0 offset:38912
    v_fma_f32 v209, v209, s33, 0.5
    v_mfma_f32_16x16x32_bf16 v[80:83], a[144:147], a[240:243], v[80:83]
    buffer_load_dwordx4 a[52:55], v3, s[44:47], 0 offen offset:2048 sc1
    v_fma_f32 v216, v208, v216, v208
    v_mfma_f32_16x16x32_bf16 v[96:99], a[144:147], a[216:219], v[96:99]
    v_exp_f32 v223, v223
    v_mfma_f32_16x16x32_bf16 v[96:99], a[132:135], a[248:251], v[96:99]
    v_exp_f32 v214, v214 clamp
    v_mfma_f32_16x16x32_bf16 v[96:99], a[120:123], a[208:211], v[96:99]
    v_exp_f32 v215, v215 clamp
    v_mfma_f32_16x16x32_bf16 v[104:107], a[136:139], a[208:211], v[104:107]
    v_fma_f32 v217, v209, v217, v209
    v_fma_f32 v210, v210, s33, 0.5
    v_mfma_f32_16x16x32_bf16 v[104:107], a[116:119], a[248:251], v[104:107]
    buffer_load_dwordx4 a[196:199], v3, s[44:47], 0 offen offset:1024 sc1
    v_fma_f32 v211, v211, s33, 0.5
    v_mfma_f32_16x16x32_bf16 v[104:107], a[148:151], a[216:219], v[104:107]
    v_rcp_f32 v216, v216
    v_mfma_f32_16x16x32_bf16 v[100:103], a[164:167], a[216:219], v[100:103]
    v_rcp_f32 v217, v217
    v_mfma_f32_16x16x32_bf16 v[100:103], a[100:103], a[248:251], v[100:103]
    v_fma_f32 v216, -v208, v216, v216
    v_fma_f32 v217, -v209, v217, v217
    v_mfma_f32_16x16x32_bf16 v[100:103], a[184:187], a[208:211], v[100:103]
    ds_read_b128 a[212:215], v1 offset:20480
    v_fma_f32 v218, v210, v218, v210
    v_mfma_f32_16x16x32_bf16 v[108:111], a[168:171], a[208:211], v[108:111]
    ds_read_b128 a[228:231], v1 offset:22528
    v_fma_f32 v219, v211, v219, v211
    v_mfma_f32_16x16x32_bf16 v[108:111], a[104:107], a[248:251], v[108:111]
    buffer_load_dwordx4 a[36:39], v3, s[44:47], 0 offen offset:3072 sc1
    ds_read_b128 a[220:223], v1 offset:24576
    v_mfma_f32_16x16x32_bf16 v[108:111], a[180:183], a[216:219], v[108:111]
    v_rcp_f32 v218, v218
    v_mfma_f32_16x16x32_bf16 v[124:127], a[180:183], a[248:251], v[124:127]
    v_rcp_f32 v219, v219
    v_mfma_f32_16x16x32_bf16 v[124:127], a[104:107], a[208:211], v[124:127]
    v_add_u32 v3, 0x8000, v3
    v_fma_f32 v218, -v210, v218, v218
    v_mfma_f32_16x16x32_bf16 v[124:127], a[168:171], a[252:255], v[124:127]
    v_fma_f32 v219, -v211, v219, v219
    v_cvt_pk_bf16_f32 v208, v216, v217
    v_mfma_f32_16x16x32_bf16 v[116:119], a[184:187], a[252:255], v[116:119]
    buffer_load_dwordx4 a[44:47], v3, s[44:47], 0 offen offset:0 sc1
    v_cvt_pk_bf16_f32 v209, v218, v219
    v_mfma_f32_16x16x32_bf16 v[116:119], a[100:103], a[208:211], v[116:119]
    v_exp_f32 v232, v232
    v_mfma_f32_16x16x32_bf16 v[116:119], a[164:167], a[248:251], v[116:119]
    v_exp_f32 v233, v233
    v_mfma_f32_16x16x32_bf16 v[120:123], a[148:151], a[248:251], v[120:123]
    v_exp_f32 v224, v224 clamp
    v_mfma_f32_16x16x32_bf16 v[120:123], a[116:119], a[208:211], v[120:123]
    v_exp_f32 v225, v225 clamp
    v_mfma_f32_16x16x32_bf16 v[120:123], a[136:139], a[252:255], v[120:123]
    v_exp_f32 v234, v234
    v_mfma_f32_16x16x32_bf16 v[112:115], a[120:123], a[252:255], v[112:115]
    buffer_load_dwordx4 a[176:179], v3, s[44:47], 0 offen offset:2048 sc1
    v_fma_f32 v212, v212, s33, 0.5
    v_mfma_f32_16x16x32_bf16 v[112:115], a[132:135], a[208:211], v[112:115]
    ds_read_b128 a[244:247], v1 offset:26624
    v_fma_f32 v213, v213, s33, 0.5
    v_mfma_f32_16x16x32_bf16 v[112:115], a[144:147], a[248:251], v[112:115]
    v_exp_f32 v235, v235
    v_mfma_f32_16x16x32_bf16 v[128:131], a[144:147], a[208:211], v[128:131]
    v_exp_f32 v226, v226 clamp
    v_mfma_f32_16x16x32_bf16 v[128:131], a[132:135], a[252:255], v[128:131]
    s_waitcnt lgkmcnt(1)
    v_exp_f32 v227, v227 clamp
    v_mfma_f32_16x16x32_bf16 v[128:131], a[120:123], a[224:227], v[128:131]
    buffer_load_dwordx4 a[76:79], v3, s[44:47], 0 offen offset:1024 sc1
    v_fma_f32 v220, v212, v220, v212
    v_mfma_f32_16x16x32_bf16 v[136:139], a[136:139], a[224:227], v[136:139]
    v_fma_f32 v221, v213, v221, v213
    v_fma_f32 v214, v214, s33, 0.5
    v_mfma_f32_16x16x32_bf16 v[136:139], a[116:119], a[252:255], v[136:139]
    v_rcp_f32 v220, v220
    v_mfma_f32_16x16x32_bf16 v[136:139], a[148:151], a[208:211], v[136:139]
    v_rcp_f32 v221, v221
    v_mfma_f32_16x16x32_bf16 v[132:135], a[164:167], a[208:211], v[132:135]
    v_fma_f32 v220, -v212, v220, v220
    v_fma_f32 v221, -v213, v221, v221
    v_mfma_f32_16x16x32_bf16 v[132:135], a[100:103], a[252:255], v[132:135]
    v_cvt_pk_bf16_f32 v210, v220, v221
    v_fma_f32 v215, v215, s33, 0.5
    v_mfma_f32_16x16x32_bf16 v[132:135], a[184:187], a[224:227], v[132:135]
    buffer_load_dwordx4 a[68:71], v3, s[44:47], 0 offen offset:3072 sc1
    v_fma_f32 v222, v214, v222, v214
    v_mfma_f32_16x16x32_bf16 v[140:143], a[168:171], a[224:227], v[140:143]
    v_exp_f32 v236, v236
    v_mfma_f32_16x16x32_bf16 v[140:143], a[104:107], a[252:255], v[140:143]
    ds_read_b128 a[232:235], v1 offset:28672
    v_fma_f32 v223, v215, v223, v215
    v_mfma_f32_16x16x32_bf16 v[140:143], a[180:183], a[208:211], v[140:143]
    v_add_u32 v3, 0x8000, v3
    v_fma_f32 v224, v224, s33, 0.5
    v_mfma_f32_16x16x32_bf16 v[144:147], a[144:147], a[252:255], v[144:147]
    v_rcp_f32 v222, v222
    v_mfma_f32_16x16x32_bf16 v[144:147], a[132:135], a[224:227], v[144:147]
    buffer_load_dwordx4 a[72:75], v3, s[44:47], 0 offen offset:0 sc1
    v_fma_f32 v225, v225, s33, 0.5
    v_mfma_f32_16x16x32_bf16 v[144:147], a[120:123], a[236:239], v[144:147]
    v_rcp_f32 v223, v223
    v_mfma_f32_16x16x32_bf16 v[152:155], a[136:139], a[236:239], v[152:155]
    v_exp_f32 v237, v237
    v_mfma_f32_16x16x32_bf16 v[152:155], a[116:119], a[224:227], v[152:155]
    v_exp_f32 v228, v228 clamp
    v_mfma_f32_16x16x32_bf16 v[152:155], a[148:151], a[252:255], v[152:155]
    v_exp_f32 v229, v229 clamp
    v_mfma_f32_16x16x32_bf16 v[148:151], a[164:167], a[252:255], v[148:151]
    v_fma_f32 v222, -v214, v222, v222
    v_fma_f32 v223, -v215, v223, v223
    v_mfma_f32_16x16x32_bf16 v[148:151], a[100:103], a[224:227], v[148:151]
    buffer_load_dwordx4 a[96:99], v3, s[44:47], 0 offen offset:2048 sc1
    v_cvt_pk_bf16_f32 v211, v222, v223
    v_mfma_f32_16x16x32_bf16 v[148:151], a[184:187], a[236:239], v[148:151]
    v_permlane16_swap_b32 v208, v210
    v_mfma_f32_16x16x32_bf16 v[156:159], a[168:171], a[236:239], v[156:159]
    v_permlane16_swap_b32 v209, v211
    v_mfma_f32_16x16x32_bf16 v[156:159], a[104:107], a[224:227], v[156:159]
    ds_read_b128 a[240:243], v1 offset:30720
    v_fma_f32 v232, v224, v232, v224
    v_mfma_f32_16x16x32_bf16 v[156:159], a[180:183], a[252:255], v[156:159]
    s_waitcnt vmcnt(29) lgkmcnt(1)
    buffer_store_dwordx4 v[208:211], v4, s[20:23], s52 offen offset:2048 sc1
    v_mfma_f32_16x16x32_bf16 v[32:35], a[152:155], a[212:215], v[32:35]
    buffer_load_dwordx4 a[160:163], v3, s[44:47], 0 offen offset:1024 sc1
    v_fma_f32 v233, v225, v233, v225
    v_mfma_f32_16x16x32_bf16 v[32:35], a[140:143], a[228:231], v[32:35]
    s_waitcnt vmcnt(28)
    v_rcp_f32 v232, v232
    v_mfma_f32_16x16x32_bf16 v[32:35], a[4:7], a[220:223], v[32:35]
    s_waitcnt vmcnt(20)
    v_rcp_f32 v233, v233
    v_mfma_f32_16x16x32_bf16 v[40:43], a[8:11], a[220:223], v[40:43]
    v_exp_f32 v238, v238
    v_mfma_f32_16x16x32_bf16 v[40:43], a[124:127], a[228:231], v[40:43]
    v_exp_f32 v239, v239
    v_mfma_f32_16x16x32_bf16 v[40:43], a[156:159], a[212:215], v[40:43]
    v_exp_f32 v230, v230 clamp
    v_mfma_f32_16x16x32_bf16 v[36:39], a[172:175], a[212:215], v[36:39]
    buffer_load_dwordx4 a[64:67], v3, s[44:47], 0 offen offset:3072 sc1
    v_fma_f32 v232, -v224, v232, v232
    v_mfma_f32_16x16x32_bf16 v[36:39], a[108:111], a[228:231], v[36:39]
    v_exp_f32 v231, v231 clamp
    v_mfma_f32_16x16x32_bf16 v[36:39], a[12:15], a[220:223], v[36:39]
    v_fma_f32 v233, -v225, v233, v233
    v_fma_f32 v226, v226, s33, 0.5
    v_mfma_f32_16x16x32_bf16 v[44:47], a[16:19], a[220:223], v[44:47]
    v_add_u32 v3, 0x8000, v3
    v_fma_f32 v227, v227, s33, 0.5
    v_mfma_f32_16x16x32_bf16 v[44:47], a[0:3], a[228:231], v[44:47]
    ds_read_b128 a[216:219], v1 offset:32768
    v_fma_f32 v234, v226, v234, v226
    v_mfma_f32_16x16x32_bf16 v[44:47], a[188:191], a[212:215], v[44:47]
    buffer_load_dwordx4 a[40:43], v3, s[44:47], 0 offen offset:0 sc1
    v_fma_f32 v235, v227, v235, v227
    v_mfma_f32_16x16x32_bf16 v[60:63], a[188:191], a[228:231], v[60:63]
    v_rcp_f32 v234, v234
    v_mfma_f32_16x16x32_bf16 v[60:63], a[0:3], a[220:223], v[60:63]
    v_rcp_f32 v235, v235
    v_mfma_f32_16x16x32_bf16 v[60:63], a[16:19], a[244:247], v[60:63]
    v_fma_f32 v234, -v226, v234, v234
    v_fma_f32 v235, -v227, v235, v235
    v_mfma_f32_16x16x32_bf16 v[52:55], a[12:15], a[244:247], v[52:55]
    v_cvt_pk_bf16_f32 v224, v232, v233
    v_cvt_pk_bf16_f32 v225, v234, v235
    v_mfma_f32_16x16x32_bf16 v[52:55], a[108:111], a[220:223], v[52:55]
    v_exp_f32 v248, v248
    v_mfma_f32_16x16x32_bf16 v[52:55], a[172:175], a[228:231], v[52:55]
    buffer_load_dwordx4 a[32:35], v3, s[44:47], 0 offen offset:2048 sc1
    v_fma_f32 v228, v228, s33, 0.5
    v_mfma_f32_16x16x32_bf16 v[56:59], a[156:159], a[228:231], v[56:59]
    v_exp_f32 v249, v249
    v_mfma_f32_16x16x32_bf16 v[56:59], a[124:127], a[220:223], v[56:59]
    v_exp_f32 v240, v240 clamp
    v_mfma_f32_16x16x32_bf16 v[56:59], a[8:11], a[244:247], v[56:59]
    v_exp_f32 v241, v241 clamp
    v_mfma_f32_16x16x32_bf16 v[48:51], a[4:7], a[244:247], v[48:51]
    v_exp_f32 v250, v250
    v_mfma_f32_16x16x32_bf16 v[48:51], a[140:143], a[220:223], v[48:51]
    buffer_load_dwordx4 a[144:147], v3, s[44:47], 0 offen offset:1024 sc1
    ds_read_b128 a[248:251], v1 offset:34816
    v_mfma_f32_16x16x32_bf16 v[48:51], a[152:155], a[228:231], v[48:51]
    v_exp_f32 v251, v251
    v_mfma_f32_16x16x32_bf16 v[64:67], a[152:155], a[220:223], v[64:67]
    v_exp_f32 v242, v242 clamp
    v_mfma_f32_16x16x32_bf16 v[64:67], a[140:143], a[244:247], v[64:67]
    v_exp_f32 v243, v243 clamp
    v_mfma_f32_16x16x32_bf16 v[64:67], a[4:7], a[232:235], v[64:67]
    v_fma_f32 v229, v229, s33, 0.5
    v_fma_f32 v236, v228, v236, v228
    v_mfma_f32_16x16x32_bf16 v[72:75], a[8:11], a[232:235], v[72:75]
    v_fma_f32 v237, v229, v237, v229
    v_fma_f32 v230, v230, s33, 0.5
    v_mfma_f32_16x16x32_bf16 v[72:75], a[124:127], a[244:247], v[72:75]
    buffer_load_dwordx4 a[132:135], v3, s[44:47], 0 offen offset:3072 sc1
    v_fma_f32 v231, v231, s33, 0.5
    v_mfma_f32_16x16x32_bf16 v[72:75], a[156:159], a[220:223], v[72:75]
    v_rcp_f32 v236, v236
    v_mfma_f32_16x16x32_bf16 v[68:71], a[172:175], a[220:223], v[68:71]
    v_rcp_f32 v237, v237
    v_mfma_f32_16x16x32_bf16 v[68:71], a[108:111], a[244:247], v[68:71]
    v_add_u32 v3, 0x8000, v3
    v_fma_f32 v236, -v228, v236, v236
    v_mfma_f32_16x16x32_bf16 v[68:71], a[12:15], a[232:235], v[68:71]
    v_fma_f32 v237, -v229, v237, v237
    v_cvt_pk_bf16_f32 v226, v236, v237
    v_mfma_f32_16x16x32_bf16 v[76:79], a[16:19], a[232:235], v[76:79]
    buffer_load_dwordx4 a[120:123], v3, s[44:47], 0 offen offset:0 sc1
    v_fma_f32 v238, v230, v238, v230
    v_mfma_f32_16x16x32_bf16 v[76:79], a[0:3], a[244:247], v[76:79]
    ds_read_b128 a[208:211], v1 offset:36864
    v_fma_f32 v239, v231, v239, v231
    v_mfma_f32_16x16x32_bf16 v[76:79], a[188:191], a[220:223], v[76:79]
    v_rcp_f32 v238, v238
    v_mfma_f32_16x16x32_bf16 v[92:95], a[188:191], a[244:247], v[92:95]
    v_rcp_f32 v239, v239
    v_mfma_f32_16x16x32_bf16 v[92:95], a[0:3], a[232:235], v[92:95]
    s_waitcnt lgkmcnt(1)
    v_exp_f32 v252, v252
    v_mfma_f32_16x16x32_bf16 v[92:95], a[16:19], a[240:243], v[92:95]
    v_exp_f32 v253, v253
    v_mfma_f32_16x16x32_bf16 v[84:87], a[12:15], a[240:243], v[84:87]
    buffer_load_dwordx4 a[136:139], v3, s[44:47], 0 offen offset:2048 sc1
    v_fma_f32 v238, -v230, v238, v238
    v_mfma_f32_16x16x32_bf16 v[84:87], a[108:111], a[232:235], v[84:87]
    v_exp_f32 v244, v244 clamp
    v_mfma_f32_16x16x32_bf16 v[84:87], a[172:175], a[244:247], v[84:87]
    v_mfma_f32_16x16x32_bf16 v[88:91], a[156:159], a[244:247], v[88:91]
    v_mfma_f32_16x16x32_bf16 v[88:91], a[124:127], a[232:235], v[88:91]
    v_mfma_f32_16x16x32_bf16 v[88:91], a[8:11], a[240:243], v[88:91]
    v_mfma_f32_16x16x32_bf16 v[80:83], a[4:7], a[240:243], v[80:83]
    buffer_load_dwordx4 a[116:119], v3, s[44:47], 0 offen offset:1024 sc1
    v_fma_f32 v239, -v231, v239, v239
    v_mfma_f32_16x16x32_bf16 v[80:83], a[140:143], a[232:235], v[80:83]
    ds_read_b128 a[236:239], v1 offset:38912
    v_cvt_pk_bf16_f32 v227, v238, v239
    v_mfma_f32_16x16x32_bf16 v[80:83], a[152:155], a[244:247], v[80:83]
    v_permlane16_swap_b32 v224, v226
    v_mfma_f32_16x16x32_bf16 v[96:99], a[152:155], a[232:235], v[96:99]
    v_permlane16_swap_b32 v225, v227
    v_mfma_f32_16x16x32_bf16 v[96:99], a[140:143], a[240:243], v[96:99]
    buffer_store_dwordx4 v[224:227], v4, s[20:23], s53 offen offset:0 sc1
    v_mfma_f32_16x16x32_bf16 v[96:99], a[4:7], a[216:219], v[96:99]
    buffer_load_dwordx4 a[148:151], v3, s[44:47], 0 offen offset:3072 sc1
    v_fma_f32 v240, v240, s33, 0.5
    v_mfma_f32_16x16x32_bf16 v[104:107], a[8:11], a[216:219], v[104:107]
    v_exp_f32 v245, v245 clamp
    v_mfma_f32_16x16x32_bf16 v[104:107], a[124:127], a[240:243], v[104:107]
    v_exp_f32 v254, v254
    v_mfma_f32_16x16x32_bf16 v[104:107], a[156:159], a[232:235], v[104:107]
    v_add_u32 v3, 0x8000, v3
    v_fma_f32 v241, v241, s33, 0.5
    v_mfma_f32_16x16x32_bf16 v[100:103], a[172:175], a[232:235], v[100:103]
    v_exp_f32 v255, v255
    v_mfma_f32_16x16x32_bf16 v[100:103], a[108:111], a[240:243], v[100:103]
    buffer_load_dwordx4 a[164:167], v3, s[44:47], 0 offen offset:0 sc1
    v_add_u32 v0, 0xa000, v0
    v_mfma_f32_16x16x32_bf16 v[100:103], a[12:15], a[216:219], v[100:103]
    v_add_u32 v1, 0xa000, v1
    v_fma_f32 v248, v240, v248, v240
    v_mfma_f32_16x16x32_bf16 v[108:111], a[16:19], a[216:219], v[108:111]
    ds_read_b128 a[224:227], v0 offset:40960
    ds_read_b128 a[252:255], v0 offset:43008
    v_mfma_f32_16x16x32_bf16 v[108:111], a[0:3], a[240:243], v[108:111]
    v_exp_f32 v246, v246 clamp
    v_mfma_f32_16x16x32_bf16 v[108:111], a[188:191], a[232:235], v[108:111]
    v_exp_f32 v247, v247 clamp
    v_mfma_f32_16x16x32_bf16 v[124:127], a[188:191], a[240:243], v[124:127]
    v_fma_f32 v249, v241, v249, v241
    v_fma_f32 v242, v242, s33, 0.5
    v_mfma_f32_16x16x32_bf16 v[124:127], a[0:3], a[216:219], v[124:127]
    buffer_load_dwordx4 a[100:103], v3, s[44:47], 0 offen offset:2048 sc1
    v_fma_f32 v243, v243, s33, 0.5
    v_mfma_f32_16x16x32_bf16 v[124:127], a[16:19], a[248:251], v[124:127]
    v_rcp_f32 v248, v248
    v_mfma_f32_16x16x32_bf16 v[116:119], a[12:15], a[248:251], v[116:119]
    v_rcp_f32 v249, v249
    v_mfma_f32_16x16x32_bf16 v[116:119], a[108:111], a[216:219], v[116:119]
    v_fma_f32 v248, -v240, v248, v248
    v_fma_f32 v249, -v241, v249, v249
    v_mfma_f32_16x16x32_bf16 v[116:119], a[172:175], a[240:243], v[116:119]
    ds_read_b128 a[200:203], v0 offset:45056
    v_fma_f32 v250, v242, v250, v242
    v_mfma_f32_16x16x32_bf16 v[120:123], a[156:159], a[240:243], v[120:123]
    buffer_load_dwordx4 a[184:187], v3, s[44:47], 0 offen offset:1024 sc1
    v_fma_f32 v251, v243, v251, v243
    v_mfma_f32_16x16x32_bf16 v[120:123], a[124:127], a[216:219], v[120:123]
    v_rcp_f32 v250, v250
    v_mfma_f32_16x16x32_bf16 v[120:123], a[8:11], a[248:251], v[120:123]
    v_rcp_f32 v251, v251
    v_mfma_f32_16x16x32_bf16 v[112:115], a[4:7], a[248:251], v[112:115]
    v_fma_f32 v250, -v242, v250, v250
    v_fma_f32 v251, -v243, v251, v251
    v_mfma_f32_16x16x32_bf16 v[112:115], a[140:143], a[216:219], v[112:115]
    v_cvt_pk_bf16_f32 v240, v248, v249
    v_cvt_pk_bf16_f32 v241, v250, v251
    v_mfma_f32_16x16x32_bf16 v[112:115], a[152:155], a[240:243], v[112:115]
    v_exp_f32 v168, v168
    v_mfma_f32_16x16x32_bf16 v[128:131], a[152:155], a[216:219], v[128:131]
    buffer_load_dwordx4 a[168:171], v3, s[44:47], 0 offen offset:3072 sc1
    v_fma_f32 v244, v244, s33, 0.5
    v_mfma_f32_16x16x32_bf16 v[128:131], a[140:143], a[248:251], v[128:131]
    s_waitcnt lgkmcnt(1)
    ds_read_b128 a[204:207], v0 offset:47104
    v_fma_f32 v245, v245, s33, 0.5
    v_mfma_f32_16x16x32_bf16 v[128:131], a[4:7], a[208:211], v[128:131]
    v_exp_f32 v169, v169
    v_mfma_f32_16x16x32_bf16 v[136:139], a[8:11], a[208:211], v[136:139]
    v_add_u32 v3, 0x8000, v3
    v_fma_f32 v252, v244, v252, v244
    v_mfma_f32_16x16x32_bf16 v[136:139], a[124:127], a[248:251], v[136:139]
    v_exp_f32 v160, v160 clamp
    v_mfma_f32_16x16x32_bf16 v[136:139], a[156:159], a[216:219], v[136:139]
    buffer_load_dwordx4 a[104:107], v3, s[44:47], 0 offen offset:0 sc1
    v_fma_f32 v253, v245, v253, v245
    v_mfma_f32_16x16x32_bf16 v[132:135], a[172:175], a[216:219], v[132:135]
    v_rcp_f32 v252, v252
    v_mfma_f32_16x16x32_bf16 v[132:135], a[108:111], a[248:251], v[132:135]
    v_rcp_f32 v253, v253
    v_mfma_f32_16x16x32_bf16 v[132:135], a[12:15], a[208:211], v[132:135]
    v_exp_f32 v161, v161 clamp
    v_mfma_f32_16x16x32_bf16 v[140:143], a[16:19], a[208:211], v[140:143]
    ds_read_b128 a[212:215], v0 offset:49152
    v_fma_f32 v252, -v244, v252, v252
    v_mfma_f32_16x16x32_bf16 v[140:143], a[0:3], a[248:251], v[140:143]
    v_exp_f32 v170, v170
    v_mfma_f32_16x16x32_bf16 v[140:143], a[188:191], a[216:219], v[140:143]
    buffer_load_dwordx4 a[180:183], v3, s[44:47], 0 offen offset:2048 sc1
    v_fma_f32 v253, -v245, v253, v253
    v_mfma_f32_16x16x32_bf16 v[144:147], a[152:155], a[248:251], v[144:147]
    v_exp_f32 v171, v171
    v_mfma_f32_16x16x32_bf16 v[144:147], a[140:143], a[208:211], v[144:147]
    v_exp_f32 v162, v162 clamp
    v_mfma_f32_16x16x32_bf16 v[144:147], a[4:7], a[236:239], v[144:147]
    v_exp_f32 v163, v163 clamp
    v_mfma_f32_16x16x32_bf16 v[152:155], a[8:11], a[236:239], v[152:155]
    v_cvt_pk_bf16_f32 v242, v252, v253
    v_fma_f32 v246, v246, s33, 0.5
    v_mfma_f32_16x16x32_bf16 v[152:155], a[124:127], a[208:211], v[152:155]
    buffer_load_dwordx4 a[152:155], v3, s[44:47], 0 offen offset:1024 sc1
    v_fma_f32 v247, v247, s33, 0.5
    v_mfma_f32_16x16x32_bf16 v[152:155], a[156:159], a[248:251], v[152:155]
    ds_read_b128 a[228:231], v0 offset:51200
    v_fma_f32 v254, v246, v254, v246
    v_mfma_f32_16x16x32_bf16 v[148:151], a[172:175], a[248:251], v[148:151]
    v_exp_f32 v172, v172
    v_mfma_f32_16x16x32_bf16 v[148:151], a[108:111], a[208:211], v[148:151]
    v_exp_f32 v173, v173
    v_mfma_f32_16x16x32_bf16 v[148:151], a[12:15], a[236:239], v[148:151]
    v_exp_f32 v164, v164 clamp
    v_mfma_f32_16x16x32_bf16 v[156:159], a[16:19], a[236:239], v[156:159]
    v_exp_f32 v165, v165 clamp
    v_mfma_f32_16x16x32_bf16 v[156:159], a[0:3], a[208:211], v[156:159]
    buffer_load_dwordx4 a[140:143], v3, s[44:47], 0 offen offset:3072 sc1
    v_fma_f32 v255, v247, v255, v247
    v_mfma_f32_16x16x32_bf16 v[156:159], a[188:191], a[248:251], v[156:159]
    v_rcp_f32 v254, v254
    v_mfma_f32_16x16x32_bf16 v[32:35], a[20:23], a[224:227], v[32:35]
    v_rcp_f32 v255, v255
    v_mfma_f32_16x16x32_bf16 v[32:35], a[48:51], a[252:255], v[32:35]
    s_waitcnt vmcnt(30) lgkmcnt(1)
    ds_read_b128 a[220:223], v0 offset:53248
    v_add_u32 v3, 0x8000, v3
    v_mfma_f32_16x16x32_bf16 v[40:43], a[56:59], a[252:255], v[40:43]
    v_fma_f32 v254, -v246, v254, v254
    v_fma_f32 v255, -v247, v255, v255
    v_mfma_f32_16x16x32_bf16 v[40:43], a[24:27], a[224:227], v[40:43]
    buffer_load_dwordx4 a[4:7], v3, s[44:47], 0 offen offset:0 sc1
    v_cvt_pk_bf16_f32 v243, v254, v255
    v_mfma_f32_16x16x32_bf16 v[36:39], a[28:31], a[224:227], v[36:39]
    s_barrier
    v_permlane16_swap_b32 v240, v242
    v_mfma_f32_16x16x32_bf16 v[36:39], a[112:115], a[252:255], v[36:39]
    v_permlane16_swap_b32 v241, v243
    v_mfma_f32_16x16x32_bf16 v[44:47], a[88:91], a[252:255], v[44:47]
    buffer_store_dwordx4 v[240:243], v4, s[20:23], s53 offen offset:2048 sc1
    v_mfma_f32_16x16x32_bf16 v[44:47], a[192:195], a[224:227], v[44:47]
    v_exp_f32 v174, v174
    v_mfma_f32_16x16x32_bf16 v[60:63], a[192:195], a[252:255], v[60:63]
    v_exp_f32 v175, v175
    v_mfma_f32_16x16x32_bf16 v[60:63], a[88:91], a[200:203], v[60:63]
    buffer_load_dwordx4 a[8:11], v3, s[44:47], 0 offen offset:2048 sc1
    ds_read_b128 a[244:247], v0 offset:55296
    v_mfma_f32_16x16x32_bf16 v[52:55], a[112:115], a[200:203], v[52:55]
    v_exp_f32 v166, v166 clamp
    v_mfma_f32_16x16x32_bf16 v[52:55], a[28:31], a[252:255], v[52:55]
    v_exp_f32 v167, v167 clamp
    v_mfma_f32_16x16x32_bf16 v[56:59], a[24:27], a[252:255], v[56:59]
    v_fma_f32 v160, v160, s33, 0.5
    v_fma_f32 v161, v161, s33, 0.5
    v_mfma_f32_16x16x32_bf16 v[56:59], a[56:59], a[200:203], v[56:59]
    v_fma_f32 v168, v160, v168, v160
    v_fma_f32 v169, v161, v169, v161
    v_mfma_f32_16x16x32_bf16 v[48:51], a[48:51], a[200:203], v[48:51]
    buffer_load_dwordx4 a[124:127], v3, s[44:47], 0 offen offset:1024 sc1
    v_fma_f32 v162, v162, s33, 0.5
    v_mfma_f32_16x16x32_bf16 v[48:51], a[20:23], a[252:255], v[48:51]
    v_rcp_f32 v168, v168
    v_mfma_f32_16x16x32_bf16 v[64:67], a[20:23], a[200:203], v[64:67]
    v_rcp_f32 v169, v169
    v_mfma_f32_16x16x32_bf16 v[64:67], a[48:51], a[204:207], v[64:67]
    ds_read_b128 a[232:235], v0 offset:57344
    v_fma_f32 v168, -v160, v168, v168
    v_mfma_f32_16x16x32_bf16 v[72:75], a[56:59], a[204:207], v[72:75]
    v_fma_f32 v169, -v161, v169, v169
    v_fma_f32 v163, v163, s33, 0.5
    v_mfma_f32_16x16x32_bf16 v[72:75], a[24:27], a[200:203], v[72:75]
    v_fma_f32 v170, v162, v170, v162
    v_fma_f32 v171, v163, v171, v163
    v_mfma_f32_16x16x32_bf16 v[68:71], a[28:31], a[200:203], v[68:71]
    buffer_load_dwordx4 a[156:159], v3, s[44:47], 0 offen offset:3072 sc1
    v_fma_f32 v164, v164, s33, 0.5
    v_mfma_f32_16x16x32_bf16 v[68:71], a[112:115], a[204:207], v[68:71]
    v_rcp_f32 v170, v170
    v_mfma_f32_16x16x32_bf16 v[76:79], a[88:91], a[204:207], v[76:79]
    v_rcp_f32 v171, v171
    v_mfma_f32_16x16x32_bf16 v[76:79], a[192:195], a[200:203], v[76:79]
    v_add_u32 v3, 0x8000, v3
    v_fma_f32 v170, -v162, v170, v170
    v_mfma_f32_16x16x32_bf16 v[92:95], a[192:195], a[204:207], v[92:95]
    ds_read_b128 a[240:243], v0 offset:45056
    v_fma_f32 v171, -v163, v171, v171
    v_mfma_f32_16x16x32_bf16 v[92:95], a[88:91], a[212:215], v[92:95]
    buffer_load_dwordx4 a[172:175], v3, s[44:47], 0 offen offset:0 sc1
    v_cvt_pk_bf16_f32 v160, v168, v169
    v_mfma_f32_16x16x32_bf16 v[84:87], a[112:115], a[212:215], v[84:87]
    v_exp_f32 v184, v184
    v_mfma_f32_16x16x32_bf16 v[84:87], a[28:31], a[204:207], v[84:87]
    v_exp_f32 v185, v185
    v_mfma_f32_16x16x32_bf16 v[88:91], a[24:27], a[204:207], v[88:91]
    ds_read_b128 a[216:219], v1 offset:40960
    v_cvt_pk_bf16_f32 v161, v170, v171
    v_mfma_f32_16x16x32_bf16 v[88:91], a[56:59], a[212:215], v[88:91]
    ds_read_b128 a[236:239], v1 offset:43008
    v_fma_f32 v165, v165, s33, 0.5
    v_mfma_f32_16x16x32_bf16 v[80:83], a[48:51], a[212:215], v[80:83]
    ds_read_b128 a[208:211], v1 offset:45056
    v_fma_f32 v172, v164, v172, v164
    v_mfma_f32_16x16x32_bf16 v[80:83], a[20:23], a[204:207], v[80:83]
    buffer_load_dwordx4 a[108:111], v3, s[44:47], 0 offen offset:2048 sc1
    v_fma_f32 v173, v165, v173, v165
    v_mfma_f32_16x16x32_bf16 v[96:99], a[20:23], a[212:215], v[96:99]
    s_waitcnt lgkmcnt(4)
    v_rcp_f32 v172, v172
    v_mfma_f32_16x16x32_bf16 v[96:99], a[48:51], a[228:231], v[96:99]
    v_rcp_f32 v173, v173
    v_mfma_f32_16x16x32_bf16 v[104:107], a[56:59], a[228:231], v[104:107]
    v_exp_f32 v176, v176 clamp
    v_mfma_f32_16x16x32_bf16 v[104:107], a[24:27], a[212:215], v[104:107]
    v_exp_f32 v177, v177 clamp
    v_mfma_f32_16x16x32_bf16 v[100:103], a[28:31], a[212:215], v[100:103]
    buffer_load_dwordx4 a[12:15], v3, s[44:47], 0 offen offset:1024 sc1
    v_fma_f32 v172, -v164, v172, v172
    v_mfma_f32_16x16x32_bf16 v[100:103], a[112:115], a[228:231], v[100:103]
    v_exp_f32 v186, v186
    v_mfma_f32_16x16x32_bf16 v[108:111], a[88:91], a[228:231], v[108:111]
    v_exp_f32 v187, v187
    v_mfma_f32_16x16x32_bf16 v[108:111], a[192:195], a[212:215], v[108:111]
    v_exp_f32 v178, v178 clamp
    v_mfma_f32_16x16x32_bf16 v[124:127], a[192:195], a[228:231], v[124:127]
    ds_read_b128 a[248:251], v0 offset:0
    v_fma_f32 v173, -v165, v173, v173
    v_mfma_f32_16x16x32_bf16 v[124:127], a[88:91], a[220:223], v[124:127]
    ds_read_b128 a[224:227], v0 offset:2048
    v_cvt_pk_bf16_f32 v162, v172, v173
    v_mfma_f32_16x16x32_bf16 v[116:119], a[112:115], a[220:223], v[116:119]
    buffer_load_dwordx4 a[16:19], v3, s[44:47], 0 offen offset:3072 sc1
    ds_read_b128 a[252:255], v0 offset:4096
    v_mfma_f32_16x16x32_bf16 v[116:119], a[28:31], a[228:231], v[116:119]
    v_exp_f32 v179, v179 clamp
    v_mfma_f32_16x16x32_bf16 v[120:123], a[24:27], a[228:231], v[120:123]
    v_exp_f32 v188, v188
    v_mfma_f32_16x16x32_bf16 v[120:123], a[56:59], a[220:223], v[120:123]
    v_exp_f32 v189, v189
    v_mfma_f32_16x16x32_bf16 v[112:115], a[48:51], a[220:223], v[112:115]
    v_exp_f32 v180, v180 clamp
    v_mfma_f32_16x16x32_bf16 v[112:115], a[20:23], a[228:231], v[112:115]
    v_exp_f32 v181, v181 clamp
    v_mfma_f32_16x16x32_bf16 v[128:131], a[20:23], a[220:223], v[128:131]
    v_fma_f32 v166, v166, s33, 0.5
    v_fma_f32 v167, v167, s33, 0.5
    v_mfma_f32_16x16x32_bf16 v[128:131], a[48:51], a[244:247], v[128:131]
    v_fma_f32 v174, v166, v174, v166
    v_fma_f32 v175, v167, v175, v167
    v_mfma_f32_16x16x32_bf16 v[136:139], a[56:59], a[244:247], v[136:139]
    v_rcp_f32 v174, v174
    v_mfma_f32_16x16x32_bf16 v[136:139], a[24:27], a[220:223], v[136:139]
    v_rcp_f32 v175, v175
    v_mfma_f32_16x16x32_bf16 v[132:135], a[28:31], a[220:223], v[132:135]
    ds_read_b128 a[200:203], v1 offset:0
    v_fma_f32 v174, -v166, v174, v174
    v_mfma_f32_16x16x32_bf16 v[132:135], a[112:115], a[244:247], v[132:135]
    ds_read_b128 a[204:207], v1 offset:2048
    v_fma_f32 v175, -v167, v175, v175
    v_mfma_f32_16x16x32_bf16 v[140:143], a[88:91], a[244:247], v[140:143]
    ds_read_b128 a[212:215], v1 offset:4096
    v_cvt_pk_bf16_f32 v163, v174, v175
    v_mfma_f32_16x16x32_bf16 v[140:143], a[192:195], a[220:223], v[140:143]
    v_permlane16_swap_b32 v160, v162
    v_mfma_f32_16x16x32_bf16 v[144:147], a[20:23], a[244:247], v[144:147]
    v_permlane16_swap_b32 v161, v163
    v_mfma_f32_16x16x32_bf16 v[144:147], a[48:51], a[232:235], v[144:147]
    buffer_store_dwordx4 v[160:163], v4, s[20:23], s54 offen offset:0 sc1
    v_mfma_f32_16x16x32_bf16 v[152:155], a[56:59], a[232:235], v[152:155]
    v_exp_f32 v190, v190
    v_mfma_f32_16x16x32_bf16 v[152:155], a[24:27], a[244:247], v[152:155]
    v_exp_f32 v191, v191
    v_mfma_f32_16x16x32_bf16 v[148:151], a[28:31], a[244:247], v[148:151]
    v_exp_f32 v182, v182 clamp
    v_mfma_f32_16x16x32_bf16 v[148:151], a[112:115], a[232:235], v[148:151]
    v_exp_f32 v183, v183 clamp
    v_mfma_f32_16x16x32_bf16 v[156:159], a[88:91], a[232:235], v[156:159]
    v_fma_f32 v176, v176, s33, 0.5
    v_fma_f32 v177, v177, s33, 0.5
    v_mfma_f32_16x16x32_bf16 v[156:159], a[192:195], a[244:247], v[156:159]
    s_waitcnt lgkmcnt(3)
    v_fma_f32 v184, v176, v184, v176
    v_fma_f32 v185, v177, v185, v177
    v_mfma_f32_16x16x32_bf16 v[32:35], a[80:83], a[240:243], v[32:35]
    ds_read_b128 a[228:231], v0 offset:47104
    v_fma_f32 v178, v178, s33, 0.5
    v_mfma_f32_16x16x32_bf16 v[40:43], a[84:87], a[240:243], v[40:43]
    ds_read_b128 a[220:223], v1 offset:47104
    v_fma_f32 v179, v179, s33, 0.5
    v_mfma_f32_16x16x32_bf16 v[36:39], a[92:95], a[240:243], v[36:39]
    v_rcp_f32 v184, v184
    v_mfma_f32_16x16x32_bf16 v[44:47], a[128:131], a[240:243], v[44:47]
    v_rcp_f32 v185, v185
    v_mfma_f32_16x16x32_bf16 v[32:35], a[60:63], a[216:219], v[32:35]
    s_waitcnt vmcnt(35) lgkmcnt(2)
    v_fma_f32 v184, -v176, v184, v184
    v_fma_f32 v185, -v177, v185, v185
    v_mfma_f32_16x16x32_bf16 v[32:35], a[44:47], a[236:239], v[32:35]
    s_waitcnt vmcnt(30)
    v_fma_f32 v186, v178, v186, v178
    v_fma_f32 v187, v179, v187, v179
    v_mfma_f32_16x16x32_bf16 v[32:35], a[72:75], a[208:211], v[32:35]
    ds_read_b128 a[232:235], v0 offset:6144
    v_fma_f32 v180, v180, s33, 0.5
    v_mfma_f32_16x16x32_bf16 v[40:43], a[52:55], a[216:219], v[40:43]
    ds_read_b128 a[244:247], v1 offset:6144
    v_fma_f32 v181, v181, s33, 0.5
    v_mfma_f32_16x16x32_bf16 v[40:43], a[176:179], a[236:239], v[40:43]
    v_rcp_f32 v186, v186
    v_mfma_f32_16x16x32_bf16 v[40:43], a[96:99], a[208:211], v[40:43]
    v_rcp_f32 v187, v187
    v_mfma_f32_16x16x32_bf16 v[36:39], a[196:199], a[216:219], v[36:39]
    v_fma_f32 v186, -v178, v186, v186
    v_fma_f32 v187, -v179, v187, v187
    v_mfma_f32_16x16x32_bf16 v[36:39], a[76:79], a[236:239], v[36:39]
    s_waitcnt vmcnt(28)
    v_cvt_pk_bf16_f32 v176, v184, v185
    v_cvt_pk_bf16_f32 v177, v186, v187
    v_mfma_f32_16x16x32_bf16 v[36:39], a[160:163], a[208:211], v[36:39]
    v_fma_f32 v188, v180, v188, v180
    v_fma_f32 v189, v181, v189, v181
    v_mfma_f32_16x16x32_bf16 v[44:47], a[36:39], a[216:219], v[44:47]
    v_rcp_f32 v188, v188
    v_mfma_f32_16x16x32_bf16 v[44:47], a[68:71], a[236:239], v[44:47]
    s_waitcnt vmcnt(20) lgkmcnt(2)
    v_rcp_f32 v189, v189
    v_mfma_f32_16x16x32_bf16 v[44:47], a[64:67], a[208:211], v[44:47]
    v_fma_f32 v188, -v180, v188, v188
    v_fma_f32 v189, -v181, v189, v189
    v_mfma_f32_16x16x32_bf16 v[32:35], a[40:43], a[248:251], v[32:35]
    v_cvt_pk_bf16_f32 v178, v188, v189
    v_fma_f32 v182, v182, s33, 0.5
    v_mfma_f32_16x16x32_bf16 v[32:35], a[120:123], a[224:227], v[32:35]
    s_waitcnt vmcnt(17)
    v_fma_f32 v183, v183, s33, 0.5
    v_fma_f32 v190, v182, v190, v182
    v_mfma_f32_16x16x32_bf16 v[32:35], a[164:167], a[252:255], v[32:35]
    v_fma_f32 v191, v183, v191, v183
    v_mbcnt_hi_u32_b32 v5, -1, v5
    v_mfma_f32_16x16x32_bf16 v[40:43], a[32:35], a[248:251], v[40:43]
    v_rcp_f32 v190, v190
    v_mfma_f32_16x16x32_bf16 v[40:43], a[136:139], a[224:227], v[40:43]
    s_waitcnt vmcnt(13) lgkmcnt(0)
    v_rcp_f32 v191, v191
    v_mfma_f32_16x16x32_bf16 v[40:43], a[100:103], a[252:255], v[40:43]
    v_fma_f32 v190, -v182, v190, v190
    v_fma_f32 v191, -v183, v191, v191
    v_mfma_f32_16x16x32_bf16 v[36:39], a[144:147], a[248:251], v[36:39]
    v_cvt_pk_bf16_f32 v179, v190, v191
    v_and_b32 v5, 14, v5
    v_mfma_f32_16x16x32_bf16 v[36:39], a[116:119], a[224:227], v[36:39]
    v_permlane16_swap_b32 v176, v178
    v_mfma_f32_16x16x32_bf16 v[36:39], a[184:187], a[252:255], v[36:39]
    v_permlane16_swap_b32 v177, v179
    v_mfma_f32_16x16x32_bf16 v[44:47], a[132:135], a[248:251], v[44:47]
    buffer_store_dwordx4 v[176:179], v4, s[20:23], s54 offen offset:2048 sc1
    v_mfma_f32_16x16x32_bf16 v[44:47], a[148:151], a[224:227], v[44:47]
    v_add_u32 v5, 2, v5
    v_and_b32 v5, 16, v5
    v_mfma_f32_16x16x32_bf16 v[44:47], a[168:171], a[252:255], v[44:47]
    v_lshlrev_b32 v5, 26, v5
    v_or_b32 v5, v5, v4
    v_mfma_f32_16x16x32_bf16 v[32:35], a[104:107], a[200:203], v[32:35]
    s_waitcnt vmcnt(10)
    v_mfma_f32_16x16x32_bf16 v[32:35], a[4:7], a[204:207], v[32:35]
    s_waitcnt vmcnt(5)
    v_mfma_f32_16x16x32_bf16 v[32:35], a[172:175], a[212:215], v[32:35]
    v_mfma_f32_16x16x32_bf16 v[40:43], a[180:183], a[200:203], v[40:43]
    v_mfma_f32_16x16x32_bf16 v[40:43], a[8:11], a[204:207], v[40:43]
    s_waitcnt vmcnt(4)
    v_mfma_f32_16x16x32_bf16 v[40:43], a[108:111], a[212:215], v[40:43]
    v_mfma_f32_16x16x32_bf16 v[36:39], a[152:155], a[200:203], v[36:39]
    v_mfma_f32_16x16x32_bf16 v[36:39], a[124:127], a[204:207], v[36:39]
    s_waitcnt vmcnt(3)
    v_mfma_f32_16x16x32_bf16 v[36:39], a[12:15], a[212:215], v[36:39]
    v_mfma_f32_16x16x32_bf16 v[44:47], a[140:143], a[200:203], v[44:47]
    v_mfma_f32_16x16x32_bf16 v[44:47], a[156:159], a[204:207], v[44:47]
    s_waitcnt vmcnt(2)
    v_mfma_f32_16x16x32_bf16 v[44:47], a[16:19], a[212:215], v[44:47]
    v_exp_f32 v40, v40
    v_mfma_f32_16x16x32_bf16 v[48:51], a[80:83], a[228:231], v[48:51]
    ds_read_b128 a[240:243], v0 offset:49152
    v_mfma_f32_16x16x32_bf16 v[48:51], a[72:75], a[220:223], v[48:51]
    ds_read_b128 a[216:219], v1 offset:49152
    v_mfma_f32_16x16x32_bf16 v[48:51], a[44:47], a[208:211], v[48:51]
    v_exp_f32 v41, v41
    v_mfma_f32_16x16x32_bf16 v[48:51], a[60:63], a[236:239], v[48:51]
    v_exp_f32 v32, v32 clamp
    v_mfma_f32_16x16x32_bf16 v[48:51], a[40:43], a[224:227], v[48:51]
    v_exp_f32 v33, v33 clamp
    v_mfma_f32_16x16x32_bf16 v[48:51], a[120:123], a[252:255], v[48:51]
    v_exp_f32 v42, v42
    v_mfma_f32_16x16x32_bf16 v[48:51], a[164:167], a[232:235], v[48:51]
    ds_read_b128 a[248:251], v0 offset:8192
    v_fma_f32 v32, v32, s33, 0.5
    v_mfma_f32_16x16x32_bf16 v[48:51], a[172:175], a[244:247], v[48:51]
    ds_read_b128 a[200:203], v1 offset:8192
    v_fma_f32 v33, v33, s33, 0.5
    v_mfma_f32_16x16x32_bf16 v[48:51], a[4:7], a[212:215], v[48:51]
    v_exp_f32 v43, v43
    v_mfma_f32_16x16x32_bf16 v[48:51], a[104:107], a[204:207], v[48:51]
    v_exp_f32 v34, v34 clamp
    v_mfma_f32_16x16x32_bf16 v[56:59], a[180:183], a[204:207], v[56:59]
    v_exp_f32 v35, v35 clamp
    v_mfma_f32_16x16x32_bf16 v[56:59], a[8:11], a[212:215], v[56:59]
    v_exp_f32 v44, v44
    v_mfma_f32_16x16x32_bf16 v[56:59], a[108:111], a[244:247], v[56:59]
    v_exp_f32 v45, v45
    v_mfma_f32_16x16x32_bf16 v[56:59], a[100:103], a[232:235], v[56:59]
    v_exp_f32 v36, v36 clamp
    v_mfma_f32_16x16x32_bf16 v[56:59], a[136:139], a[252:255], v[56:59]
    v_exp_f32 v37, v37 clamp
    v_mfma_f32_16x16x32_bf16 v[56:59], a[32:35], a[224:227], v[56:59]
    v_exp_f32 v46, v46
    v_mfma_f32_16x16x32_bf16 v[56:59], a[52:55], a[236:239], v[56:59]
    v_exp_f32 v47, v47
    v_mfma_f32_16x16x32_bf16 v[56:59], a[176:179], a[208:211], v[56:59]
    v_exp_f32 v38, v38 clamp
    v_mfma_f32_16x16x32_bf16 v[56:59], a[96:99], a[220:223], v[56:59]
    v_exp_f32 v39, v39 clamp
    v_mfma_f32_16x16x32_bf16 v[56:59], a[84:87], a[228:231], v[56:59]
    v_fma_f32 v40, v32, v40, v32
    v_fma_f32 v41, v33, v41, v33
    v_mfma_f32_16x16x32_bf16 v[52:55], a[92:95], a[228:231], v[52:55]
    v_rcp_f32 v40, v40
    v_mfma_f32_16x16x32_bf16 v[52:55], a[160:163], a[220:223], v[52:55]
    v_rcp_f32 v41, v41
    v_mfma_f32_16x16x32_bf16 v[52:55], a[76:79], a[208:211], v[52:55]
    v_fma_f32 v40, v32, v40, -v40
    v_fma_f32 v41, v33, v41, -v41
    v_mfma_f32_16x16x32_bf16 v[52:55], a[196:199], a[236:239], v[52:55]
    v_fma_f32 v34, v34, s33, 0.5
    v_fma_f32 v35, v35, s33, 0.5
    v_mfma_f32_16x16x32_bf16 v[52:55], a[144:147], a[224:227], v[52:55]
    v_fma_f32 v42, v34, v42, v34
    v_fma_f32 v43, v35, v43, v35
    v_mfma_f32_16x16x32_bf16 v[52:55], a[116:119], a[252:255], v[52:55]
    v_rcp_f32 v42, v42
    v_mfma_f32_16x16x32_bf16 v[52:55], a[184:187], a[232:235], v[52:55]
    v_rcp_f32 v43, v43
    v_mfma_f32_16x16x32_bf16 v[52:55], a[12:15], a[244:247], v[52:55]
    v_fma_f32 v42, v34, v42, -v42
    v_fma_f32 v43, v35, v43, -v43
    v_mfma_f32_16x16x32_bf16 v[52:55], a[124:127], a[212:215], v[52:55]
    v_cvt_pk_bf16_f32 v32, v40, v41
    v_cvt_pk_bf16_f32 v33, v42, v43
    v_mfma_f32_16x16x32_bf16 v[52:55], a[152:155], a[204:207], v[52:55]
    v_exp_f32 v56, v56
    v_mfma_f32_16x16x32_bf16 v[60:63], a[140:143], a[204:207], v[60:63]
    v_exp_f32 v57, v57
    v_mfma_f32_16x16x32_bf16 v[60:63], a[156:159], a[212:215], v[60:63]
    v_exp_f32 v48, v48 clamp
    v_mfma_f32_16x16x32_bf16 v[60:63], a[16:19], a[244:247], v[60:63]
    v_exp_f32 v49, v49 clamp
    v_mfma_f32_16x16x32_bf16 v[60:63], a[168:171], a[232:235], v[60:63]
    v_exp_f32 v58, v58
    v_mfma_f32_16x16x32_bf16 v[60:63], a[148:151], a[252:255], v[60:63]
    v_exp_f32 v59, v59
    v_mfma_f32_16x16x32_bf16 v[60:63], a[132:135], a[224:227], v[60:63]
    v_exp_f32 v50, v50 clamp
    v_mfma_f32_16x16x32_bf16 v[60:63], a[36:39], a[236:239], v[60:63]
    v_exp_f32 v51, v51 clamp
    v_mfma_f32_16x16x32_bf16 v[60:63], a[68:71], a[208:211], v[60:63]
    v_fma_f32 v36, v36, s33, 0.5
    v_fma_f32 v37, v37, s33, 0.5
    v_mfma_f32_16x16x32_bf16 v[60:63], a[64:67], a[220:223], v[60:63]
    v_fma_f32 v44, v36, v44, v36
    v_fma_f32 v45, v37, v45, v37
    v_mfma_f32_16x16x32_bf16 v[60:63], a[128:131], a[228:231], v[60:63]
    s_waitcnt lgkmcnt(0)
    v_rcp_f32 v44, v44
    v_mfma_f32_16x16x32_bf16 v[64:67], a[80:83], a[240:243], v[64:67]
    ds_read_b128 a[204:207], v0 offset:51200
    v_fma_f32 v38, v38, s33, 0.5
    v_mfma_f32_16x16x32_bf16 v[64:67], a[72:75], a[216:219], v[64:67]
    ds_read_b128 a[224:227], v1 offset:51200
    v_fma_f32 v39, v39, s33, 0.5
    v_mfma_f32_16x16x32_bf16 v[64:67], a[44:47], a[220:223], v[64:67]
    v_rcp_f32 v45, v45
    v_mfma_f32_16x16x32_bf16 v[64:67], a[60:63], a[208:211], v[64:67]
    v_fma_f32 v44, v36, v44, -v44
    v_fma_f32 v45, v37, v45, -v45
    v_mfma_f32_16x16x32_bf16 v[64:67], a[40:43], a[252:255], v[64:67]
    v_cvt_pk_bf16_f32 v34, v44, v45
    v_fma_f32 v46, v38, v46, v38
    v_mfma_f32_16x16x32_bf16 v[64:67], a[120:123], a[232:235], v[64:67]
    v_exp_f32 v60, v60
    v_mfma_f32_16x16x32_bf16 v[64:67], a[164:167], a[248:251], v[64:67]
    ds_read_b128 a[236:239], v0 offset:10240
    v_fma_f32 v47, v39, v47, v39
    v_mfma_f32_16x16x32_bf16 v[64:67], a[172:175], a[200:203], v[64:67]
    ds_read_b128 a[228:231], v1 offset:10240
    v_fma_f32 v48, v48, s33, 0.5
    v_mfma_f32_16x16x32_bf16 v[64:67], a[4:7], a[244:247], v[64:67]
    v_rcp_f32 v46, v46
    v_mfma_f32_16x16x32_bf16 v[64:67], a[104:107], a[212:215], v[64:67]
    v_rcp_f32 v47, v47
    v_mfma_f32_16x16x32_bf16 v[72:75], a[180:183], a[212:215], v[72:75]
    v_exp_f32 v61, v61
    v_mfma_f32_16x16x32_bf16 v[72:75], a[8:11], a[244:247], v[72:75]
    v_exp_f32 v52, v52 clamp
    v_mfma_f32_16x16x32_bf16 v[72:75], a[108:111], a[200:203], v[72:75]
    v_exp_f32 v53, v53 clamp
    v_mfma_f32_16x16x32_bf16 v[72:75], a[100:103], a[248:251], v[72:75]
    v_fma_f32 v46, v38, v46, -v46
    v_fma_f32 v47, v39, v47, -v47
    v_mfma_f32_16x16x32_bf16 v[72:75], a[136:139], a[232:235], v[72:75]
    v_cvt_pk_bf16_f32 v35, v46, v47
    v_fma_f32 v49, v49, s33, 0.5
    v_mfma_f32_16x16x32_bf16 v[72:75], a[32:35], a[252:255], v[72:75]
    v_permlane16_swap_b32 v32, v34
    v_mfma_f32_16x16x32_bf16 v[72:75], a[52:55], a[208:211], v[72:75]
    v_permlane16_swap_b32 v33, v35
    v_mfma_f32_16x16x32_bf16 v[72:75], a[176:179], a[220:223], v[72:75]
    buffer_store_dwordx4 v[32:35], v4, s[20:23], 0 offen offset:1024 sc1
    v_mfma_f32_16x16x32_bf16 v[72:75], a[96:99], a[216:219], v[72:75]
    v_exp_f32 v62, v62
    v_mfma_f32_16x16x32_bf16 v[72:75], a[84:87], a[240:243], v[72:75]
    v_exp_f32 v63, v63
    v_mfma_f32_16x16x32_bf16 v[68:71], a[92:95], a[240:243], v[68:71]
    v_exp_f32 v54, v54 clamp
    v_mfma_f32_16x16x32_bf16 v[68:71], a[160:163], a[216:219], v[68:71]
    v_exp_f32 v55, v55 clamp
    v_mfma_f32_16x16x32_bf16 v[68:71], a[76:79], a[220:223], v[68:71]
    v_fma_f32 v56, v48, v56, v48
    v_fma_f32 v57, v49, v57, v49
    v_mfma_f32_16x16x32_bf16 v[68:71], a[196:199], a[208:211], v[68:71]
    v_rcp_f32 v56, v56
    v_mfma_f32_16x16x32_bf16 v[68:71], a[144:147], a[252:255], v[68:71]
    v_rcp_f32 v57, v57
    v_mfma_f32_16x16x32_bf16 v[68:71], a[116:119], a[232:235], v[68:71]
    v_fma_f32 v56, v48, v56, -v56
    v_fma_f32 v57, v49, v57, -v57
    v_mfma_f32_16x16x32_bf16 v[68:71], a[184:187], a[248:251], v[68:71]
    v_fma_f32 v50, v50, s33, 0.5
    v_fma_f32 v51, v51, s33, 0.5
    v_mfma_f32_16x16x32_bf16 v[68:71], a[12:15], a[200:203], v[68:71]
    v_fma_f32 v58, v50, v58, v50
    v_fma_f32 v59, v51, v59, v51
    v_mfma_f32_16x16x32_bf16 v[68:71], a[124:127], a[244:247], v[68:71]
    v_rcp_f32 v58, v58
    v_mfma_f32_16x16x32_bf16 v[68:71], a[152:155], a[212:215], v[68:71]
    v_rcp_f32 v59, v59
    v_mfma_f32_16x16x32_bf16 v[76:79], a[140:143], a[212:215], v[76:79]
    v_fma_f32 v58, v50, v58, -v58
    v_fma_f32 v59, v51, v59, -v59
    v_mfma_f32_16x16x32_bf16 v[76:79], a[156:159], a[244:247], v[76:79]
    v_cvt_pk_bf16_f32 v48, v56, v57
    v_cvt_pk_bf16_f32 v49, v58, v59
    v_mfma_f32_16x16x32_bf16 v[76:79], a[16:19], a[200:203], v[76:79]
    v_exp_f32 v72, v72
    v_mfma_f32_16x16x32_bf16 v[76:79], a[168:171], a[248:251], v[76:79]
    v_exp_f32 v73, v73
    v_mfma_f32_16x16x32_bf16 v[76:79], a[148:151], a[232:235], v[76:79]
    v_exp_f32 v64, v64 clamp
    v_mfma_f32_16x16x32_bf16 v[76:79], a[132:135], a[252:255], v[76:79]
    v_mfma_f32_16x16x32_bf16 v[76:79], a[36:39], a[208:211], v[76:79]
    v_mfma_f32_16x16x32_bf16 v[76:79], a[68:71], a[220:223], v[76:79]
    v_mfma_f32_16x16x32_bf16 v[76:79], a[64:67], a[216:219], v[76:79]
    v_mfma_f32_16x16x32_bf16 v[76:79], a[128:131], a[240:243], v[76:79]
    s_waitcnt lgkmcnt(0)
    v_exp_f32 v65, v65 clamp
    v_mfma_f32_16x16x32_bf16 v[80:83], a[80:83], a[204:207], v[80:83]
    ds_read_b128 a[212:215], v0 offset:53248
    v_fma_f32 v52, v52, s33, 0.5
    v_mfma_f32_16x16x32_bf16 v[80:83], a[72:75], a[224:227], v[80:83]
    ds_read_b128 a[252:255], v1 offset:53248
    v_fma_f32 v53, v53, s33, 0.5
    v_mfma_f32_16x16x32_bf16 v[80:83], a[44:47], a[216:219], v[80:83]
    v_exp_f32 v74, v74
    v_mfma_f32_16x16x32_bf16 v[80:83], a[60:63], a[220:223], v[80:83]
    v_exp_f32 v75, v75
    v_mfma_f32_16x16x32_bf16 v[80:83], a[40:43], a[232:235], v[80:83]
    v_exp_f32 v66, v66 clamp
    v_mfma_f32_16x16x32_bf16 v[80:83], a[120:123], a[248:251], v[80:83]
    v_exp_f32 v67, v67 clamp
    v_mfma_f32_16x16x32_bf16 v[80:83], a[164:167], a[236:239], v[80:83]
    ds_read_b128 a[208:211], v0 offset:12288
    v_fma_f32 v60, v52, v60, v52
    v_mfma_f32_16x16x32_bf16 v[80:83], a[172:175], a[228:231], v[80:83]
    ds_read_b128 a[240:243], v1 offset:12288
    v_fma_f32 v61, v53, v61, v53
    v_mfma_f32_16x16x32_bf16 v[80:83], a[4:7], a[200:203], v[80:83]
    v_rcp_f32 v60, v60
    v_mfma_f32_16x16x32_bf16 v[80:83], a[104:107], a[244:247], v[80:83]
    v_rcp_f32 v61, v61
    v_mfma_f32_16x16x32_bf16 v[88:91], a[180:183], a[244:247], v[88:91]
    v_fma_f32 v60, v52, v60, -v60
    v_fma_f32 v61, v53, v61, -v61
    v_mfma_f32_16x16x32_bf16 v[88:91], a[8:11], a[200:203], v[88:91]
    v_cvt_pk_bf16_f32 v50, v60, v61
    v_fma_f32 v54, v54, s33, 0.5
    v_mfma_f32_16x16x32_bf16 v[88:91], a[108:111], a[228:231], v[88:91]
    v_exp_f32 v76, v76
    v_mfma_f32_16x16x32_bf16 v[88:91], a[100:103], a[236:239], v[88:91]
    v_exp_f32 v77, v77
    v_mfma_f32_16x16x32_bf16 v[88:91], a[136:139], a[248:251], v[88:91]
    v_exp_f32 v68, v68 clamp
    v_mfma_f32_16x16x32_bf16 v[88:91], a[32:35], a[232:235], v[88:91]
    v_exp_f32 v69, v69 clamp
    v_mfma_f32_16x16x32_bf16 v[88:91], a[52:55], a[220:223], v[88:91]
    v_fma_f32 v55, v55, s33, 0.5
    v_fma_f32 v62, v54, v62, v54
    v_mfma_f32_16x16x32_bf16 v[88:91], a[176:179], a[216:219], v[88:91]
    v_fma_f32 v63, v55, v63, v55
    v_fma_f32 v64, v64, s33, 0.5
    v_mfma_f32_16x16x32_bf16 v[88:91], a[96:99], a[224:227], v[88:91]
    v_rcp_f32 v62, v62
    v_mfma_f32_16x16x32_bf16 v[88:91], a[84:87], a[204:207], v[88:91]
    v_rcp_f32 v63, v63
    v_mfma_f32_16x16x32_bf16 v[84:87], a[92:95], a[204:207], v[84:87]
    v_fma_f32 v62, v54, v62, -v62
    v_fma_f32 v63, v55, v63, -v63
    v_mfma_f32_16x16x32_bf16 v[84:87], a[160:163], a[224:227], v[84:87]
    v_cvt_pk_bf16_f32 v51, v62, v63
    v_fma_f32 v65, v65, s33, 0.5
    v_mfma_f32_16x16x32_bf16 v[84:87], a[76:79], a[216:219], v[84:87]
    v_permlane16_swap_b32 v48, v50
    v_mfma_f32_16x16x32_bf16 v[84:87], a[196:199], a[220:223], v[84:87]
    v_permlane16_swap_b32 v49, v51
    v_mfma_f32_16x16x32_bf16 v[84:87], a[144:147], a[232:235], v[84:87]
    buffer_store_dwordx4 v[48:51], v4, s[20:23], 0 offen offset:3072 sc1
    v_mfma_f32_16x16x32_bf16 v[84:87], a[116:119], a[248:251], v[84:87]
    v_exp_f32 v78, v78
    v_mfma_f32_16x16x32_bf16 v[84:87], a[184:187], a[236:239], v[84:87]
    v_exp_f32 v79, v79
    v_mfma_f32_16x16x32_bf16 v[84:87], a[12:15], a[228:231], v[84:87]
    v_exp_f32 v70, v70 clamp
    v_mfma_f32_16x16x32_bf16 v[84:87], a[124:127], a[200:203], v[84:87]
    v_exp_f32 v71, v71 clamp
    v_mfma_f32_16x16x32_bf16 v[84:87], a[152:155], a[244:247], v[84:87]
    v_fma_f32 v72, v64, v72, v64
    v_fma_f32 v73, v65, v73, v65
    v_mfma_f32_16x16x32_bf16 v[92:95], a[140:143], a[244:247], v[92:95]
    v_rcp_f32 v72, v72
    v_mfma_f32_16x16x32_bf16 v[92:95], a[156:159], a[200:203], v[92:95]
    v_rcp_f32 v73, v73
    v_mfma_f32_16x16x32_bf16 v[92:95], a[16:19], a[228:231], v[92:95]
    v_fma_f32 v72, v64, v72, -v72
    v_fma_f32 v73, v65, v73, -v73
    v_mfma_f32_16x16x32_bf16 v[92:95], a[168:171], a[236:239], v[92:95]
    v_fma_f32 v66, v66, s33, 0.5
    v_fma_f32 v67, v67, s33, 0.5
    v_mfma_f32_16x16x32_bf16 v[92:95], a[148:151], a[248:251], v[92:95]
    v_fma_f32 v74, v66, v74, v66
    v_fma_f32 v75, v67, v75, v67
    v_mfma_f32_16x16x32_bf16 v[92:95], a[132:135], a[232:235], v[92:95]
    v_rcp_f32 v74, v74
    v_mfma_f32_16x16x32_bf16 v[92:95], a[36:39], a[220:223], v[92:95]
    v_rcp_f32 v75, v75
    v_mfma_f32_16x16x32_bf16 v[92:95], a[68:71], a[216:219], v[92:95]
    v_fma_f32 v74, v66, v74, -v74
    v_fma_f32 v75, v67, v75, -v75
    v_mfma_f32_16x16x32_bf16 v[92:95], a[64:67], a[224:227], v[92:95]
    v_cvt_pk_bf16_f32 v64, v72, v73
    v_cvt_pk_bf16_f32 v65, v74, v75
    v_mfma_f32_16x16x32_bf16 v[92:95], a[128:131], a[204:207], v[92:95]
    s_waitcnt lgkmcnt(0)
    v_exp_f32 v88, v88
    v_mfma_f32_16x16x32_bf16 v[96:99], a[80:83], a[212:215], v[96:99]
    ds_read_b128 a[244:247], v0 offset:55296
    v_fma_f32 v68, v68, s33, 0.5
    v_mfma_f32_16x16x32_bf16 v[96:99], a[72:75], a[252:255], v[96:99]
    ds_read_b128 a[232:235], v1 offset:55296
    v_fma_f32 v69, v69, s33, 0.5
    v_mfma_f32_16x16x32_bf16 v[96:99], a[44:47], a[224:227], v[96:99]
    v_exp_f32 v89, v89
    v_mfma_f32_16x16x32_bf16 v[96:99], a[60:63], a[216:219], v[96:99]
    v_exp_f32 v80, v80 clamp
    v_mfma_f32_16x16x32_bf16 v[96:99], a[40:43], a[248:251], v[96:99]
    v_exp_f32 v81, v81 clamp
    v_mfma_f32_16x16x32_bf16 v[96:99], a[120:123], a[236:239], v[96:99]
    v_exp_f32 v90, v90
    v_mfma_f32_16x16x32_bf16 v[96:99], a[164:167], a[208:211], v[96:99]
    ds_read_b128 a[220:223], v0 offset:14336
    v_fma_f32 v76, v68, v76, v68
    v_mfma_f32_16x16x32_bf16 v[96:99], a[172:175], a[240:243], v[96:99]
    ds_read_b128 a[204:207], v1 offset:14336
    v_fma_f32 v77, v69, v77, v69
    v_mfma_f32_16x16x32_bf16 v[96:99], a[4:7], a[228:231], v[96:99]
    v_rcp_f32 v76, v76
    v_mfma_f32_16x16x32_bf16 v[96:99], a[104:107], a[200:203], v[96:99]
    v_rcp_f32 v77, v77
    v_mfma_f32_16x16x32_bf16 v[104:107], a[180:183], a[200:203], v[104:107]
    v_exp_f32 v91, v91
    v_mfma_f32_16x16x32_bf16 v[104:107], a[8:11], a[228:231], v[104:107]
    v_exp_f32 v82, v82 clamp
    v_mfma_f32_16x16x32_bf16 v[104:107], a[108:111], a[240:243], v[104:107]
    v_exp_f32 v83, v83 clamp
    v_mfma_f32_16x16x32_bf16 v[104:107], a[100:103], a[208:211], v[104:107]
    v_fma_f32 v76, v68, v76, -v76
    v_fma_f32 v77, v69, v77, -v77
    v_mfma_f32_16x16x32_bf16 v[104:107], a[136:139], a[236:239], v[104:107]
    v_cvt_pk_bf16_f32 v66, v76, v77
    v_fma_f32 v70, v70, s33, 0.5
    v_mfma_f32_16x16x32_bf16 v[104:107], a[32:35], a[248:251], v[104:107]
    v_exp_f32 v92, v92
    v_mfma_f32_16x16x32_bf16 v[104:107], a[52:55], a[216:219], v[104:107]
    v_exp_f32 v93, v93
    v_mfma_f32_16x16x32_bf16 v[104:107], a[176:179], a[224:227], v[104:107]
    v_exp_f32 v84, v84 clamp
    v_mfma_f32_16x16x32_bf16 v[104:107], a[96:99], a[252:255], v[104:107]
    v_exp_f32 v85, v85 clamp
    v_mfma_f32_16x16x32_bf16 v[104:107], a[84:87], a[212:215], v[104:107]
    v_fma_f32 v71, v71, s33, 0.5
    v_fma_f32 v78, v70, v78, v70
    v_mfma_f32_16x16x32_bf16 v[100:103], a[92:95], a[212:215], v[100:103]
    v_fma_f32 v79, v71, v79, v71
    v_fma_f32 v80, v80, s33, 0.5
    v_mfma_f32_16x16x32_bf16 v[100:103], a[160:163], a[252:255], v[100:103]
    v_rcp_f32 v78, v78
    v_mfma_f32_16x16x32_bf16 v[100:103], a[76:79], a[224:227], v[100:103]
    v_rcp_f32 v79, v79
    v_mfma_f32_16x16x32_bf16 v[100:103], a[196:199], a[216:219], v[100:103]
    v_fma_f32 v78, v70, v78, -v78
    v_fma_f32 v79, v71, v79, -v79
    v_mfma_f32_16x16x32_bf16 v[100:103], a[144:147], a[248:251], v[100:103]
    v_cvt_pk_bf16_f32 v67, v78, v79
    v_fma_f32 v81, v81, s33, 0.5
    v_mfma_f32_16x16x32_bf16 v[100:103], a[116:119], a[236:239], v[100:103]
    v_permlane16_swap_b32 v64, v66
    v_mfma_f32_16x16x32_bf16 v[100:103], a[184:187], a[208:211], v[100:103]
    v_permlane16_swap_b32 v65, v67
    v_mfma_f32_16x16x32_bf16 v[100:103], a[12:15], a[240:243], v[100:103]
    buffer_store_dwordx4 v[64:67], v4, s[20:23], s52 offen offset:1024 sc1
    v_mfma_f32_16x16x32_bf16 v[100:103], a[124:127], a[228:231], v[100:103]
    v_exp_f32 v94, v94
    v_mfma_f32_16x16x32_bf16 v[100:103], a[152:155], a[200:203], v[100:103]
    v_exp_f32 v95, v95
    v_mfma_f32_16x16x32_bf16 v[108:111], a[140:143], a[200:203], v[108:111]
    v_exp_f32 v86, v86 clamp
    v_mfma_f32_16x16x32_bf16 v[108:111], a[156:159], a[228:231], v[108:111]
    v_exp_f32 v87, v87 clamp
    v_mfma_f32_16x16x32_bf16 v[108:111], a[16:19], a[240:243], v[108:111]
    v_fma_f32 v88, v80, v88, v80
    v_fma_f32 v89, v81, v89, v81
    v_mfma_f32_16x16x32_bf16 v[108:111], a[168:171], a[208:211], v[108:111]
    v_rcp_f32 v88, v88
    v_mfma_f32_16x16x32_bf16 v[108:111], a[148:151], a[236:239], v[108:111]
    v_rcp_f32 v89, v89
    v_mfma_f32_16x16x32_bf16 v[108:111], a[132:135], a[248:251], v[108:111]
    v_fma_f32 v88, v80, v88, -v88
    v_fma_f32 v89, v81, v89, -v89
    v_mfma_f32_16x16x32_bf16 v[108:111], a[36:39], a[216:219], v[108:111]
    v_fma_f32 v82, v82, s33, 0.5
    v_fma_f32 v83, v83, s33, 0.5
    v_mfma_f32_16x16x32_bf16 v[108:111], a[68:71], a[224:227], v[108:111]
    v_fma_f32 v90, v82, v90, v82
    v_fma_f32 v91, v83, v91, v83
    v_mfma_f32_16x16x32_bf16 v[108:111], a[64:67], a[252:255], v[108:111]
    v_rcp_f32 v90, v90
    v_mfma_f32_16x16x32_bf16 v[108:111], a[128:131], a[212:215], v[108:111]
    s_waitcnt lgkmcnt(0)
    v_rcp_f32 v91, v91
    v_mfma_f32_16x16x32_bf16 v[112:115], a[80:83], a[244:247], v[112:115]
    ds_read_b128 a[200:203], v0 offset:57344
    v_fma_f32 v90, v82, v90, -v90
    v_mfma_f32_16x16x32_bf16 v[112:115], a[72:75], a[232:235], v[112:115]
    ds_read_b128 a[248:251], v1 offset:57344
    v_fma_f32 v91, v83, v91, -v91
    v_mfma_f32_16x16x32_bf16 v[112:115], a[44:47], a[252:255], v[112:115]
    v_cvt_pk_bf16_f32 v80, v88, v89
    v_cvt_pk_bf16_f32 v81, v90, v91
    v_mfma_f32_16x16x32_bf16 v[112:115], a[60:63], a[224:227], v[112:115]
    v_exp_f32 v104, v104
    v_mfma_f32_16x16x32_bf16 v[112:115], a[40:43], a[236:239], v[112:115]
    v_exp_f32 v105, v105
    v_mfma_f32_16x16x32_bf16 v[112:115], a[120:123], a[208:211], v[112:115]
    v_exp_f32 v96, v96 clamp
    v_mfma_f32_16x16x32_bf16 v[112:115], a[164:167], a[220:223], v[112:115]
    ds_read_b128 a[216:219], v0 offset:16384
    v_fma_f32 v84, v84, s33, 0.5
    v_mfma_f32_16x16x32_bf16 v[112:115], a[172:175], a[204:207], v[112:115]
    ds_read_b128 a[212:215], v1 offset:16384
    v_fma_f32 v85, v85, s33, 0.5
    v_mfma_f32_16x16x32_bf16 v[112:115], a[4:7], a[240:243], v[112:115]
    v_exp_f32 v97, v97 clamp
    v_mfma_f32_16x16x32_bf16 v[112:115], a[104:107], a[228:231], v[112:115]
    v_exp_f32 v106, v106
    v_mfma_f32_16x16x32_bf16 v[120:123], a[180:183], a[228:231], v[120:123]
    v_exp_f32 v107, v107
    v_mfma_f32_16x16x32_bf16 v[120:123], a[8:11], a[240:243], v[120:123]
    v_exp_f32 v98, v98 clamp
    v_mfma_f32_16x16x32_bf16 v[120:123], a[108:111], a[204:207], v[120:123]
    v_exp_f32 v99, v99 clamp
    v_mfma_f32_16x16x32_bf16 v[120:123], a[100:103], a[220:223], v[120:123]
    v_fma_f32 v92, v84, v92, v84
    v_fma_f32 v93, v85, v93, v85
    v_mfma_f32_16x16x32_bf16 v[120:123], a[136:139], a[208:211], v[120:123]
    v_rcp_f32 v92, v92
    v_mfma_f32_16x16x32_bf16 v[120:123], a[32:35], a[236:239], v[120:123]
    v_rcp_f32 v93, v93
    v_mfma_f32_16x16x32_bf16 v[120:123], a[52:55], a[224:227], v[120:123]
    v_fma_f32 v92, v84, v92, -v92
    v_fma_f32 v93, v85, v93, -v93
    v_mfma_f32_16x16x32_bf16 v[120:123], a[176:179], a[252:255], v[120:123]
    v_cvt_pk_bf16_f32 v82, v92, v93
    v_fma_f32 v86, v86, s33, 0.5
    v_mfma_f32_16x16x32_bf16 v[120:123], a[96:99], a[232:235], v[120:123]
    v_exp_f32 v108, v108
    v_mfma_f32_16x16x32_bf16 v[120:123], a[84:87], a[244:247], v[120:123]
    v_exp_f32 v109, v109
    v_mfma_f32_16x16x32_bf16 v[116:119], a[92:95], a[244:247], v[116:119]
    v_exp_f32 v100, v100 clamp
    v_mfma_f32_16x16x32_bf16 v[116:119], a[160:163], a[232:235], v[116:119]
    v_exp_f32 v101, v101 clamp
    v_mfma_f32_16x16x32_bf16 v[116:119], a[76:79], a[252:255], v[116:119]
    v_fma_f32 v87, v87, s33, 0.5
    v_fma_f32 v94, v86, v94, v86
    v_mfma_f32_16x16x32_bf16 v[116:119], a[196:199], a[224:227], v[116:119]
    v_fma_f32 v95, v87, v95, v87
    v_fma_f32 v96, v96, s33, 0.5
    v_mfma_f32_16x16x32_bf16 v[116:119], a[144:147], a[236:239], v[116:119]
    v_rcp_f32 v94, v94
    v_mfma_f32_16x16x32_bf16 v[116:119], a[116:119], a[208:211], v[116:119]
    v_rcp_f32 v95, v95
    v_mfma_f32_16x16x32_bf16 v[116:119], a[184:187], a[220:223], v[116:119]
    v_fma_f32 v94, v86, v94, -v94
    v_fma_f32 v95, v87, v95, -v95
    v_mfma_f32_16x16x32_bf16 v[116:119], a[12:15], a[204:207], v[116:119]
    v_cvt_pk_bf16_f32 v83, v94, v95
    v_fma_f32 v97, v97, s33, 0.5
    v_mfma_f32_16x16x32_bf16 v[116:119], a[124:127], a[240:243], v[116:119]
    v_permlane16_swap_b32 v80, v82
    v_mfma_f32_16x16x32_bf16 v[116:119], a[152:155], a[228:231], v[116:119]
    v_permlane16_swap_b32 v81, v83
    v_mfma_f32_16x16x32_bf16 v[124:127], a[140:143], a[228:231], v[124:127]
    buffer_store_dwordx4 v[80:83], v4, s[20:23], s52 offen offset:3072 sc1
    v_mfma_f32_16x16x32_bf16 v[124:127], a[156:159], a[240:243], v[124:127]
    v_exp_f32 v110, v110
    v_mfma_f32_16x16x32_bf16 v[124:127], a[16:19], a[204:207], v[124:127]
    v_exp_f32 v111, v111
    v_mfma_f32_16x16x32_bf16 v[124:127], a[168:171], a[220:223], v[124:127]
    v_exp_f32 v102, v102 clamp
    v_mfma_f32_16x16x32_bf16 v[124:127], a[148:151], a[208:211], v[124:127]
    v_exp_f32 v103, v103 clamp
    v_mfma_f32_16x16x32_bf16 v[124:127], a[132:135], a[236:239], v[124:127]
    v_fma_f32 v104, v96, v104, v96
    v_fma_f32 v105, v97, v105, v97
    v_mfma_f32_16x16x32_bf16 v[124:127], a[36:39], a[224:227], v[124:127]
    v_rcp_f32 v104, v104
    v_mfma_f32_16x16x32_bf16 v[124:127], a[68:71], a[252:255], v[124:127]
    v_rcp_f32 v105, v105
    v_mfma_f32_16x16x32_bf16 v[124:127], a[64:67], a[232:235], v[124:127]
    v_fma_f32 v104, v96, v104, -v104
    v_fma_f32 v105, v97, v105, -v105
    v_mfma_f32_16x16x32_bf16 v[124:127], a[128:131], a[244:247], v[124:127]
    s_waitcnt lgkmcnt(0)
    v_fma_f32 v98, v98, s33, 0.5
    v_fma_f32 v99, v99, s33, 0.5
    v_mfma_f32_16x16x32_bf16 v[128:131], a[80:83], a[200:203], v[128:131]
    ds_read_b128 a[228:231], v0 offset:59392
    v_fma_f32 v106, v98, v106, v98
    v_mfma_f32_16x16x32_bf16 v[128:131], a[72:75], a[248:251], v[128:131]
    ds_read_b128 a[236:239], v1 offset:59392
    v_fma_f32 v107, v99, v107, v99
    v_mfma_f32_16x16x32_bf16 v[128:131], a[44:47], a[232:235], v[128:131]
    v_rcp_f32 v106, v106
    v_mfma_f32_16x16x32_bf16 v[128:131], a[60:63], a[252:255], v[128:131]
    v_rcp_f32 v107, v107
    v_mfma_f32_16x16x32_bf16 v[128:131], a[40:43], a[208:211], v[128:131]
    v_fma_f32 v106, v98, v106, -v106
    v_fma_f32 v107, v99, v107, -v107
    v_mfma_f32_16x16x32_bf16 v[128:131], a[120:123], a[220:223], v[128:131]
    v_cvt_pk_bf16_f32 v96, v104, v105
    v_cvt_pk_bf16_f32 v97, v106, v107
    v_mfma_f32_16x16x32_bf16 v[128:131], a[164:167], a[216:219], v[128:131]
    ds_read_b128 a[224:227], v0 offset:18432
    v_fma_f32 v100, v100, s33, 0.5
    v_mfma_f32_16x16x32_bf16 v[128:131], a[172:175], a[212:215], v[128:131]
    ds_read_b128 a[244:247], v1 offset:18432
    v_fma_f32 v101, v101, s33, 0.5
    v_mfma_f32_16x16x32_bf16 v[128:131], a[4:7], a[204:207], v[128:131]
    v_exp_f32 v120, v120
    v_mfma_f32_16x16x32_bf16 v[128:131], a[104:107], a[240:243], v[128:131]
    v_exp_f32 v121, v121
    v_mfma_f32_16x16x32_bf16 v[136:139], a[180:183], a[240:243], v[136:139]
    v_exp_f32 v112, v112 clamp
    v_mfma_f32_16x16x32_bf16 v[136:139], a[8:11], a[204:207], v[136:139]
    v_exp_f32 v113, v113 clamp
    v_mfma_f32_16x16x32_bf16 v[136:139], a[108:111], a[212:215], v[136:139]
    v_exp_f32 v122, v122
    v_mfma_f32_16x16x32_bf16 v[136:139], a[100:103], a[216:219], v[136:139]
    v_exp_f32 v123, v123
    v_mfma_f32_16x16x32_bf16 v[136:139], a[136:139], a[220:223], v[136:139]
    v_exp_f32 v114, v114 clamp
    v_mfma_f32_16x16x32_bf16 v[136:139], a[32:35], a[208:211], v[136:139]
    v_exp_f32 v115, v115 clamp
    v_mfma_f32_16x16x32_bf16 v[136:139], a[52:55], a[252:255], v[136:139]
    v_fma_f32 v108, v100, v108, v100
    v_fma_f32 v109, v101, v109, v101
    v_mfma_f32_16x16x32_bf16 v[136:139], a[176:179], a[232:235], v[136:139]
    v_rcp_f32 v108, v108
    v_mfma_f32_16x16x32_bf16 v[136:139], a[96:99], a[248:251], v[136:139]
    v_rcp_f32 v109, v109
    v_mfma_f32_16x16x32_bf16 v[136:139], a[84:87], a[200:203], v[136:139]
    v_fma_f32 v108, v100, v108, -v108
    v_fma_f32 v109, v101, v109, -v109
    v_mfma_f32_16x16x32_bf16 v[132:135], a[92:95], a[200:203], v[132:135]
    v_cvt_pk_bf16_f32 v98, v108, v109
    v_fma_f32 v102, v102, s33, 0.5
    v_mfma_f32_16x16x32_bf16 v[132:135], a[160:163], a[248:251], v[132:135]
    v_exp_f32 v124, v124
    v_mfma_f32_16x16x32_bf16 v[132:135], a[76:79], a[232:235], v[132:135]
    v_exp_f32 v125, v125
    v_mfma_f32_16x16x32_bf16 v[132:135], a[196:199], a[252:255], v[132:135]
    v_exp_f32 v116, v116 clamp
    v_mfma_f32_16x16x32_bf16 v[132:135], a[144:147], a[208:211], v[132:135]
    v_exp_f32 v117, v117 clamp
    v_mfma_f32_16x16x32_bf16 v[132:135], a[116:119], a[220:223], v[132:135]
    v_fma_f32 v103, v103, s33, 0.5
    v_fma_f32 v110, v102, v110, v102
    v_mfma_f32_16x16x32_bf16 v[132:135], a[184:187], a[216:219], v[132:135]
    v_fma_f32 v111, v103, v111, v103
    v_fma_f32 v112, v112, s33, 0.5
    v_mfma_f32_16x16x32_bf16 v[132:135], a[12:15], a[212:215], v[132:135]
    v_rcp_f32 v110, v110
    v_mfma_f32_16x16x32_bf16 v[132:135], a[124:127], a[204:207], v[132:135]
    v_rcp_f32 v111, v111
    v_mfma_f32_16x16x32_bf16 v[132:135], a[152:155], a[240:243], v[132:135]
    v_fma_f32 v110, v102, v110, -v110
    v_fma_f32 v111, v103, v111, -v111
    v_mfma_f32_16x16x32_bf16 v[140:143], a[140:143], a[240:243], v[140:143]
    v_cvt_pk_bf16_f32 v99, v110, v111
    v_fma_f32 v113, v113, s33, 0.5
    v_mfma_f32_16x16x32_bf16 v[140:143], a[156:159], a[204:207], v[140:143]
    v_permlane16_swap_b32 v96, v98
    v_mfma_f32_16x16x32_bf16 v[140:143], a[16:19], a[212:215], v[140:143]
    v_permlane16_swap_b32 v97, v99
    v_mfma_f32_16x16x32_bf16 v[140:143], a[168:171], a[216:219], v[140:143]
    buffer_store_dwordx4 v[96:99], v4, s[20:23], s53 offen offset:1024 sc1
    v_mfma_f32_16x16x32_bf16 v[140:143], a[148:151], a[220:223], v[140:143]
    v_exp_f32 v126, v126
    v_mfma_f32_16x16x32_bf16 v[140:143], a[132:135], a[208:211], v[140:143]
    v_exp_f32 v127, v127
    v_mfma_f32_16x16x32_bf16 v[140:143], a[36:39], a[252:255], v[140:143]
    v_exp_f32 v118, v118 clamp
    v_mfma_f32_16x16x32_bf16 v[140:143], a[68:71], a[232:235], v[140:143]
    v_exp_f32 v119, v119 clamp
    v_mfma_f32_16x16x32_bf16 v[140:143], a[64:67], a[248:251], v[140:143]
    v_fma_f32 v120, v112, v120, v112
    v_fma_f32 v121, v113, v121, v113
    v_mfma_f32_16x16x32_bf16 v[140:143], a[128:131], a[200:203], v[140:143]
    s_waitcnt lgkmcnt(0)
    v_rcp_f32 v120, v120
    v_mfma_f32_16x16x32_bf16 v[144:147], a[80:83], a[228:231], v[144:147]
    v_rcp_f32 v121, v121
    v_mfma_f32_16x16x32_bf16 v[144:147], a[72:75], a[236:239], v[144:147]
    v_fma_f32 v120, v112, v120, -v120
    v_fma_f32 v121, v113, v121, -v121
    v_mfma_f32_16x16x32_bf16 v[144:147], a[44:47], a[248:251], v[144:147]
    v_fma_f32 v114, v114, s33, 0.5
    v_fma_f32 v115, v115, s33, 0.5
    v_mfma_f32_16x16x32_bf16 v[144:147], a[60:63], a[232:235], v[144:147]
    v_fma_f32 v122, v114, v122, v114
    v_fma_f32 v123, v115, v123, v115
    v_mfma_f32_16x16x32_bf16 v[144:147], a[40:43], a[220:223], v[144:147]
    v_rcp_f32 v122, v122
    v_mfma_f32_16x16x32_bf16 v[144:147], a[120:123], a[216:219], v[144:147]
    v_rcp_f32 v123, v123
    v_mfma_f32_16x16x32_bf16 v[144:147], a[164:167], a[224:227], v[144:147]
    v_fma_f32 v122, v114, v122, -v122
    v_fma_f32 v123, v115, v123, -v123
    v_mfma_f32_16x16x32_bf16 v[144:147], a[172:175], a[244:247], v[144:147]
    v_cvt_pk_bf16_f32 v112, v120, v121
    v_cvt_pk_bf16_f32 v113, v122, v123
    v_mfma_f32_16x16x32_bf16 v[144:147], a[4:7], a[212:215], v[144:147]
    v_exp_f32 v136, v136
    v_mfma_f32_16x16x32_bf16 v[144:147], a[104:107], a[204:207], v[144:147]
    v_exp_f32 v137, v137
    v_mfma_f32_16x16x32_bf16 v[152:155], a[180:183], a[204:207], v[152:155]
    v_exp_f32 v128, v128 clamp
    v_mfma_f32_16x16x32_bf16 v[152:155], a[8:11], a[212:215], v[152:155]
    v_exp_f32 v129, v129 clamp
    v_mfma_f32_16x16x32_bf16 v[152:155], a[108:111], a[244:247], v[152:155]
    v_exp_f32 v138, v138
    v_mfma_f32_16x16x32_bf16 v[152:155], a[100:103], a[224:227], v[152:155]
    v_exp_f32 v139, v139
    v_mfma_f32_16x16x32_bf16 v[152:155], a[136:139], a[216:219], v[152:155]
    v_exp_f32 v130, v130 clamp
    v_mfma_f32_16x16x32_bf16 v[152:155], a[32:35], a[220:223], v[152:155]
    v_exp_f32 v131, v131 clamp
    v_mfma_f32_16x16x32_bf16 v[152:155], a[52:55], a[232:235], v[152:155]
    v_fma_f32 v116, v116, s33, 0.5
    v_fma_f32 v117, v117, s33, 0.5
    v_mfma_f32_16x16x32_bf16 v[152:155], a[176:179], a[248:251], v[152:155]
    v_fma_f32 v124, v116, v124, v116
    v_fma_f32 v125, v117, v125, v117
    v_mfma_f32_16x16x32_bf16 v[152:155], a[96:99], a[236:239], v[152:155]
    v_rcp_f32 v124, v124
    v_mfma_f32_16x16x32_bf16 v[152:155], a[84:87], a[228:231], v[152:155]
    v_rcp_f32 v125, v125
    v_mfma_f32_16x16x32_bf16 v[148:151], a[92:95], a[228:231], v[148:151]
    v_fma_f32 v124, v116, v124, -v124
    v_fma_f32 v125, v117, v125, -v125
    v_mfma_f32_16x16x32_bf16 v[148:151], a[160:163], a[236:239], v[148:151]
    v_cvt_pk_bf16_f32 v114, v124, v125
    v_fma_f32 v118, v118, s33, 0.5
    v_mfma_f32_16x16x32_bf16 v[148:151], a[76:79], a[248:251], v[148:151]
    v_exp_f32 v140, v140
    v_mfma_f32_16x16x32_bf16 v[148:151], a[196:199], a[232:235], v[148:151]
    v_exp_f32 v141, v141
    v_mfma_f32_16x16x32_bf16 v[148:151], a[144:147], a[220:223], v[148:151]
    v_exp_f32 v132, v132 clamp
    v_mfma_f32_16x16x32_bf16 v[148:151], a[116:119], a[216:219], v[148:151]
    v_exp_f32 v133, v133 clamp
    v_mfma_f32_16x16x32_bf16 v[148:151], a[184:187], a[224:227], v[148:151]
    v_fma_f32 v119, v119, s33, 0.5
    v_fma_f32 v126, v118, v126, v118
    v_mfma_f32_16x16x32_bf16 v[148:151], a[12:15], a[244:247], v[148:151]
    v_fma_f32 v127, v119, v127, v119
    v_fma_f32 v128, v128, s33, 0.5
    v_mfma_f32_16x16x32_bf16 v[148:151], a[124:127], a[212:215], v[148:151]
    v_rcp_f32 v126, v126
    v_mfma_f32_16x16x32_bf16 v[148:151], a[152:155], a[204:207], v[148:151]
    v_rcp_f32 v127, v127
    v_mfma_f32_16x16x32_bf16 v[156:159], a[140:143], a[204:207], v[156:159]
    v_fma_f32 v126, v118, v126, -v126
    v_fma_f32 v127, v119, v127, -v127
    v_mfma_f32_16x16x32_bf16 v[156:159], a[156:159], a[212:215], v[156:159]
    v_cvt_pk_bf16_f32 v115, v126, v127
    v_fma_f32 v129, v129, s33, 0.5
    v_mfma_f32_16x16x32_bf16 v[156:159], a[16:19], a[244:247], v[156:159]
    v_permlane16_swap_b32 v112, v114
    v_mfma_f32_16x16x32_bf16 v[156:159], a[168:171], a[224:227], v[156:159]
    v_permlane16_swap_b32 v113, v115
    v_mfma_f32_16x16x32_bf16 v[156:159], a[148:151], a[216:219], v[156:159]
    buffer_store_dwordx4 v[112:115], v4, s[20:23], s53 offen offset:3072 sc1
    v_mfma_f32_16x16x32_bf16 v[156:159], a[132:135], a[220:223], v[156:159]
    v_exp_f32 v142, v142
    v_mfma_f32_16x16x32_bf16 v[156:159], a[36:39], a[232:235], v[156:159]
    v_exp_f32 v143, v143
    v_mfma_f32_16x16x32_bf16 v[156:159], a[68:71], a[248:251], v[156:159]
    v_exp_f32 v134, v134 clamp
    v_mfma_f32_16x16x32_bf16 v[156:159], a[64:67], a[236:239], v[156:159]
    v_exp_f32 v135, v135 clamp
    v_mfma_f32_16x16x32_bf16 v[156:159], a[128:131], a[228:231], v[156:159]
    v_fma_f32 v136, v128, v136, v128
    v_fma_f32 v137, v129, v137, v129
    v_rcp_f32 v136, v136
    v_rcp_f32 v137, v137
    v_fma_f32 v136, v128, v136, -v136
    v_fma_f32 v137, v129, v137, -v137
    v_fma_f32 v130, v130, s33, 0.5
    v_fma_f32 v131, v131, s33, 0.5
    v_fma_f32 v138, v130, v138, v130
    v_fma_f32 v139, v131, v139, v131
    v_rcp_f32 v138, v138
    v_rcp_f32 v139, v139
    v_fma_f32 v138, v130, v138, -v138
    v_fma_f32 v139, v131, v139, -v139
    v_cvt_pk_bf16_f32 v128, v136, v137
    v_cvt_pk_bf16_f32 v129, v138, v139
    v_fma_f32 v132, v132, s33, 0.5
    v_fma_f32 v133, v133, s33, 0.5
    v_fma_f32 v140, v132, v140, v132
    v_fma_f32 v141, v133, v141, v133
    v_rcp_f32 v140, v140
    v_rcp_f32 v141, v141
    v_fma_f32 v140, v132, v140, -v140
    v_fma_f32 v141, v133, v141, -v141
    v_cvt_pk_bf16_f32 v130, v140, v141
    v_fma_f32 v134, v134, s33, 0.5
    v_fma_f32 v135, v135, s33, 0.5
    v_fma_f32 v142, v134, v142, v134
    v_fma_f32 v143, v135, v143, v135
    v_rcp_f32 v142, v142
    v_rcp_f32 v143, v143
    v_fma_f32 v142, v134, v142, -v142
    v_fma_f32 v143, v135, v143, -v143
    v_cvt_pk_bf16_f32 v131, v142, v143
    v_permlane16_swap_b32 v128, v130
    v_exp_f32 v152, v152
    v_permlane16_swap_b32 v129, v131
    buffer_store_dwordx4 v[128:131], v4, s[20:23], s54 offen offset:1024 sc1
    v_exp_f32 v153, v153
    v_exp_f32 v144, v144 clamp
    v_exp_f32 v145, v145 clamp
    v_fma_f32 v144, v144, s33, 0.5
    v_fma_f32 v145, v145, s33, 0.5
    v_fma_f32 v152, v144, v152, v144
    v_fma_f32 v153, v145, v153, v145
    v_rcp_f32 v152, v152
    v_rcp_f32 v153, v153
    v_fma_f32 v152, v144, v152, -v152
    v_fma_f32 v153, v145, v153, -v153
    v_exp_f32 v154, v154
    v_exp_f32 v155, v155
    v_exp_f32 v146, v146 clamp
    v_exp_f32 v147, v147 clamp
    v_fma_f32 v146, v146, s33, 0.5
    v_fma_f32 v147, v147, s33, 0.5
    v_fma_f32 v154, v146, v154, v146
    v_fma_f32 v155, v147, v155, v147
    v_rcp_f32 v154, v154
    v_rcp_f32 v155, v155
    v_fma_f32 v154, v146, v154, -v154
    v_fma_f32 v155, v147, v155, -v155
    v_cvt_pk_bf16_f32 v144, v152, v153
    v_cvt_pk_bf16_f32 v145, v154, v155
    v_exp_f32 v156, v156
    v_exp_f32 v157, v157
    v_exp_f32 v148, v148 clamp
    v_exp_f32 v149, v149 clamp
    v_fma_f32 v148, v148, s33, 0.5
    v_fma_f32 v149, v149, s33, 0.5
    v_fma_f32 v156, v148, v156, v148
    v_fma_f32 v157, v149, v157, v149
    v_rcp_f32 v156, v156
    v_rcp_f32 v157, v157
    v_fma_f32 v156, v148, v156, -v156
    v_fma_f32 v157, v149, v157, -v157
    v_cvt_pk_bf16_f32 v146, v156, v157
    v_exp_f32 v158, v158
    v_exp_f32 v159, v159
    v_exp_f32 v150, v150 clamp
    v_exp_f32 v151, v151 clamp
    v_fma_f32 v150, v150, s33, 0.5
    v_fma_f32 v151, v151, s33, 0.5
    v_fma_f32 v158, v150, v158, v150
    v_fma_f32 v159, v151, v159, v151
    v_rcp_f32 v158, v158
    v_rcp_f32 v159, v159
    v_fma_f32 v158, v150, v158, -v158
    v_fma_f32 v159, v151, v159, -v159
    v_cvt_pk_bf16_f32 v147, v158, v159
    v_permlane16_swap_b32 v144, v146
    s_nop 0
    v_permlane16_swap_b32 v145, v147
    buffer_store_dwordx4 v[144:147], v5, s[20:23], s54 offen offset:3072 sc1
    s_endpgm
L_spin0:
    s_mov_b32 s59, 0x40000
L_spin0a:
    buffer_load_dword v15, off, s[48:51], 0 offset:0 sc1
    s_waitcnt vmcnt(0)
    v_cmp_gt_u32 vcc, 4, v15
    s_sub_u32 s59, s59, 1
    s_cmp_eq_u32 s59, 0
    s_cbranch_scc1 L_back0
    s_sleep 4
    s_cbranch_vccnz L_spin0a
    s_branch L_back0
L_spin1:
    s_mov_b32 s59, 0x40000
L_spin1a:
    buffer_load_dword v15, off, s[48:51], 0 offset:4 sc1
    s_waitcnt vmcnt(0)
    v_cmp_gt_u32 vcc, 4, v15
    s_sub_u32 s59, s59, 1
    s_cmp_eq_u32 s59, 0
    s_cbranch_scc1 L_back1
    s_sleep 4
    s_cbranch_vccnz L_spin1a
    s_branch L_back1
L_spin2:
    s_mov_b32 s59, 0x40000
L_spin2a:
    buffer_load_dword v15, off, s[48:51], 0 offset:8 sc1
    s_waitcnt vmcnt(0)
    v_cmp_gt_u32 vcc, 4, v15
    s_sub_u32 s59, s59, 1
    s_cmp_eq_u32 s59, 0
    s_cbranch_scc1 L_back2
    s_sleep 4
    s_cbranch_vccnz L_spin2a
    s_branch L_back2
L_spin3:
    s_mov_b32 s59, 0x40000
L_spin3a:
    buffer_load_dword v15, off, s[48:51], 0 offset:12 sc1
    s_waitcnt vmcnt(0)
    v_cmp_gt_u32 vcc, 4, v15
    s_sub_u32 s59, s59, 1
    s_cmp_eq_u32 s59, 0
    s_cbranch_scc1 L_back3
    s_sleep 4
    s_cbranch_vccnz L_spin3a
    s_branch L_back3
L_helper:
    s_sub_u32 s24, s24, 126
    s_lshl_b32 s24, s24, 1
    s_add_u32 s24, s24, s26
    v_and_b32 v1, 63, v0
    v_lshrrev_b32 v2, 6, v0
    s_nop 0
    v_readfirstlane_b32 s30, v2
    v_lshrrev_b32 v3, 3, v1
    v_and_b32 v4, 2, v3
    v_xor_b32 v4, v4, v1
    v_and_b32 v4, 7, v4
    v_lshlrev_b32 v4, 4, v4
    v_lshl_add_u32 v4, v3, 10, v4
    v_xor_b32 v5, 64, v4
    s_lshl_b32 s24, s24, 2
    s_add_u32 s24, s24, s30
    s_and_b32 s25, s24, 7
    s_lshr_b32 s26, s24, 3
    s_mul_i32 s27, s30, 40960
    v_lshrrev_b32 v6, 4, v1
    v_bfe_u32 v7, v1, 2, 2
    v_lshl_add_u32 v8, v6, 3, v7
    v_lshlrev_b32 v8, 7, v8
    v_and_b32 v9, 2, v7
    v_and_b32 v10, 1, v6
    v_lshl_add_u32 v9, v10, 2, v9
    v_lshl_add_u32 v8, v9, 4, v8
    v_and_b32 v9, 3, v1
    v_lshl_add_u32 v8, v9, 3, v8
    v_add_u32 v10, s27, v8
    v_xor_b32 v11, 32, v10
    v_xor_b32 v12, 64, v10
    v_xor_b32 v13, 0x60, v10
    v_lshlrev_b32 v14, 4, v1
    s_bfe_u32 s28, s25, 0x10001
    s_lshl_b32 s28, s28, 14
    s_and_b32 s29, s25, 1
    s_lshl_b32 s29, s29, 13
    s_add_u32 s28, s28, s29
    s_lshr_b32 s29, s25, 2
    s_lshl_b32 s29, s29, 11
    s_add_u32 s28, s28, s29
    v_add_u32 v14, s28, v14
    v_add_u32 v15, 4096, v14
    s_cmp_lt_u32 s25, 4
    s_mov_b32 s35, 0xbfb8aa3b
    s_cselect_b32 s35, 0x4038aa3b, s35
    s_mov_b32 s34, 0xffff0000
    s_lshl_b32 s25, s25, 7
    s_lshl_b32 s31, s26, 15
    s_add_u32 s25, s25, s31
    v_or_b32 v16, s30, v1
    v_mov_b32 v17, 0
    v_cmp_ne_u32 vcc, 0, v16
    v_mov_b32 v16, 0x40000000
    v_mov_b32 v18, 1
    v_cndmask_b32 v17, v17, v16, vcc
    s_waitcnt lgkmcnt(0)
    s_mov_b32 s16, s6
    s_mov_b32 s17, s7
    s_mov_b32 s18, 1310720
    s_mov_b32 s19, 0x20000
    s_mov_b32 s48, s10
    s_mov_b32 s49, s11
    s_mov_b32 s50, 256
    s_mov_b32 s51, 0x20000
    s_mov_b32 s46, 1441792
    s_mov_b32 s47, 0x20000
    s_add_u32 m0, s27, 0
    s_add_u32 s38, s25, 458752
    buffer_load_dwordx4 v4, s[16:19], s38 offen lds
    s_add_u32 m0, s27, 1024
    s_add_u32 s38, s25, 466944
    buffer_load_dwordx4 v5, s[16:19], s38 offen lds
    s_add_u32 m0, s27, 2048
    s_add_u32 s38, s25, 475136
    buffer_load_dwordx4 v4, s[16:19], s38 offen lds
    s_add_u32 m0, s27, 3072
    s_add_u32 s38, s25, 483328
    buffer_load_dwordx4 v5, s[16:19], s38 offen lds
    s_add_u32 m0, s27, 4096
    s_add_u32 s38, s25, 720896
    buffer_load_dwordx4 v4, s[16:19], s38 offen lds
    s_add_u32 m0, s27, 5120
    s_add_u32 s38, s25, 729088
    buffer_load_dwordx4 v5, s[16:19], s38 offen lds
    s_add_u32 m0, s27, 6144
    s_add_u32 s38, s25, 737280
    buffer_load_dwordx4 v4, s[16:19], s38 offen lds
    s_add_u32 m0, s27, 7168
    s_add_u32 s38, s25, 745472
    buffer_load_dwordx4 v5, s[16:19], s38 offen lds
    s_add_u32 m0, s27, 8192
    s_add_u32 s38, s25, 983040
    buffer_load_dwordx4 v4, s[16:19], s38 offen lds
    s_add_u32 m0, s27, 9216
    s_add_u32 s38, s25, 991232
    buffer_load_dwordx4 v5, s[16:19], s38 offen lds
    s_add_u32 m0, s27, 10240
    s_add_u32 s38, s25, 999424
    buffer_load_dwordx4 v4, s[16:19], s38 offen lds
    s_add_u32 m0, s27, 11264
    s_add_u32 s38, s25, 1007616
    buffer_load_dwordx4 v5, s[16:19], s38 offen lds
    s_add_u32 m0, s27, 12288
    s_add_u32 s38, s25, 1245184
    buffer_load_dwordx4 v4, s[16:19], s38 offen lds
    s_add_u32 m0, s27, 13312
    s_add_u32 s38, s25, 1253376
    buffer_load_dwordx4 v5, s[16:19], s38 offen lds
    s_add_u32 m0, s27, 14336
    s_add_u32 s38, s25, 1261568
    buffer_load_dwordx4 v4, s[16:19], s38 offen lds
    s_add_u32 m0, s27, 15360
    s_add_u32 s38, s25, 1269760
    buffer_load_dwordx4 v5, s[16:19], s38 offen lds
    s_mul_i32 s39, s26, 163840
    s_mul_i32 s40, s26, 98304
    s_waitcnt vmcnt(12)
    ds_read_b64_tr_b16 v[32:33], v10 offset:0
    ds_read_b64_tr_b16 v[34:35], v10 offset:512
    ds_read_b64_tr_b16 v[36:37], v11 offset:0
    ds_read_b64_tr_b16 v[38:39], v11 offset:512
    ds_read_b64_tr_b16 v[40:41], v12 offset:0
    ds_read_b64_tr_b16 v[42:43], v12 offset:512
    ds_read_b64_tr_b16 v[44:45], v13 offset:0
    ds_read_b64_tr_b16 v[46:47], v13 offset:512
    s_waitcnt vmcnt(8)
    ds_read_b64_tr_b16 v[48:49], v10 offset:4096
    ds_read_b64_tr_b16 v[50:51], v10 offset:4608
    ds_read_b64_tr_b16 v[52:53], v11 offset:4096
    ds_read_b64_tr_b16 v[54:55], v11 offset:4608
    ds_read_b64_tr_b16 v[56:57], v12 offset:4096
    ds_read_b64_tr_b16 v[58:59], v12 offset:4608
    ds_read_b64_tr_b16 v[60:61], v13 offset:4096
    ds_read_b64_tr_b16 v[62:63], v13 offset:4608
    s_add_u32 m0, s27, 16384
    s_add_u32 s38, s25, 196608
    buffer_load_dwordx4 v4, s[16:19], s38 offen lds
    s_add_u32 m0, s27, 17408
    s_add_u32 s38, s25, 204800
    buffer_load_dwordx4 v5, s[16:19], s38 offen lds
    s_add_u32 m0, s27, 18432
    s_add_u32 s38, s25, 212992
    buffer_load_dwordx4 v4, s[16:19], s38 offen lds
    s_add_u32 m0, s27, 19456
    s_add_u32 s38, s25, 221184
    buffer_load_dwordx4 v5, s[16:19], s38 offen lds
    s_add_u32 s41, s39, 1146880
    s_waitcnt lgkmcnt(14)
    buffer_store_dwordx4 v[32:35], v14, s[44:47], s41 offen offset:0 sc1
    s_waitcnt lgkmcnt(12)
    buffer_store_dwordx4 v[36:39], v14, s[44:47], s41 offen offset:1024 sc1
    s_waitcnt lgkmcnt(10)
    buffer_store_dwordx4 v[40:43], v15, s[44:47], s41 offen offset:0 sc1
    s_waitcnt lgkmcnt(8)
    buffer_store_dwordx4 v[44:47], v15, s[44:47], s41 offen offset:1024 sc1
    s_nop 1
    s_add_u32 s41, s39, 1179648
    s_waitcnt lgkmcnt(6)
    buffer_store_dwordx4 v[48:51], v14, s[44:47], s41 offen offset:0 sc1
    s_waitcnt lgkmcnt(4)
    buffer_store_dwordx4 v[52:55], v14, s[44:47], s41 offen offset:1024 sc1
    s_waitcnt lgkmcnt(2)
    buffer_store_dwordx4 v[56:59], v15, s[44:47], s41 offen offset:0 sc1
    s_waitcnt lgkmcnt(0)
    buffer_store_dwordx4 v[60:63], v15, s[44:47], s41 offen offset:1024 sc1
    s_nop 1
    s_add_u32 s41, s40, 622592
    v_lshlrev_b32 v20, 16, v32
    v_and_b32 v21, s34, v32
    v_lshlrev_b32 v22, 16, v48
    v_and_b32 v23, s34, v48
    v_add_f32 v20, v20, v22
    v_add_f32 v21, v21, v23
    v_mul_f32 v20, s35, v20
    v_mul_f32 v21, s35, v21
    v_cvt_pk_bf16_f32 v112, v20, v21
    v_lshlrev_b32 v20, 16, v33
    v_and_b32 v21, s34, v33
    v_lshlrev_b32 v22, 16, v49
    v_and_b32 v23, s34, v49
    v_add_f32 v20, v20, v22
    v_add_f32 v21, v21, v23
    v_mul_f32 v20, s35, v20
    v_mul_f32 v21, s35, v21
    v_cvt_pk_bf16_f32 v113, v20, v21
    v_lshlrev_b32 v20, 16, v34
    v_and_b32 v21, s34, v34
    v_lshlrev_b32 v22, 16, v50
    v_and_b32 v23, s34, v50
    v_add_f32 v20, v20, v22
    v_add_f32 v21, v21, v23
    v_mul_f32 v20, s35, v20
    v_mul_f32 v21, s35, v21
    v_cvt_pk_bf16_f32 v114, v20, v21
    v_lshlrev_b32 v20, 16, v35
    v_and_b32 v21, s34, v35
    v_lshlrev_b32 v22, 16, v51
    v_and_b32 v23, s34, v51
    v_add_f32 v20, v20, v22
    v_add_f32 v21, v21, v23
    v_mul_f32 v20, s35, v20
    v_mul_f32 v21, s35, v21
    v_cvt_pk_bf16_f32 v115, v20, v21
    buffer_store_dwordx4 v[112:115], v14, s[44:47], s41 offen offset:0 sc1
    v_lshlrev_b32 v20, 16, v36
    v_and_b32 v21, s34, v36
    v_lshlrev_b32 v22, 16, v52
    v_and_b32 v23, s34, v52
    v_add_f32 v20, v20, v22
    v_add_f32 v21, v21, v23
    v_mul_f32 v20, s35, v20
    v_mul_f32 v21, s35, v21
    v_cvt_pk_bf16_f32 v116, v20, v21
    v_lshlrev_b32 v20, 16, v37
    v_and_b32 v21, s34, v37
    v_lshlrev_b32 v22, 16, v53
    v_and_b32 v23, s34, v53
    v_add_f32 v20, v20, v22
    v_add_f32 v21, v21, v23
    v_mul_f32 v20, s35, v20
    v_mul_f32 v21, s35, v21
    v_cvt_pk_bf16_f32 v117, v20, v21
    v_lshlrev_b32 v20, 16, v38
    v_and_b32 v21, s34, v38
    v_lshlrev_b32 v22, 16, v54
    v_and_b32 v23, s34, v54
    v_add_f32 v20, v20, v22
    v_add_f32 v21, v21, v23
    v_mul_f32 v20, s35, v20
    v_mul_f32 v21, s35, v21
    v_cvt_pk_bf16_f32 v118, v20, v21
    v_lshlrev_b32 v20, 16, v39
    v_and_b32 v21, s34, v39
    v_lshlrev_b32 v22, 16, v55
    v_and_b32 v23, s34, v55
    v_add_f32 v20, v20, v22
    v_add_f32 v21, v21, v23
    v_mul_f32 v20, s35, v20
    v_mul_f32 v21, s35, v21
    v_cvt_pk_bf16_f32 v119, v20, v21
    buffer_store_dwordx4 v[116:119], v14, s[44:47], s41 offen offset:1024 sc1
    v_lshlrev_b32 v20, 16, v40
    v_and_b32 v21, s34, v40
    v_lshlrev_b32 v22, 16, v56
    v_and_b32 v23, s34, v56
    v_add_f32 v20, v20, v22
    v_add_f32 v21, v21, v23
    v_mul_f32 v20, s35, v20
    v_mul_f32 v21, s35, v21
    v_cvt_pk_bf16_f32 v120, v20, v21
    v_lshlrev_b32 v20, 16, v41
    v_and_b32 v21, s34, v41
    v_lshlrev_b32 v22, 16, v57
    v_and_b32 v23, s34, v57
    v_add_f32 v20, v20, v22
    v_add_f32 v21, v21, v23
    v_mul_f32 v20, s35, v20
    v_mul_f32 v21, s35, v21
    v_cvt_pk_bf16_f32 v121, v20, v21
    v_lshlrev_b32 v20, 16, v42
    v_and_b32 v21, s34, v42
    v_lshlrev_b32 v22, 16, v58
    v_and_b32 v23, s34, v58
    v_add_f32 v20, v20, v22
    v_add_f32 v21, v21, v23
    v_mul_f32 v20, s35, v20
    v_mul_f32 v21, s35, v21
    v_cvt_pk_bf16_f32 v122, v20, v21
    v_lshlrev_b32 v20, 16, v43
    v_and_b32 v21, s34, v43
    v_lshlrev_b32 v22, 16, v59
    v_and_b32 v23, s34, v59
    v_add_f32 v20, v20, v22
    v_add_f32 v21, v21, v23
    v_mul_f32 v20, s35, v20
    v_mul_f32 v21, s35, v21
    v_cvt_pk_bf16_f32 v123, v20, v21
    buffer_store_dwordx4 v[120:123], v15, s[44:47], s41 offen offset:0 sc1
    v_lshlrev_b32 v20, 16, v44
    v_and_b32 v21, s34, v44
    v_lshlrev_b32 v22, 16, v60
    v_and_b32 v23, s34, v60
    v_add_f32 v20, v20, v22
    v_add_f32 v21, v21, v23
    v_mul_f32 v20, s35, v20
    v_mul_f32 v21, s35, v21
    v_cvt_pk_bf16_f32 v124, v20, v21
    v_lshlrev_b32 v20, 16, v45
    v_and_b32 v21, s34, v45
    v_lshlrev_b32 v22, 16, v61
    v_and_b32 v23, s34, v61
    v_add_f32 v20, v20, v22
    v_add_f32 v21, v21, v23
    v_mul_f32 v20, s35, v20
    v_mul_f32 v21, s35, v21
    v_cvt_pk_bf16_f32 v125, v20, v21
    v_lshlrev_b32 v20, 16, v46
    v_and_b32 v21, s34, v46
    v_lshlrev_b32 v22, 16, v62
    v_and_b32 v23, s34, v62
    v_add_f32 v20, v20, v22
    v_add_f32 v21, v21, v23
    v_mul_f32 v20, s35, v20
    v_mul_f32 v21, s35, v21
    v_cvt_pk_bf16_f32 v126, v20, v21
    v_lshlrev_b32 v20, 16, v47
    v_and_b32 v21, s34, v47
    v_lshlrev_b32 v22, 16, v63
    v_and_b32 v23, s34, v63
    v_add_f32 v20, v20, v22
    v_add_f32 v21, v21, v23
    v_mul_f32 v20, s35, v20
    v_mul_f32 v21, s35, v21
    v_cvt_pk_bf16_f32 v127, v20, v21
    buffer_store_dwordx4 v[124:127], v15, s[44:47], s41 offen offset:1024 sc1
    s_waitcnt vmcnt(20)
    ds_read_b64_tr_b16 v[64:65], v10 offset:8192
    ds_read_b64_tr_b16 v[66:67], v10 offset:8704
    ds_read_b64_tr_b16 v[68:69], v11 offset:8192
    ds_read_b64_tr_b16 v[70:71], v11 offset:8704
    ds_read_b64_tr_b16 v[72:73], v12 offset:8192
    ds_read_b64_tr_b16 v[74:75], v12 offset:8704
    ds_read_b64_tr_b16 v[76:77], v13 offset:8192
    ds_read_b64_tr_b16 v[78:79], v13 offset:8704
    s_waitcnt vmcnt(16)
    ds_read_b64_tr_b16 v[80:81], v10 offset:12288
    ds_read_b64_tr_b16 v[82:83], v10 offset:12800
    ds_read_b64_tr_b16 v[84:85], v11 offset:12288
    ds_read_b64_tr_b16 v[86:87], v11 offset:12800
    ds_read_b64_tr_b16 v[88:89], v12 offset:12288
    ds_read_b64_tr_b16 v[90:91], v12 offset:12800
    ds_read_b64_tr_b16 v[92:93], v13 offset:12288
    ds_read_b64_tr_b16 v[94:95], v13 offset:12800
    s_add_u32 m0, s27, 24576
    s_add_u32 s38, s25, 262144
    buffer_load_dwordx4 v4, s[16:19], s38 offen lds
    s_add_u32 m0, s27, 25600
    s_add_u32 s38, s25, 270336
    buffer_load_dwordx4 v5, s[16:19], s38 offen lds
    s_add_u32 m0, s27, 26624
    s_add_u32 s38, s25, 278528
    buffer_load_dwordx4 v4, s[16:19], s38 offen lds
    s_add_u32 m0, s27, 27648
    s_add_u32 s38, s25, 286720
    buffer_load_dwordx4 v5, s[16:19], s38 offen lds
    s_add_u32 m0, s27, 28672
    s_add_u32 s38, s25, 524288
    buffer_load_dwordx4 v4, s[16:19], s38 offen lds
    s_add_u32 m0, s27, 29696
    s_add_u32 s38, s25, 532480
    buffer_load_dwordx4 v5, s[16:19], s38 offen lds
    s_add_u32 m0, s27, 30720
    s_add_u32 s38, s25, 540672
    buffer_load_dwordx4 v4, s[16:19], s38 offen lds
    s_add_u32 m0, s27, 31744
    s_add_u32 s38, s25, 548864
    buffer_load_dwordx4 v5, s[16:19], s38 offen lds
    s_add_u32 s41, s39, 1212416
    s_waitcnt lgkmcnt(14)
    buffer_store_dwordx4 v[64:67], v14, s[44:47], s41 offen offset:0 sc1
    s_waitcnt lgkmcnt(12)
    buffer_store_dwordx4 v[68:71], v14, s[44:47], s41 offen offset:1024 sc1
    s_waitcnt lgkmcnt(10)
    buffer_store_dwordx4 v[72:75], v15, s[44:47], s41 offen offset:0 sc1
    s_waitcnt lgkmcnt(8)
    buffer_store_dwordx4 v[76:79], v15, s[44:47], s41 offen offset:1024 sc1
    s_nop 1
    s_add_u32 s41, s39, 1245184
    s_waitcnt lgkmcnt(6)
    buffer_store_dwordx4 v[80:83], v14, s[44:47], s41 offen offset:0 sc1
    s_waitcnt lgkmcnt(4)
    buffer_store_dwordx4 v[84:87], v14, s[44:47], s41 offen offset:1024 sc1
    s_waitcnt lgkmcnt(2)
    buffer_store_dwordx4 v[88:91], v15, s[44:47], s41 offen offset:0 sc1
    s_waitcnt lgkmcnt(0)
    buffer_store_dwordx4 v[92:95], v15, s[44:47], s41 offen offset:1024 sc1
    s_nop 1
    s_add_u32 s41, s40, 655360
    v_lshlrev_b32 v20, 16, v64
    v_and_b32 v21, s34, v64
    v_lshlrev_b32 v22, 16, v80
    v_and_b32 v23, s34, v80
    v_add_f32 v20, v20, v22
    v_add_f32 v21, v21, v23
    v_mul_f32 v20, s35, v20
    v_mul_f32 v21, s35, v21
    v_cvt_pk_bf16_f32 v112, v20, v21
    v_lshlrev_b32 v20, 16, v65
    v_and_b32 v21, s34, v65
    v_lshlrev_b32 v22, 16, v81
    v_and_b32 v23, s34, v81
    v_add_f32 v20, v20, v22
    v_add_f32 v21, v21, v23
    v_mul_f32 v20, s35, v20
    v_mul_f32 v21, s35, v21
    v_cvt_pk_bf16_f32 v113, v20, v21
    v_lshlrev_b32 v20, 16, v66
    v_and_b32 v21, s34, v66
    v_lshlrev_b32 v22, 16, v82
    v_and_b32 v23, s34, v82
    v_add_f32 v20, v20, v22
    v_add_f32 v21, v21, v23
    v_mul_f32 v20, s35, v20
    v_mul_f32 v21, s35, v21
    v_cvt_pk_bf16_f32 v114, v20, v21
    v_lshlrev_b32 v20, 16, v67
    v_and_b32 v21, s34, v67
    v_lshlrev_b32 v22, 16, v83
    v_and_b32 v23, s34, v83
    v_add_f32 v20, v20, v22
    v_add_f32 v21, v21, v23
    v_mul_f32 v20, s35, v20
    v_mul_f32 v21, s35, v21
    v_cvt_pk_bf16_f32 v115, v20, v21
    buffer_store_dwordx4 v[112:115], v14, s[44:47], s41 offen offset:0 sc1
    v_lshlrev_b32 v20, 16, v68
    v_and_b32 v21, s34, v68
    v_lshlrev_b32 v22, 16, v84
    v_and_b32 v23, s34, v84
    v_add_f32 v20, v20, v22
    v_add_f32 v21, v21, v23
    v_mul_f32 v20, s35, v20
    v_mul_f32 v21, s35, v21
    v_cvt_pk_bf16_f32 v116, v20, v21
    v_lshlrev_b32 v20, 16, v69
    v_and_b32 v21, s34, v69
    v_lshlrev_b32 v22, 16, v85
    v_and_b32 v23, s34, v85
    v_add_f32 v20, v20, v22
    v_add_f32 v21, v21, v23
    v_mul_f32 v20, s35, v20
    v_mul_f32 v21, s35, v21
    v_cvt_pk_bf16_f32 v117, v20, v21
    v_lshlrev_b32 v20, 16, v70
    v_and_b32 v21, s34, v70
    v_lshlrev_b32 v22, 16, v86
    v_and_b32 v23, s34, v86
    v_add_f32 v20, v20, v22
    v_add_f32 v21, v21, v23
    v_mul_f32 v20, s35, v20
    v_mul_f32 v21, s35, v21
    v_cvt_pk_bf16_f32 v118, v20, v21
    v_lshlrev_b32 v20, 16, v71
    v_and_b32 v21, s34, v71
    v_lshlrev_b32 v22, 16, v87
    v_and_b32 v23, s34, v87
    v_add_f32 v20, v20, v22
    v_add_f32 v21, v21, v23
    v_mul_f32 v20, s35, v20
    v_mul_f32 v21, s35, v21
    v_cvt_pk_bf16_f32 v119, v20, v21
    buffer_store_dwordx4 v[116:119], v14, s[44:47], s41 offen offset:1024 sc1
    v_lshlrev_b32 v20, 16, v72
    v_and_b32 v21, s34, v72
    v_lshlrev_b32 v22, 16, v88
    v_and_b32 v23, s34, v88
    v_add_f32 v20, v20, v22
    v_add_f32 v21, v21, v23
    v_mul_f32 v20, s35, v20
    v_mul_f32 v21, s35, v21
    v_cvt_pk_bf16_f32 v120, v20, v21
    v_lshlrev_b32 v20, 16, v73
    v_and_b32 v21, s34, v73
    v_lshlrev_b32 v22, 16, v89
    v_and_b32 v23, s34, v89
    v_add_f32 v20, v20, v22
    v_add_f32 v21, v21, v23
    v_mul_f32 v20, s35, v20
    v_mul_f32 v21, s35, v21
    v_cvt_pk_bf16_f32 v121, v20, v21
    v_lshlrev_b32 v20, 16, v74
    v_and_b32 v21, s34, v74
    v_lshlrev_b32 v22, 16, v90
    v_and_b32 v23, s34, v90
    v_add_f32 v20, v20, v22
    v_add_f32 v21, v21, v23
    v_mul_f32 v20, s35, v20
    v_mul_f32 v21, s35, v21
    v_cvt_pk_bf16_f32 v122, v20, v21
    v_lshlrev_b32 v20, 16, v75
    v_and_b32 v21, s34, v75
    v_lshlrev_b32 v22, 16, v91
    v_and_b32 v23, s34, v91
    v_add_f32 v20, v20, v22
    v_add_f32 v21, v21, v23
    v_mul_f32 v20, s35, v20
    v_mul_f32 v21, s35, v21
    v_cvt_pk_bf16_f32 v123, v20, v21
    buffer_store_dwordx4 v[120:123], v15, s[44:47], s41 offen offset:0 sc1
    v_lshlrev_b32 v20, 16, v76
    v_and_b32 v21, s34, v76
    v_lshlrev_b32 v22, 16, v92
    v_and_b32 v23, s34, v92
    v_add_f32 v20, v20, v22
    v_add_f32 v21, v21, v23
    v_mul_f32 v20, s35, v20
    v_mul_f32 v21, s35, v21
    v_cvt_pk_bf16_f32 v124, v20, v21
    v_lshlrev_b32 v20, 16, v77
    v_and_b32 v21, s34, v77
    v_lshlrev_b32 v22, 16, v93
    v_and_b32 v23, s34, v93
    v_add_f32 v20, v20, v22
    v_add_f32 v21, v21, v23
    v_mul_f32 v20, s35, v20
    v_mul_f32 v21, s35, v21
    v_cvt_pk_bf16_f32 v125, v20, v21
    v_lshlrev_b32 v20, 16, v78
    v_and_b32 v21, s34, v78
    v_lshlrev_b32 v22, 16, v94
    v_and_b32 v23, s34, v94
    v_add_f32 v20, v20, v22
    v_add_f32 v21, v21, v23
    v_mul_f32 v20, s35, v20
    v_mul_f32 v21, s35, v21
    v_cvt_pk_bf16_f32 v126, v20, v21
    v_lshlrev_b32 v20, 16, v79
    v_and_b32 v21, s34, v79
    v_lshlrev_b32 v22, 16, v95
    v_and_b32 v23, s34, v95
    v_add_f32 v20, v20, v22
    v_add_f32 v21, v21, v23
    v_mul_f32 v20, s35, v20
    v_mul_f32 v21, s35, v21
    v_cvt_pk_bf16_f32 v127, v20, v21
    buffer_store_dwordx4 v[124:127], v15, s[44:47], s41 offen offset:1024 sc1
    s_waitcnt vmcnt(32)
    ds_read_b64_tr_b16 v[32:33], v10 offset:16384
    ds_read_b64_tr_b16 v[34:35], v10 offset:16896
    ds_read_b64_tr_b16 v[36:37], v11 offset:16384
    ds_read_b64_tr_b16 v[38:39], v11 offset:16896
    ds_read_b64_tr_b16 v[40:41], v12 offset:16384
    ds_read_b64_tr_b16 v[42:43], v12 offset:16896
    ds_read_b64_tr_b16 v[44:45], v13 offset:16384
    ds_read_b64_tr_b16 v[46:47], v13 offset:16896
    s_add_u32 m0, s27, 32768
    s_add_u32 s38, s25, 786432
    buffer_load_dwordx4 v4, s[16:19], s38 offen lds
    s_add_u32 m0, s27, 33792
    s_add_u32 s38, s25, 794624
    buffer_load_dwordx4 v5, s[16:19], s38 offen lds
    s_add_u32 m0, s27, 34816
    s_add_u32 s38, s25, 802816
    buffer_load_dwordx4 v4, s[16:19], s38 offen lds
    s_add_u32 m0, s27, 35840
    s_add_u32 s38, s25, 811008
    buffer_load_dwordx4 v5, s[16:19], s38 offen lds
    s_add_u32 m0, s27, 36864
    s_add_u32 s38, s25, 1048576
    buffer_load_dwordx4 v4, s[16:19], s38 offen lds
    s_add_u32 m0, s27, 37888
    s_add_u32 s38, s25, 1056768
    buffer_load_dwordx4 v5, s[16:19], s38 offen lds
    s_add_u32 m0, s27, 38912
    s_add_u32 s38, s25, 1064960
    buffer_load_dwordx4 v4, s[16:19], s38 offen lds
    s_add_u32 m0, s27, 39936
    s_add_u32 s38, s25, 1073152
    buffer_load_dwordx4 v5, s[16:19], s38 offen lds
    s_add_u32 s41, s39, 1114112
    s_waitcnt lgkmcnt(6)
    buffer_store_dwordx4 v[32:35], v14, s[44:47], s41 offen offset:0 sc1
    s_waitcnt lgkmcnt(4)
    buffer_store_dwordx4 v[36:39], v14, s[44:47], s41 offen offset:1024 sc1
    s_waitcnt lgkmcnt(2)
    buffer_store_dwordx4 v[40:43], v15, s[44:47], s41 offen offset:0 sc1
    s_waitcnt lgkmcnt(0)
    buffer_store_dwordx4 v[44:47], v15, s[44:47], s41 offen offset:1024 sc1
    s_nop 1
    s_add_u32 s41, s40, 589824
    v_lshlrev_b32 v20, 16, v32
    v_and_b32 v21, s34, v32
    v_mul_f32 v20, s35, v20
    v_mul_f32 v21, s35, v21
    v_cvt_pk_bf16_f32 v112, v20, v21
    v_lshlrev_b32 v20, 16, v33
    v_and_b32 v21, s34, v33
    v_mul_f32 v20, s35, v20
    v_mul_f32 v21, s35, v21
    v_cvt_pk_bf16_f32 v113, v20, v21
    v_lshlrev_b32 v20, 16, v34
    v_and_b32 v21, s34, v34
    v_mul_f32 v20, s35, v20
    v_mul_f32 v21, s35, v21
    v_cvt_pk_bf16_f32 v114, v20, v21
    v_lshlrev_b32 v20, 16, v35
    v_and_b32 v21, s34, v35
    v_mul_f32 v20, s35, v20
    v_mul_f32 v21, s35, v21
    v_cvt_pk_bf16_f32 v115, v20, v21
    buffer_store_dwordx4 v[112:115], v14, s[44:47], s41 offen offset:0 sc1
    v_lshlrev_b32 v20, 16, v36
    v_and_b32 v21, s34, v36
    v_mul_f32 v20, s35, v20
    v_mul_f32 v21, s35, v21
    v_cvt_pk_bf16_f32 v116, v20, v21
    v_lshlrev_b32 v20, 16, v37
    v_and_b32 v21, s34, v37
    v_mul_f32 v20, s35, v20
    v_mul_f32 v21, s35, v21
    v_cvt_pk_bf16_f32 v117, v20, v21
    v_lshlrev_b32 v20, 16, v38
    v_and_b32 v21, s34, v38
    v_mul_f32 v20, s35, v20
    v_mul_f32 v21, s35, v21
    v_cvt_pk_bf16_f32 v118, v20, v21
    v_lshlrev_b32 v20, 16, v39
    v_and_b32 v21, s34, v39
    v_mul_f32 v20, s35, v20
    v_mul_f32 v21, s35, v21
    v_cvt_pk_bf16_f32 v119, v20, v21
    buffer_store_dwordx4 v[116:119], v14, s[44:47], s41 offen offset:1024 sc1
    v_lshlrev_b32 v20, 16, v40
    v_and_b32 v21, s34, v40
    v_mul_f32 v20, s35, v20
    v_mul_f32 v21, s35, v21
    v_cvt_pk_bf16_f32 v120, v20, v21
    v_lshlrev_b32 v20, 16, v41
    v_and_b32 v21, s34, v41
    v_mul_f32 v20, s35, v20
    v_mul_f32 v21, s35, v21
    v_cvt_pk_bf16_f32 v121, v20, v21
    v_lshlrev_b32 v20, 16, v42
    v_and_b32 v21, s34, v42
    v_mul_f32 v20, s35, v20
    v_mul_f32 v21, s35, v21
    v_cvt_pk_bf16_f32 v122, v20, v21
    v_lshlrev_b32 v20, 16, v43
    v_and_b32 v21, s34, v43
    v_mul_f32 v20, s35, v20
    v_mul_f32 v21, s35, v21
    v_cvt_pk_bf16_f32 v123, v20, v21
    buffer_store_dwordx4 v[120:123], v15, s[44:47], s41 offen offset:0 sc1
    v_lshlrev_b32 v20, 16, v44
    v_and_b32 v21, s34, v44
    v_mul_f32 v20, s35, v20
    v_mul_f32 v21, s35, v21
    v_cvt_pk_bf16_f32 v124, v20, v21
    v_lshlrev_b32 v20, 16, v45
    v_and_b32 v21, s34, v45
    v_mul_f32 v20, s35, v20
    v_mul_f32 v21, s35, v21
    v_cvt_pk_bf16_f32 v125, v20, v21
    v_lshlrev_b32 v20, 16, v46
    v_and_b32 v21, s34, v46
    v_mul_f32 v20, s35, v20
    v_mul_f32 v21, s35, v21
    v_cvt_pk_bf16_f32 v126, v20, v21
    v_lshlrev_b32 v20, 16, v47
    v_and_b32 v21, s34, v47
    v_mul_f32 v20, s35, v20
    v_mul_f32 v21, s35, v21
    v_cvt_pk_bf16_f32 v127, v20, v21
    buffer_store_dwordx4 v[124:127], v15, s[44:47], s41 offen offset:1024 sc1
    s_waitcnt vmcnt(32)
    ds_read_b64_tr_b16 v[64:65], v10 offset:24576
    ds_read_b64_tr_b16 v[66:67], v10 offset:25088
    ds_read_b64_tr_b16 v[68:69], v11 offset:24576
    ds_read_b64_tr_b16 v[70:71], v11 offset:25088
    ds_read_b64_tr_b16 v[72:73], v12 offset:24576
    ds_read_b64_tr_b16 v[74:75], v12 offset:25088
    ds_read_b64_tr_b16 v[76:77], v13 offset:24576
    ds_read_b64_tr_b16 v[78:79], v13 offset:25088
    s_waitcnt vmcnt(28)
    ds_read_b64_tr_b16 v[80:81], v10 offset:28672
    ds_read_b64_tr_b16 v[82:83], v10 offset:29184
    ds_read_b64_tr_b16 v[84:85], v11 offset:28672
    ds_read_b64_tr_b16 v[86:87], v11 offset:29184
    ds_read_b64_tr_b16 v[88:89], v12 offset:28672
    ds_read_b64_tr_b16 v[90:91], v12 offset:29184
    ds_read_b64_tr_b16 v[92:93], v13 offset:28672
    ds_read_b64_tr_b16 v[94:95], v13 offset:29184
    s_add_u32 m0, s27, 0
    s_add_u32 s38, s25, 0
    buffer_load_dwordx4 v4, s[16:19], s38 offen lds
    s_add_u32 m0, s27, 1024
    s_add_u32 s38, s25, 8192
    buffer_load_dwordx4 v5, s[16:19], s38 offen lds
    s_add_u32 m0, s27, 2048
    s_add_u32 s38, s25, 16384
    buffer_load_dwordx4 v4, s[16:19], s38 offen lds
    s_add_u32 m0, s27, 3072
    s_add_u32 s38, s25, 24576
    buffer_load_dwordx4 v5, s[16:19], s38 offen lds
    s_add_u32 s41, s40, 32768
    s_waitcnt lgkmcnt(15)
    v_lshlrev_b32 v20, 16, v64
    v_and_b32 v21, s34, v64
    s_waitcnt lgkmcnt(7)
    v_lshlrev_b32 v22, 16, v80
    v_and_b32 v23, s34, v80
    v_add_f32 v20, v20, v22
    v_add_f32 v21, v21, v23
    v_mul_f32 v20, s35, v20
    v_mul_f32 v21, s35, v21
    v_cvt_pk_bf16_f32 v112, v20, v21
    v_lshlrev_b32 v20, 16, v65
    v_and_b32 v21, s34, v65
    v_lshlrev_b32 v22, 16, v81
    v_and_b32 v23, s34, v81
    v_add_f32 v20, v20, v22
    v_add_f32 v21, v21, v23
    v_mul_f32 v20, s35, v20
    v_mul_f32 v21, s35, v21
    v_cvt_pk_bf16_f32 v113, v20, v21
    v_lshlrev_b32 v20, 16, v66
    v_and_b32 v21, s34, v66
    s_waitcnt lgkmcnt(6)
    v_lshlrev_b32 v22, 16, v82
    v_and_b32 v23, s34, v82
    v_add_f32 v20, v20, v22
    v_add_f32 v21, v21, v23
    v_mul_f32 v20, s35, v20
    v_mul_f32 v21, s35, v21
    v_cvt_pk_bf16_f32 v114, v20, v21
    v_lshlrev_b32 v20, 16, v67
    v_and_b32 v21, s34, v67
    v_lshlrev_b32 v22, 16, v83
    v_and_b32 v23, s34, v83
    v_add_f32 v20, v20, v22
    v_add_f32 v21, v21, v23
    v_mul_f32 v20, s35, v20
    v_mul_f32 v21, s35, v21
    v_cvt_pk_bf16_f32 v115, v20, v21
    buffer_store_dwordx4 v[112:115], v14, s[44:47], s41 offen offset:0 sc1
    v_lshlrev_b32 v20, 16, v68
    v_and_b32 v21, s34, v68
    s_waitcnt lgkmcnt(0)
    v_lshlrev_b32 v22, 16, v84
    v_and_b32 v23, s34, v84
    v_add_f32 v20, v20, v22
    v_add_f32 v21, v21, v23
    v_mul_f32 v20, s35, v20
    v_mul_f32 v21, s35, v21
    v_cvt_pk_bf16_f32 v116, v20, v21
    v_lshlrev_b32 v20, 16, v69
    v_and_b32 v21, s34, v69
    v_lshlrev_b32 v22, 16, v85
    v_and_b32 v23, s34, v85
    v_add_f32 v20, v20, v22
    v_add_f32 v21, v21, v23
    v_mul_f32 v20, s35, v20
    v_mul_f32 v21, s35, v21
    v_cvt_pk_bf16_f32 v117, v20, v21
    v_lshlrev_b32 v20, 16, v70
    v_and_b32 v21, s34, v70
    v_lshlrev_b32 v22, 16, v86
    v_and_b32 v23, s34, v86
    v_add_f32 v20, v20, v22
    v_add_f32 v21, v21, v23
    v_mul_f32 v20, s35, v20
    v_mul_f32 v21, s35, v21
    v_cvt_pk_bf16_f32 v118, v20, v21
    v_lshlrev_b32 v20, 16, v71
    v_and_b32 v21, s34, v71
    v_lshlrev_b32 v22, 16, v87
    v_and_b32 v23, s34, v87
    v_add_f32 v20, v20, v22
    v_add_f32 v21, v21, v23
    v_mul_f32 v20, s35, v20
    v_mul_f32 v21, s35, v21
    v_cvt_pk_bf16_f32 v119, v20, v21
    buffer_store_dwordx4 v[116:119], v14, s[44:47], s41 offen offset:1024 sc1
    v_lshlrev_b32 v20, 16, v72
    v_and_b32 v21, s34, v72
    v_lshlrev_b32 v22, 16, v88
    v_and_b32 v23, s34, v88
    v_add_f32 v20, v20, v22
    v_add_f32 v21, v21, v23
    v_mul_f32 v20, s35, v20
    v_mul_f32 v21, s35, v21
    v_cvt_pk_bf16_f32 v120, v20, v21
    v_lshlrev_b32 v20, 16, v73
    v_and_b32 v21, s34, v73
    v_lshlrev_b32 v22, 16, v89
    v_and_b32 v23, s34, v89
    v_add_f32 v20, v20, v22
    v_add_f32 v21, v21, v23
    v_mul_f32 v20, s35, v20
    v_mul_f32 v21, s35, v21
    v_cvt_pk_bf16_f32 v121, v20, v21
    v_lshlrev_b32 v20, 16, v74
    v_and_b32 v21, s34, v74
    v_lshlrev_b32 v22, 16, v90
    v_and_b32 v23, s34, v90
    v_add_f32 v20, v20, v22
    v_add_f32 v21, v21, v23
    v_mul_f32 v20, s35, v20
    v_mul_f32 v21, s35, v21
    v_cvt_pk_bf16_f32 v122, v20, v21
    v_lshlrev_b32 v20, 16, v75
    v_and_b32 v21, s34, v75
    v_lshlrev_b32 v22, 16, v91
    v_and_b32 v23, s34, v91
    v_add_f32 v20, v20, v22
    v_add_f32 v21, v21, v23
    v_mul_f32 v20, s35, v20
    v_mul_f32 v21, s35, v21
    v_cvt_pk_bf16_f32 v123, v20, v21
    s_waitcnt vmcnt(6)
    s_barrier
    buffer_atomic_add v18, v17, s[48:51], 0 offen offset:0
    buffer_store_dwordx4 v[120:123], v15, s[44:47], s41 offen offset:0 sc1
    v_lshlrev_b32 v20, 16, v76
    v_and_b32 v21, s34, v76
    v_lshlrev_b32 v22, 16, v92
    v_and_b32 v23, s34, v92
    v_add_f32 v20, v20, v22
    v_add_f32 v21, v21, v23
    v_mul_f32 v20, s35, v20
    v_mul_f32 v21, s35, v21
    v_cvt_pk_bf16_f32 v124, v20, v21
    v_lshlrev_b32 v20, 16, v77
    v_and_b32 v21, s34, v77
    v_lshlrev_b32 v22, 16, v93
    v_and_b32 v23, s34, v93
    v_add_f32 v20, v20, v22
    v_add_f32 v21, v21, v23
    v_mul_f32 v20, s35, v20
    v_mul_f32 v21, s35, v21
    v_cvt_pk_bf16_f32 v125, v20, v21
    v_lshlrev_b32 v20, 16, v78
    v_and_b32 v21, s34, v78
    v_lshlrev_b32 v22, 16, v94
    v_and_b32 v23, s34, v94
    v_add_f32 v20, v20, v22
    v_add_f32 v21, v21, v23
    v_mul_f32 v20, s35, v20
    v_mul_f32 v21, s35, v21
    v_cvt_pk_bf16_f32 v126, v20, v21
    v_lshlrev_b32 v20, 16, v79
    v_and_b32 v21, s34, v79
    v_lshlrev_b32 v22, 16, v95
    v_and_b32 v23, s34, v95
    v_add_f32 v20, v20, v22
    v_add_f32 v21, v21, v23
    v_mul_f32 v20, s35, v20
    v_mul_f32 v21, s35, v21
    v_cvt_pk_bf16_f32 v127, v20, v21
    buffer_store_dwordx4 v[124:127], v15, s[44:47], s41 offen offset:1024 sc1
    ds_read_b64_tr_b16 v[32:33], v10 offset:32768
    ds_read_b64_tr_b16 v[34:35], v10 offset:33280
    ds_read_b64_tr_b16 v[36:37], v11 offset:32768
    ds_read_b64_tr_b16 v[38:39], v11 offset:33280
    ds_read_b64_tr_b16 v[40:41], v12 offset:32768
    ds_read_b64_tr_b16 v[42:43], v12 offset:33280
    ds_read_b64_tr_b16 v[44:45], v13 offset:32768
    ds_read_b64_tr_b16 v[46:47], v13 offset:33280
    ds_read_b64_tr_b16 v[48:49], v10 offset:36864
    ds_read_b64_tr_b16 v[50:51], v10 offset:37376
    ds_read_b64_tr_b16 v[52:53], v11 offset:36864
    ds_read_b64_tr_b16 v[54:55], v11 offset:37376
    ds_read_b64_tr_b16 v[56:57], v12 offset:36864
    ds_read_b64_tr_b16 v[58:59], v12 offset:37376
    ds_read_b64_tr_b16 v[60:61], v13 offset:36864
    ds_read_b64_tr_b16 v[62:63], v13 offset:37376
    s_add_u32 m0, s27, 8192
    s_add_u32 s38, s25, 327680
    buffer_load_dwordx4 v4, s[16:19], s38 offen lds
    s_add_u32 m0, s27, 9216
    s_add_u32 s38, s25, 335872
    buffer_load_dwordx4 v5, s[16:19], s38 offen lds
    s_add_u32 m0, s27, 10240
    s_add_u32 s38, s25, 344064
    buffer_load_dwordx4 v4, s[16:19], s38 offen lds
    s_add_u32 m0, s27, 11264
    s_add_u32 s38, s25, 352256
    buffer_load_dwordx4 v5, s[16:19], s38 offen lds
    s_add_u32 m0, s27, 12288
    s_add_u32 s38, s25, 589824
    buffer_load_dwordx4 v4, s[16:19], s38 offen lds
    s_add_u32 m0, s27, 13312
    s_add_u32 s38, s25, 598016
    buffer_load_dwordx4 v5, s[16:19], s38 offen lds
    s_add_u32 m0, s27, 14336
    s_add_u32 s38, s25, 606208
    buffer_load_dwordx4 v4, s[16:19], s38 offen lds
    s_add_u32 m0, s27, 15360
    s_add_u32 s38, s25, 614400
    buffer_load_dwordx4 v5, s[16:19], s38 offen lds
    s_add_u32 s41, s40, 65536
    s_waitcnt lgkmcnt(15)
    v_lshlrev_b32 v20, 16, v32
    v_and_b32 v21, s34, v32
    s_waitcnt lgkmcnt(7)
    v_lshlrev_b32 v22, 16, v48
    v_and_b32 v23, s34, v48
    v_add_f32 v20, v20, v22
    v_add_f32 v21, v21, v23
    v_mul_f32 v20, s35, v20
    v_mul_f32 v21, s35, v21
    v_cvt_pk_bf16_f32 v112, v20, v21
    v_lshlrev_b32 v20, 16, v33
    v_and_b32 v21, s34, v33
    v_lshlrev_b32 v22, 16, v49
    v_and_b32 v23, s34, v49
    v_add_f32 v20, v20, v22
    v_add_f32 v21, v21, v23
    v_mul_f32 v20, s35, v20
    v_mul_f32 v21, s35, v21
    v_cvt_pk_bf16_f32 v113, v20, v21
    v_lshlrev_b32 v20, 16, v34
    v_and_b32 v21, s34, v34
    s_waitcnt lgkmcnt(2)
    v_lshlrev_b32 v22, 16, v50
    v_and_b32 v23, s34, v50
    v_add_f32 v20, v20, v22
    v_add_f32 v21, v21, v23
    v_mul_f32 v20, s35, v20
    v_mul_f32 v21, s35, v21
    v_cvt_pk_bf16_f32 v114, v20, v21
    v_lshlrev_b32 v20, 16, v35
    v_and_b32 v21, s34, v35
    v_lshlrev_b32 v22, 16, v51
    v_and_b32 v23, s34, v51
    v_add_f32 v20, v20, v22
    v_add_f32 v21, v21, v23
    v_mul_f32 v20, s35, v20
    v_mul_f32 v21, s35, v21
    v_cvt_pk_bf16_f32 v115, v20, v21
    buffer_store_dwordx4 v[112:115], v14, s[44:47], s41 offen offset:0 sc1
    v_lshlrev_b32 v20, 16, v36
    v_and_b32 v21, s34, v36
    v_lshlrev_b32 v22, 16, v52
    v_and_b32 v23, s34, v52
    v_add_f32 v20, v20, v22
    v_add_f32 v21, v21, v23
    v_mul_f32 v20, s35, v20
    v_mul_f32 v21, s35, v21
    v_cvt_pk_bf16_f32 v116, v20, v21
    v_lshlrev_b32 v20, 16, v37
    v_and_b32 v21, s34, v37
    v_lshlrev_b32 v22, 16, v53
    v_and_b32 v23, s34, v53
    v_add_f32 v20, v20, v22
    v_add_f32 v21, v21, v23
    v_mul_f32 v20, s35, v20
    v_mul_f32 v21, s35, v21
    v_cvt_pk_bf16_f32 v117, v20, v21
    v_lshlrev_b32 v20, 16, v38
    v_and_b32 v21, s34, v38
    v_lshlrev_b32 v22, 16, v54
    v_and_b32 v23, s34, v54
    v_add_f32 v20, v20, v22
    v_add_f32 v21, v21, v23
    v_mul_f32 v20, s35, v20
    v_mul_f32 v21, s35, v21
    v_cvt_pk_bf16_f32 v118, v20, v21
    v_lshlrev_b32 v20, 16, v39
    v_and_b32 v21, s34, v39
    v_lshlrev_b32 v22, 16, v55
    v_and_b32 v23, s34, v55
    v_add_f32 v20, v20, v22
    v_add_f32 v21, v21, v23
    v_mul_f32 v20, s35, v20
    v_mul_f32 v21, s35, v21
    v_cvt_pk_bf16_f32 v119, v20, v21
    buffer_store_dwordx4 v[116:119], v14, s[44:47], s41 offen offset:1024 sc1
    v_lshlrev_b32 v20, 16, v40
    v_and_b32 v21, s34, v40
    v_lshlrev_b32 v22, 16, v56
    v_and_b32 v23, s34, v56
    v_add_f32 v20, v20, v22
    v_add_f32 v21, v21, v23
    v_mul_f32 v20, s35, v20
    v_mul_f32 v21, s35, v21
    v_cvt_pk_bf16_f32 v120, v20, v21
    v_lshlrev_b32 v20, 16, v41
    v_and_b32 v21, s34, v41
    v_lshlrev_b32 v22, 16, v57
    v_and_b32 v23, s34, v57
    v_add_f32 v20, v20, v22
    v_add_f32 v21, v21, v23
    v_mul_f32 v20, s35, v20
    v_mul_f32 v21, s35, v21
    v_cvt_pk_bf16_f32 v121, v20, v21
    v_lshlrev_b32 v20, 16, v42
    v_and_b32 v21, s34, v42
    v_lshlrev_b32 v22, 16, v58
    v_and_b32 v23, s34, v58
    v_add_f32 v20, v20, v22
    v_add_f32 v21, v21, v23
    v_mul_f32 v20, s35, v20
    v_mul_f32 v21, s35, v21
    v_cvt_pk_bf16_f32 v122, v20, v21
    v_lshlrev_b32 v20, 16, v43
    v_and_b32 v21, s34, v43
    v_lshlrev_b32 v22, 16, v59
    v_and_b32 v23, s34, v59
    v_add_f32 v20, v20, v22
    v_add_f32 v21, v21, v23
    v_mul_f32 v20, s35, v20
    v_mul_f32 v21, s35, v21
    v_cvt_pk_bf16_f32 v123, v20, v21
    buffer_store_dwordx4 v[120:123], v15, s[44:47], s41 offen offset:0 sc1
    v_lshlrev_b32 v20, 16, v44
    v_and_b32 v21, s34, v44
    s_waitcnt lgkmcnt(0)
    v_lshlrev_b32 v22, 16, v60
    v_and_b32 v23, s34, v60
    v_add_f32 v20, v20, v22
    v_add_f32 v21, v21, v23
    v_mul_f32 v20, s35, v20
    v_mul_f32 v21, s35, v21
    v_cvt_pk_bf16_f32 v124, v20, v21
    v_lshlrev_b32 v20, 16, v45
    v_and_b32 v21, s34, v45
    v_lshlrev_b32 v22, 16, v61
    v_and_b32 v23, s34, v61
    v_add_f32 v20, v20, v22
    v_add_f32 v21, v21, v23
    v_mul_f32 v20, s35, v20
    v_mul_f32 v21, s35, v21
    v_cvt_pk_bf16_f32 v125, v20, v21
    v_lshlrev_b32 v20, 16, v46
    v_and_b32 v21, s34, v46
    v_lshlrev_b32 v22, 16, v62
    v_and_b32 v23, s34, v62
    v_add_f32 v20, v20, v22
    v_add_f32 v21, v21, v23
    v_mul_f32 v20, s35, v20
    v_mul_f32 v21, s35, v21
    v_cvt_pk_bf16_f32 v126, v20, v21
    v_lshlrev_b32 v20, 16, v47
    v_and_b32 v21, s34, v47
    v_lshlrev_b32 v22, 16, v63
    v_and_b32 v23, s34, v63
    v_add_f32 v20, v20, v22
    v_add_f32 v21, v21, v23
    v_mul_f32 v20, s35, v20
    v_mul_f32 v21, s35, v21
    v_cvt_pk_bf16_f32 v127, v20, v21
    buffer_store_dwordx4 v[124:127], v15, s[44:47], s41 offen offset:1024 sc1
    s_waitcnt vmcnt(17)
    ds_read_b64_tr_b16 v[64:65], v10 offset:0
    ds_read_b64_tr_b16 v[66:67], v10 offset:512
    ds_read_b64_tr_b16 v[68:69], v11 offset:0
    ds_read_b64_tr_b16 v[70:71], v11 offset:512
    ds_read_b64_tr_b16 v[72:73], v12 offset:0
    ds_read_b64_tr_b16 v[74:75], v12 offset:512
    ds_read_b64_tr_b16 v[76:77], v13 offset:0
    ds_read_b64_tr_b16 v[78:79], v13 offset:512
    s_add_u32 m0, s27, 16384
    s_add_u32 s38, s25, 851968
    buffer_load_dwordx4 v4, s[16:19], s38 offen lds
    s_add_u32 m0, s27, 17408
    s_add_u32 s38, s25, 860160
    buffer_load_dwordx4 v5, s[16:19], s38 offen lds
    s_add_u32 m0, s27, 18432
    s_add_u32 s38, s25, 868352
    buffer_load_dwordx4 v4, s[16:19], s38 offen lds
    s_add_u32 m0, s27, 19456
    s_add_u32 s38, s25, 876544
    buffer_load_dwordx4 v5, s[16:19], s38 offen lds
    s_add_u32 m0, s27, 20480
    s_add_u32 s38, s25, 1114112
    buffer_load_dwordx4 v4, s[16:19], s38 offen lds
    s_add_u32 m0, s27, 21504
    s_add_u32 s38, s25, 1122304
    buffer_load_dwordx4 v5, s[16:19], s38 offen lds
    s_add_u32 m0, s27, 22528
    s_add_u32 s38, s25, 1130496
    buffer_load_dwordx4 v4, s[16:19], s38 offen lds
    s_add_u32 m0, s27, 23552
    s_add_u32 s38, s25, 1138688
    buffer_load_dwordx4 v5, s[16:19], s38 offen lds
    s_add_u32 s41, s40, 0
    s_waitcnt lgkmcnt(7)
    v_lshlrev_b32 v20, 16, v64
    v_and_b32 v21, s34, v64
    v_mul_f32 v20, s35, v20
    v_mul_f32 v21, s35, v21
    v_cvt_pk_bf16_f32 v112, v20, v21
    v_lshlrev_b32 v20, 16, v65
    v_and_b32 v21, s34, v65
    v_mul_f32 v20, s35, v20
    v_mul_f32 v21, s35, v21
    v_cvt_pk_bf16_f32 v113, v20, v21
    s_waitcnt lgkmcnt(6)
    v_lshlrev_b32 v20, 16, v66
    v_and_b32 v21, s34, v66
    v_mul_f32 v20, s35, v20
    v_mul_f32 v21, s35, v21
    v_cvt_pk_bf16_f32 v114, v20, v21
    v_lshlrev_b32 v20, 16, v67
    v_and_b32 v21, s34, v67
    v_mul_f32 v20, s35, v20
    v_mul_f32 v21, s35, v21
    v_cvt_pk_bf16_f32 v115, v20, v21
    buffer_store_dwordx4 v[112:115], v14, s[44:47], s41 offen offset:0 sc1
    s_waitcnt lgkmcnt(1)
    v_lshlrev_b32 v20, 16, v68
    v_and_b32 v21, s34, v68
    v_mul_f32 v20, s35, v20
    v_mul_f32 v21, s35, v21
    v_cvt_pk_bf16_f32 v116, v20, v21
    v_lshlrev_b32 v20, 16, v69
    v_and_b32 v21, s34, v69
    v_mul_f32 v20, s35, v20
    v_mul_f32 v21, s35, v21
    v_cvt_pk_bf16_f32 v117, v20, v21
    v_lshlrev_b32 v20, 16, v70
    v_and_b32 v21, s34, v70
    v_mul_f32 v20, s35, v20
    v_mul_f32 v21, s35, v21
    v_cvt_pk_bf16_f32 v118, v20, v21
    v_lshlrev_b32 v20, 16, v71
    v_and_b32 v21, s34, v71
    v_mul_f32 v20, s35, v20
    v_mul_f32 v21, s35, v21
    v_cvt_pk_bf16_f32 v119, v20, v21
    buffer_store_dwordx4 v[116:119], v14, s[44:47], s41 offen offset:1024 sc1
    v_lshlrev_b32 v20, 16, v72
    v_and_b32 v21, s34, v72
    v_mul_f32 v20, s35, v20
    v_mul_f32 v21, s35, v21
    v_cvt_pk_bf16_f32 v120, v20, v21
    v_lshlrev_b32 v20, 16, v73
    v_and_b32 v21, s34, v73
    v_mul_f32 v20, s35, v20
    v_mul_f32 v21, s35, v21
    v_cvt_pk_bf16_f32 v121, v20, v21
    v_lshlrev_b32 v20, 16, v74
    v_and_b32 v21, s34, v74
    v_mul_f32 v20, s35, v20
    v_mul_f32 v21, s35, v21
    v_cvt_pk_bf16_f32 v122, v20, v21
    v_lshlrev_b32 v20, 16, v75
    v_and_b32 v21, s34, v75
    v_mul_f32 v20, s35, v20
    v_mul_f32 v21, s35, v21
    v_cvt_pk_bf16_f32 v123, v20, v21
    buffer_store_dwordx4 v[120:123], v15, s[44:47], s41 offen offset:0 sc1
    v_lshlrev_b32 v20, 16, v76
    v_and_b32 v21, s34, v76
    v_mul_f32 v20, s35, v20
    v_mul_f32 v21, s35, v21
    v_cvt_pk_bf16_f32 v124, v20, v21
    v_lshlrev_b32 v20, 16, v77
    v_and_b32 v21, s34, v77
    v_mul_f32 v20, s35, v20
    v_mul_f32 v21, s35, v21
    v_cvt_pk_bf16_f32 v125, v20, v21
    s_waitcnt lgkmcnt(0)
    v_lshlrev_b32 v20, 16, v78
    v_and_b32 v21, s34, v78
    v_mul_f32 v20, s35, v20
    v_mul_f32 v21, s35, v21
    v_cvt_pk_bf16_f32 v126, v20, v21
    v_lshlrev_b32 v20, 16, v79
    v_and_b32 v21, s34, v79
    v_mul_f32 v20, s35, v20
    v_mul_f32 v21, s35, v21
    v_cvt_pk_bf16_f32 v127, v20, v21
    buffer_store_dwordx4 v[124:127], v15, s[44:47], s41 offen offset:1024 sc1
    s_waitcnt vmcnt(20)
    ds_read_b64_tr_b16 v[32:33], v10 offset:8192
    ds_read_b64_tr_b16 v[34:35], v10 offset:8704
    ds_read_b64_tr_b16 v[36:37], v11 offset:8192
    ds_read_b64_tr_b16 v[38:39], v11 offset:8704
    ds_read_b64_tr_b16 v[40:41], v12 offset:8192
    ds_read_b64_tr_b16 v[42:43], v12 offset:8704
    ds_read_b64_tr_b16 v[44:45], v13 offset:8192
    ds_read_b64_tr_b16 v[46:47], v13 offset:8704
    s_waitcnt vmcnt(16)
    ds_read_b64_tr_b16 v[48:49], v10 offset:12288
    ds_read_b64_tr_b16 v[50:51], v10 offset:12800
    ds_read_b64_tr_b16 v[52:53], v11 offset:12288
    ds_read_b64_tr_b16 v[54:55], v11 offset:12800
    ds_read_b64_tr_b16 v[56:57], v12 offset:12288
    ds_read_b64_tr_b16 v[58:59], v12 offset:12800
    ds_read_b64_tr_b16 v[60:61], v13 offset:12288
    ds_read_b64_tr_b16 v[62:63], v13 offset:12800
    s_add_u32 m0, s27, 24576
    s_add_u32 s38, s25, 65536
    buffer_load_dwordx4 v4, s[16:19], s38 offen lds
    s_add_u32 m0, s27, 25600
    s_add_u32 s38, s25, 73728
    buffer_load_dwordx4 v5, s[16:19], s38 offen lds
    s_add_u32 m0, s27, 26624
    s_add_u32 s38, s25, 81920
    buffer_load_dwordx4 v4, s[16:19], s38 offen lds
    s_add_u32 m0, s27, 27648
    s_add_u32 s38, s25, 90112
    buffer_load_dwordx4 v5, s[16:19], s38 offen lds
    s_add_u32 s41, s40, 229376
    s_waitcnt lgkmcnt(15)
    v_lshlrev_b32 v20, 16, v32
    v_and_b32 v21, s34, v32
    s_waitcnt lgkmcnt(7)
    v_lshlrev_b32 v22, 16, v48
    v_and_b32 v23, s34, v48
    v_add_f32 v20, v20, v22
    v_add_f32 v21, v21, v23
    v_mul_f32 v20, s35, v20
    v_mul_f32 v21, s35, v21
    v_cvt_pk_bf16_f32 v112, v20, v21
    v_lshlrev_b32 v20, 16, v33
    v_and_b32 v21, s34, v33
    v_lshlrev_b32 v22, 16, v49
    v_and_b32 v23, s34, v49
    v_add_f32 v20, v20, v22
    v_add_f32 v21, v21, v23
    v_mul_f32 v20, s35, v20
    v_mul_f32 v21, s35, v21
    v_cvt_pk_bf16_f32 v113, v20, v21
    v_lshlrev_b32 v20, 16, v34
    v_and_b32 v21, s34, v34
    s_waitcnt lgkmcnt(6)
    v_lshlrev_b32 v22, 16, v50
    v_and_b32 v23, s34, v50
    v_add_f32 v20, v20, v22
    v_add_f32 v21, v21, v23
    v_mul_f32 v20, s35, v20
    v_mul_f32 v21, s35, v21
    v_cvt_pk_bf16_f32 v114, v20, v21
    v_lshlrev_b32 v20, 16, v35
    v_and_b32 v21, s34, v35
    v_lshlrev_b32 v22, 16, v51
    v_and_b32 v23, s34, v51
    v_add_f32 v20, v20, v22
    v_add_f32 v21, v21, v23
    v_mul_f32 v20, s35, v20
    v_mul_f32 v21, s35, v21
    v_cvt_pk_bf16_f32 v115, v20, v21
    buffer_store_dwordx4 v[112:115], v14, s[44:47], s41 offen offset:0 sc1
    v_lshlrev_b32 v20, 16, v36
    v_and_b32 v21, s34, v36
    s_waitcnt lgkmcnt(0)
    v_lshlrev_b32 v22, 16, v52
    v_and_b32 v23, s34, v52
    v_add_f32 v20, v20, v22
    v_add_f32 v21, v21, v23
    v_mul_f32 v20, s35, v20
    v_mul_f32 v21, s35, v21
    v_cvt_pk_bf16_f32 v116, v20, v21
    v_lshlrev_b32 v20, 16, v37
    v_and_b32 v21, s34, v37
    v_lshlrev_b32 v22, 16, v53
    v_and_b32 v23, s34, v53
    v_add_f32 v20, v20, v22
    v_add_f32 v21, v21, v23
    v_mul_f32 v20, s35, v20
    v_mul_f32 v21, s35, v21
    v_cvt_pk_bf16_f32 v117, v20, v21
    v_lshlrev_b32 v20, 16, v38
    v_and_b32 v21, s34, v38
    v_lshlrev_b32 v22, 16, v54
    v_and_b32 v23, s34, v54
    v_add_f32 v20, v20, v22
    v_add_f32 v21, v21, v23
    v_mul_f32 v20, s35, v20
    v_mul_f32 v21, s35, v21
    v_cvt_pk_bf16_f32 v118, v20, v21
    v_lshlrev_b32 v20, 16, v39
    v_and_b32 v21, s34, v39
    v_lshlrev_b32 v22, 16, v55
    v_and_b32 v23, s34, v55
    v_add_f32 v20, v20, v22
    v_add_f32 v21, v21, v23
    v_mul_f32 v20, s35, v20
    v_mul_f32 v21, s35, v21
    v_cvt_pk_bf16_f32 v119, v20, v21
    buffer_store_dwordx4 v[116:119], v14, s[44:47], s41 offen offset:1024 sc1
    v_lshlrev_b32 v20, 16, v40
    v_and_b32 v21, s34, v40
    v_lshlrev_b32 v22, 16, v56
    v_and_b32 v23, s34, v56
    v_add_f32 v20, v20, v22
    v_add_f32 v21, v21, v23
    v_mul_f32 v20, s35, v20
    v_mul_f32 v21, s35, v21
    v_cvt_pk_bf16_f32 v120, v20, v21
    v_lshlrev_b32 v20, 16, v41
    v_and_b32 v21, s34, v41
    v_lshlrev_b32 v22, 16, v57
    v_and_b32 v23, s34, v57
    v_add_f32 v20, v20, v22
    v_add_f32 v21, v21, v23
    v_mul_f32 v20, s35, v20
    v_mul_f32 v21, s35, v21
    v_cvt_pk_bf16_f32 v121, v20, v21
    v_lshlrev_b32 v20, 16, v42
    v_and_b32 v21, s34, v42
    v_lshlrev_b32 v22, 16, v58
    v_and_b32 v23, s34, v58
    v_add_f32 v20, v20, v22
    v_add_f32 v21, v21, v23
    v_mul_f32 v20, s35, v20
    v_mul_f32 v21, s35, v21
    v_cvt_pk_bf16_f32 v122, v20, v21
    v_lshlrev_b32 v20, 16, v43
    v_and_b32 v21, s34, v43
    v_lshlrev_b32 v22, 16, v59
    v_and_b32 v23, s34, v59
    v_add_f32 v20, v20, v22
    v_add_f32 v21, v21, v23
    v_mul_f32 v20, s35, v20
    v_mul_f32 v21, s35, v21
    v_cvt_pk_bf16_f32 v123, v20, v21
    s_waitcnt vmcnt(6)
    s_barrier
    buffer_atomic_add v18, v17, s[48:51], 0 offen offset:4
    buffer_store_dwordx4 v[120:123], v15, s[44:47], s41 offen offset:0 sc1
    v_lshlrev_b32 v20, 16, v44
    v_and_b32 v21, s34, v44
    v_lshlrev_b32 v22, 16, v60
    v_and_b32 v23, s34, v60
    v_add_f32 v20, v20, v22
    v_add_f32 v21, v21, v23
    v_mul_f32 v20, s35, v20
    v_mul_f32 v21, s35, v21
    v_cvt_pk_bf16_f32 v124, v20, v21
    v_lshlrev_b32 v20, 16, v45
    v_and_b32 v21, s34, v45
    v_lshlrev_b32 v22, 16, v61
    v_and_b32 v23, s34, v61
    v_add_f32 v20, v20, v22
    v_add_f32 v21, v21, v23
    v_mul_f32 v20, s35, v20
    v_mul_f32 v21, s35, v21
    v_cvt_pk_bf16_f32 v125, v20, v21
    v_lshlrev_b32 v20, 16, v46
    v_and_b32 v21, s34, v46
    v_lshlrev_b32 v22, 16, v62
    v_and_b32 v23, s34, v62
    v_add_f32 v20, v20, v22
    v_add_f32 v21, v21, v23
    v_mul_f32 v20, s35, v20
    v_mul_f32 v21, s35, v21
    v_cvt_pk_bf16_f32 v126, v20, v21
    v_lshlrev_b32 v20, 16, v47
    v_and_b32 v21, s34, v47
    v_lshlrev_b32 v22, 16, v63
    v_and_b32 v23, s34, v63
    v_add_f32 v20, v20, v22
    v_add_f32 v21, v21, v23
    v_mul_f32 v20, s35, v20
    v_mul_f32 v21, s35, v21
    v_cvt_pk_bf16_f32 v127, v20, v21
    buffer_store_dwordx4 v[124:127], v15, s[44:47], s41 offen offset:1024 sc1
    ds_read_b64_tr_b16 v[64:65], v10 offset:16384
    ds_read_b64_tr_b16 v[66:67], v10 offset:16896
    ds_read_b64_tr_b16 v[68:69], v11 offset:16384
    ds_read_b64_tr_b16 v[70:71], v11 offset:16896
    ds_read_b64_tr_b16 v[72:73], v12 offset:16384
    ds_read_b64_tr_b16 v[74:75], v12 offset:16896
    ds_read_b64_tr_b16 v[76:77], v13 offset:16384
    ds_read_b64_tr_b16 v[78:79], v13 offset:16896
    ds_read_b64_tr_b16 v[80:81], v10 offset:20480
    ds_read_b64_tr_b16 v[82:83], v10 offset:20992
    ds_read_b64_tr_b16 v[84:85], v11 offset:20480
    ds_read_b64_tr_b16 v[86:87], v11 offset:20992
    ds_read_b64_tr_b16 v[88:89], v12 offset:20480
    ds_read_b64_tr_b16 v[90:91], v12 offset:20992
    ds_read_b64_tr_b16 v[92:93], v13 offset:20480
    ds_read_b64_tr_b16 v[94:95], v13 offset:20992
    s_add_u32 m0, s27, 32768
    s_add_u32 s38, s25, 393216
    buffer_load_dwordx4 v4, s[16:19], s38 offen lds
    s_add_u32 m0, s27, 33792
    s_add_u32 s38, s25, 401408
    buffer_load_dwordx4 v5, s[16:19], s38 offen lds
    s_add_u32 m0, s27, 34816
    s_add_u32 s38, s25, 409600
    buffer_load_dwordx4 v4, s[16:19], s38 offen lds
    s_add_u32 m0, s27, 35840
    s_add_u32 s38, s25, 417792
    buffer_load_dwordx4 v5, s[16:19], s38 offen lds
    s_add_u32 m0, s27, 36864
    s_add_u32 s38, s25, 655360
    buffer_load_dwordx4 v4, s[16:19], s38 offen lds
    s_add_u32 m0, s27, 37888
    s_add_u32 s38, s25, 663552
    buffer_load_dwordx4 v5, s[16:19], s38 offen lds
    s_add_u32 m0, s27, 38912
    s_add_u32 s38, s25, 671744
    buffer_load_dwordx4 v4, s[16:19], s38 offen lds
    s_add_u32 m0, s27, 39936
    s_add_u32 s38, s25, 679936
    buffer_load_dwordx4 v5, s[16:19], s38 offen lds
    s_add_u32 s41, s40, 262144
    s_waitcnt lgkmcnt(15)
    v_lshlrev_b32 v20, 16, v64
    v_and_b32 v21, s34, v64
    s_waitcnt lgkmcnt(7)
    v_lshlrev_b32 v22, 16, v80
    v_and_b32 v23, s34, v80
    v_add_f32 v20, v20, v22
    v_add_f32 v21, v21, v23
    v_mul_f32 v20, s35, v20
    v_mul_f32 v21, s35, v21
    v_cvt_pk_bf16_f32 v112, v20, v21
    v_lshlrev_b32 v20, 16, v65
    v_and_b32 v21, s34, v65
    v_lshlrev_b32 v22, 16, v81
    v_and_b32 v23, s34, v81
    v_add_f32 v20, v20, v22
    v_add_f32 v21, v21, v23
    v_mul_f32 v20, s35, v20
    v_mul_f32 v21, s35, v21
    v_cvt_pk_bf16_f32 v113, v20, v21
    v_lshlrev_b32 v20, 16, v66
    v_and_b32 v21, s34, v66
    s_waitcnt lgkmcnt(2)
    v_lshlrev_b32 v22, 16, v82
    v_and_b32 v23, s34, v82
    v_add_f32 v20, v20, v22
    v_add_f32 v21, v21, v23
    v_mul_f32 v20, s35, v20
    v_mul_f32 v21, s35, v21
    v_cvt_pk_bf16_f32 v114, v20, v21
    v_lshlrev_b32 v20, 16, v67
    v_and_b32 v21, s34, v67
    v_lshlrev_b32 v22, 16, v83
    v_and_b32 v23, s34, v83
    v_add_f32 v20, v20, v22
    v_add_f32 v21, v21, v23
    v_mul_f32 v20, s35, v20
    v_mul_f32 v21, s35, v21
    v_cvt_pk_bf16_f32 v115, v20, v21
    buffer_store_dwordx4 v[112:115], v14, s[44:47], s41 offen offset:0 sc1
    v_lshlrev_b32 v20, 16, v68
    v_and_b32 v21, s34, v68
    v_lshlrev_b32 v22, 16, v84
    v_and_b32 v23, s34, v84
    v_add_f32 v20, v20, v22
    v_add_f32 v21, v21, v23
    v_mul_f32 v20, s35, v20
    v_mul_f32 v21, s35, v21
    v_cvt_pk_bf16_f32 v116, v20, v21
    v_lshlrev_b32 v20, 16, v69
    v_and_b32 v21, s34, v69
    v_lshlrev_b32 v22, 16, v85
    v_and_b32 v23, s34, v85
    v_add_f32 v20, v20, v22
    v_add_f32 v21, v21, v23
    v_mul_f32 v20, s35, v20
    v_mul_f32 v21, s35, v21
    v_cvt_pk_bf16_f32 v117, v20, v21
    v_lshlrev_b32 v20, 16, v70
    v_and_b32 v21, s34, v70
    v_lshlrev_b32 v22, 16, v86
    v_and_b32 v23, s34, v86
    v_add_f32 v20, v20, v22
    v_add_f32 v21, v21, v23
    v_mul_f32 v20, s35, v20
    v_mul_f32 v21, s35, v21
    v_cvt_pk_bf16_f32 v118, v20, v21
    v_lshlrev_b32 v20, 16, v71
    v_and_b32 v21, s34, v71
    v_lshlrev_b32 v22, 16, v87
    v_and_b32 v23, s34, v87
    v_add_f32 v20, v20, v22
    v_add_f32 v21, v21, v23
    v_mul_f32 v20, s35, v20
    v_mul_f32 v21, s35, v21
    v_cvt_pk_bf16_f32 v119, v20, v21
    buffer_store_dwordx4 v[116:119], v14, s[44:47], s41 offen offset:1024 sc1
    v_lshlrev_b32 v20, 16, v72
    v_and_b32 v21, s34, v72
    v_lshlrev_b32 v22, 16, v88
    v_and_b32 v23, s34, v88
    v_add_f32 v20, v20, v22
    v_add_f32 v21, v21, v23
    v_mul_f32 v20, s35, v20
    v_mul_f32 v21, s35, v21
    v_cvt_pk_bf16_f32 v120, v20, v21
    v_lshlrev_b32 v20, 16, v73
    v_and_b32 v21, s34, v73
    v_lshlrev_b32 v22, 16, v89
    v_and_b32 v23, s34, v89
    v_add_f32 v20, v20, v22
    v_add_f32 v21, v21, v23
    v_mul_f32 v20, s35, v20
    v_mul_f32 v21, s35, v21
    v_cvt_pk_bf16_f32 v121, v20, v21
    v_lshlrev_b32 v20, 16, v74
    v_and_b32 v21, s34, v74
    v_lshlrev_b32 v22, 16, v90
    v_and_b32 v23, s34, v90
    v_add_f32 v20, v20, v22
    v_add_f32 v21, v21, v23
    v_mul_f32 v20, s35, v20
    v_mul_f32 v21, s35, v21
    v_cvt_pk_bf16_f32 v122, v20, v21
    v_lshlrev_b32 v20, 16, v75
    v_and_b32 v21, s34, v75
    v_lshlrev_b32 v22, 16, v91
    v_and_b32 v23, s34, v91
    v_add_f32 v20, v20, v22
    v_add_f32 v21, v21, v23
    v_mul_f32 v20, s35, v20
    v_mul_f32 v21, s35, v21
    v_cvt_pk_bf16_f32 v123, v20, v21
    buffer_store_dwordx4 v[120:123], v15, s[44:47], s41 offen offset:0 sc1
    v_lshlrev_b32 v20, 16, v76
    v_and_b32 v21, s34, v76
    s_waitcnt lgkmcnt(0)
    v_lshlrev_b32 v22, 16, v92
    v_and_b32 v23, s34, v92
    v_add_f32 v20, v20, v22
    v_add_f32 v21, v21, v23
    v_mul_f32 v20, s35, v20
    v_mul_f32 v21, s35, v21
    v_cvt_pk_bf16_f32 v124, v20, v21
    v_lshlrev_b32 v20, 16, v77
    v_and_b32 v21, s34, v77
    v_lshlrev_b32 v22, 16, v93
    v_and_b32 v23, s34, v93
    v_add_f32 v20, v20, v22
    v_add_f32 v21, v21, v23
    v_mul_f32 v20, s35, v20
    v_mul_f32 v21, s35, v21
    v_cvt_pk_bf16_f32 v125, v20, v21
    v_lshlrev_b32 v20, 16, v78
    v_and_b32 v21, s34, v78
    v_lshlrev_b32 v22, 16, v94
    v_and_b32 v23, s34, v94
    v_add_f32 v20, v20, v22
    v_add_f32 v21, v21, v23
    v_mul_f32 v20, s35, v20
    v_mul_f32 v21, s35, v21
    v_cvt_pk_bf16_f32 v126, v20, v21
    v_lshlrev_b32 v20, 16, v79
    v_and_b32 v21, s34, v79
    v_lshlrev_b32 v22, 16, v95
    v_and_b32 v23, s34, v95
    v_add_f32 v20, v20, v22
    v_add_f32 v21, v21, v23
    v_mul_f32 v20, s35, v20
    v_mul_f32 v21, s35, v21
    v_cvt_pk_bf16_f32 v127, v20, v21
    buffer_store_dwordx4 v[124:127], v15, s[44:47], s41 offen offset:1024 sc1
    s_waitcnt vmcnt(17)
    ds_read_b64_tr_b16 v[32:33], v10 offset:24576
    ds_read_b64_tr_b16 v[34:35], v10 offset:25088
    ds_read_b64_tr_b16 v[36:37], v11 offset:24576
    ds_read_b64_tr_b16 v[38:39], v11 offset:25088
    ds_read_b64_tr_b16 v[40:41], v12 offset:24576
    ds_read_b64_tr_b16 v[42:43], v12 offset:25088
    ds_read_b64_tr_b16 v[44:45], v13 offset:24576
    ds_read_b64_tr_b16 v[46:47], v13 offset:25088
    s_add_u32 m0, s27, 0
    s_add_u32 s38, s25, 917504
    buffer_load_dwordx4 v4, s[16:19], s38 offen lds
    s_add_u32 m0, s27, 1024
    s_add_u32 s38, s25, 925696
    buffer_load_dwordx4 v5, s[16:19], s38 offen lds
    s_add_u32 m0, s27, 2048
    s_add_u32 s38, s25, 933888
    buffer_load_dwordx4 v4, s[16:19], s38 offen lds
    s_add_u32 m0, s27, 3072
    s_add_u32 s38, s25, 942080
    buffer_load_dwordx4 v5, s[16:19], s38 offen lds
    s_add_u32 m0, s27, 4096
    s_add_u32 s38, s25, 1179648
    buffer_load_dwordx4 v4, s[16:19], s38 offen lds
    s_add_u32 m0, s27, 5120
    s_add_u32 s38, s25, 1187840
    buffer_load_dwordx4 v5, s[16:19], s38 offen lds
    s_add_u32 m0, s27, 6144
    s_add_u32 s38, s25, 1196032
    buffer_load_dwordx4 v4, s[16:19], s38 offen lds
    s_add_u32 m0, s27, 7168
    s_add_u32 s38, s25, 1204224
    buffer_load_dwordx4 v5, s[16:19], s38 offen lds
    s_add_u32 s41, s40, 196608
    s_waitcnt lgkmcnt(7)
    v_lshlrev_b32 v20, 16, v32
    v_and_b32 v21, s34, v32
    v_mul_f32 v20, s35, v20
    v_mul_f32 v21, s35, v21
    v_cvt_pk_bf16_f32 v112, v20, v21
    v_lshlrev_b32 v20, 16, v33
    v_and_b32 v21, s34, v33
    v_mul_f32 v20, s35, v20
    v_mul_f32 v21, s35, v21
    v_cvt_pk_bf16_f32 v113, v20, v21
    s_waitcnt lgkmcnt(6)
    v_lshlrev_b32 v20, 16, v34
    v_and_b32 v21, s34, v34
    v_mul_f32 v20, s35, v20
    v_mul_f32 v21, s35, v21
    v_cvt_pk_bf16_f32 v114, v20, v21
    v_lshlrev_b32 v20, 16, v35
    v_and_b32 v21, s34, v35
    v_mul_f32 v20, s35, v20
    v_mul_f32 v21, s35, v21
    v_cvt_pk_bf16_f32 v115, v20, v21
    buffer_store_dwordx4 v[112:115], v14, s[44:47], s41 offen offset:0 sc1
    s_waitcnt lgkmcnt(1)
    v_lshlrev_b32 v20, 16, v36
    v_and_b32 v21, s34, v36
    v_mul_f32 v20, s35, v20
    v_mul_f32 v21, s35, v21
    v_cvt_pk_bf16_f32 v116, v20, v21
    v_lshlrev_b32 v20, 16, v37
    v_and_b32 v21, s34, v37
    v_mul_f32 v20, s35, v20
    v_mul_f32 v21, s35, v21
    v_cvt_pk_bf16_f32 v117, v20, v21
    v_lshlrev_b32 v20, 16, v38
    v_and_b32 v21, s34, v38
    v_mul_f32 v20, s35, v20
    v_mul_f32 v21, s35, v21
    v_cvt_pk_bf16_f32 v118, v20, v21
    v_lshlrev_b32 v20, 16, v39
    v_and_b32 v21, s34, v39
    v_mul_f32 v20, s35, v20
    v_mul_f32 v21, s35, v21
    v_cvt_pk_bf16_f32 v119, v20, v21
    buffer_store_dwordx4 v[116:119], v14, s[44:47], s41 offen offset:1024 sc1
    v_lshlrev_b32 v20, 16, v40
    v_and_b32 v21, s34, v40
    v_mul_f32 v20, s35, v20
    v_mul_f32 v21, s35, v21
    v_cvt_pk_bf16_f32 v120, v20, v21
    v_lshlrev_b32 v20, 16, v41
    v_and_b32 v21, s34, v41
    v_mul_f32 v20, s35, v20
    v_mul_f32 v21, s35, v21
    v_cvt_pk_bf16_f32 v121, v20, v21
    v_lshlrev_b32 v20, 16, v42
    v_and_b32 v21, s34, v42
    v_mul_f32 v20, s35, v20
    v_mul_f32 v21, s35, v21
    v_cvt_pk_bf16_f32 v122, v20, v21
    v_lshlrev_b32 v20, 16, v43
    v_and_b32 v21, s34, v43
    v_mul_f32 v20, s35, v20
    v_mul_f32 v21, s35, v21
    v_cvt_pk_bf16_f32 v123, v20, v21
    buffer_store_dwordx4 v[120:123], v15, s[44:47], s41 offen offset:0 sc1
    v_lshlrev_b32 v20, 16, v44
    v_and_b32 v21, s34, v44
    v_mul_f32 v20, s35, v20
    v_mul_f32 v21, s35, v21
    v_cvt_pk_bf16_f32 v124, v20, v21
    v_lshlrev_b32 v20, 16, v45
    v_and_b32 v21, s34, v45
    v_mul_f32 v20, s35, v20
    v_mul_f32 v21, s35, v21
    v_cvt_pk_bf16_f32 v125, v20, v21
    s_waitcnt lgkmcnt(0)
    v_lshlrev_b32 v20, 16, v46
    v_and_b32 v21, s34, v46
    v_mul_f32 v20, s35, v20
    v_mul_f32 v21, s35, v21
    v_cvt_pk_bf16_f32 v126, v20, v21
    v_lshlrev_b32 v20, 16, v47
    v_and_b32 v21, s34, v47
    v_mul_f32 v20, s35, v20
    v_mul_f32 v21, s35, v21
    v_cvt_pk_bf16_f32 v127, v20, v21
    buffer_store_dwordx4 v[124:127], v15, s[44:47], s41 offen offset:1024 sc1
    s_waitcnt vmcnt(20)
    ds_read_b64_tr_b16 v[64:65], v10 offset:32768
    ds_read_b64_tr_b16 v[66:67], v10 offset:33280
    ds_read_b64_tr_b16 v[68:69], v11 offset:32768
    ds_read_b64_tr_b16 v[70:71], v11 offset:33280
    ds_read_b64_tr_b16 v[72:73], v12 offset:32768
    ds_read_b64_tr_b16 v[74:75], v12 offset:33280
    ds_read_b64_tr_b16 v[76:77], v13 offset:32768
    ds_read_b64_tr_b16 v[78:79], v13 offset:33280
    s_waitcnt vmcnt(16)
    ds_read_b64_tr_b16 v[80:81], v10 offset:36864
    ds_read_b64_tr_b16 v[82:83], v10 offset:37376
    ds_read_b64_tr_b16 v[84:85], v11 offset:36864
    ds_read_b64_tr_b16 v[86:87], v11 offset:37376
    ds_read_b64_tr_b16 v[88:89], v12 offset:36864
    ds_read_b64_tr_b16 v[90:91], v12 offset:37376
    ds_read_b64_tr_b16 v[92:93], v13 offset:36864
    ds_read_b64_tr_b16 v[94:95], v13 offset:37376
    s_add_u32 m0, s27, 8192
    s_add_u32 s38, s25, 131072
    buffer_load_dwordx4 v4, s[16:19], s38 offen lds
    s_add_u32 m0, s27, 9216
    s_add_u32 s38, s25, 139264
    buffer_load_dwordx4 v5, s[16:19], s38 offen lds
    s_add_u32 m0, s27, 10240
    s_add_u32 s38, s25, 147456
    buffer_load_dwordx4 v4, s[16:19], s38 offen lds
    s_add_u32 m0, s27, 11264
    s_add_u32 s38, s25, 155648
    buffer_load_dwordx4 v5, s[16:19], s38 offen lds
    s_add_u32 s41, s40, 425984
    s_waitcnt lgkmcnt(15)
    v_lshlrev_b32 v20, 16, v64
    v_and_b32 v21, s34, v64
    s_waitcnt lgkmcnt(7)
    v_lshlrev_b32 v22, 16, v80
    v_and_b32 v23, s34, v80
    v_add_f32 v20, v20, v22
    v_add_f32 v21, v21, v23
    v_mul_f32 v20, s35, v20
    v_mul_f32 v21, s35, v21
    v_cvt_pk_bf16_f32 v112, v20, v21
    v_lshlrev_b32 v20, 16, v65
    v_and_b32 v21, s34, v65
    v_lshlrev_b32 v22, 16, v81
    v_and_b32 v23, s34, v81
    v_add_f32 v20, v20, v22
    v_add_f32 v21, v21, v23
    v_mul_f32 v20, s35, v20
    v_mul_f32 v21, s35, v21
    v_cvt_pk_bf16_f32 v113, v20, v21
    v_lshlrev_b32 v20, 16, v66
    v_and_b32 v21, s34, v66
    s_waitcnt lgkmcnt(6)
    v_lshlrev_b32 v22, 16, v82
    v_and_b32 v23, s34, v82
    v_add_f32 v20, v20, v22
    v_add_f32 v21, v21, v23
    v_mul_f32 v20, s35, v20
    v_mul_f32 v21, s35, v21
    v_cvt_pk_bf16_f32 v114, v20, v21
    v_lshlrev_b32 v20, 16, v67
    v_and_b32 v21, s34, v67
    v_lshlrev_b32 v22, 16, v83
    v_and_b32 v23, s34, v83
    v_add_f32 v20, v20, v22
    v_add_f32 v21, v21, v23
    v_mul_f32 v20, s35, v20
    v_mul_f32 v21, s35, v21
    v_cvt_pk_bf16_f32 v115, v20, v21
    buffer_store_dwordx4 v[112:115], v14, s[44:47], s41 offen offset:0 sc1
    v_lshlrev_b32 v20, 16, v68
    v_and_b32 v21, s34, v68
    s_waitcnt lgkmcnt(0)
    v_lshlrev_b32 v22, 16, v84
    v_and_b32 v23, s34, v84
    v_add_f32 v20, v20, v22
    v_add_f32 v21, v21, v23
    v_mul_f32 v20, s35, v20
    v_mul_f32 v21, s35, v21
    v_cvt_pk_bf16_f32 v116, v20, v21
    v_lshlrev_b32 v20, 16, v69
    v_and_b32 v21, s34, v69
    v_lshlrev_b32 v22, 16, v85
    v_and_b32 v23, s34, v85
    v_add_f32 v20, v20, v22
    v_add_f32 v21, v21, v23
    v_mul_f32 v20, s35, v20
    v_mul_f32 v21, s35, v21
    v_cvt_pk_bf16_f32 v117, v20, v21
    v_lshlrev_b32 v20, 16, v70
    v_and_b32 v21, s34, v70
    v_lshlrev_b32 v22, 16, v86
    v_and_b32 v23, s34, v86
    v_add_f32 v20, v20, v22
    v_add_f32 v21, v21, v23
    v_mul_f32 v20, s35, v20
    v_mul_f32 v21, s35, v21
    v_cvt_pk_bf16_f32 v118, v20, v21
    v_lshlrev_b32 v20, 16, v71
    v_and_b32 v21, s34, v71
    v_lshlrev_b32 v22, 16, v87
    v_and_b32 v23, s34, v87
    v_add_f32 v20, v20, v22
    v_add_f32 v21, v21, v23
    v_mul_f32 v20, s35, v20
    v_mul_f32 v21, s35, v21
    v_cvt_pk_bf16_f32 v119, v20, v21
    buffer_store_dwordx4 v[116:119], v14, s[44:47], s41 offen offset:1024 sc1
    v_lshlrev_b32 v20, 16, v72
    v_and_b32 v21, s34, v72
    v_lshlrev_b32 v22, 16, v88
    v_and_b32 v23, s34, v88
    v_add_f32 v20, v20, v22
    v_add_f32 v21, v21, v23
    v_mul_f32 v20, s35, v20
    v_mul_f32 v21, s35, v21
    v_cvt_pk_bf16_f32 v120, v20, v21
    v_lshlrev_b32 v20, 16, v73
    v_and_b32 v21, s34, v73
    v_lshlrev_b32 v22, 16, v89
    v_and_b32 v23, s34, v89
    v_add_f32 v20, v20, v22
    v_add_f32 v21, v21, v23
    v_mul_f32 v20, s35, v20
    v_mul_f32 v21, s35, v21
    v_cvt_pk_bf16_f32 v121, v20, v21
    v_lshlrev_b32 v20, 16, v74
    v_and_b32 v21, s34, v74
    v_lshlrev_b32 v22, 16, v90
    v_and_b32 v23, s34, v90
    v_add_f32 v20, v20, v22
    v_add_f32 v21, v21, v23
    v_mul_f32 v20, s35, v20
    v_mul_f32 v21, s35, v21
    v_cvt_pk_bf16_f32 v122, v20, v21
    v_lshlrev_b32 v20, 16, v75
    v_and_b32 v21, s34, v75
    v_lshlrev_b32 v22, 16, v91
    v_and_b32 v23, s34, v91
    v_add_f32 v20, v20, v22
    v_add_f32 v21, v21, v23
    v_mul_f32 v20, s35, v20
    v_mul_f32 v21, s35, v21
    v_cvt_pk_bf16_f32 v123, v20, v21
    s_waitcnt vmcnt(6)
    s_barrier
    buffer_atomic_add v18, v17, s[48:51], 0 offen offset:8
    buffer_store_dwordx4 v[120:123], v15, s[44:47], s41 offen offset:0 sc1
    v_lshlrev_b32 v20, 16, v76
    v_and_b32 v21, s34, v76
    v_lshlrev_b32 v22, 16, v92
    v_and_b32 v23, s34, v92
    v_add_f32 v20, v20, v22
    v_add_f32 v21, v21, v23
    v_mul_f32 v20, s35, v20
    v_mul_f32 v21, s35, v21
    v_cvt_pk_bf16_f32 v124, v20, v21
    v_lshlrev_b32 v20, 16, v77
    v_and_b32 v21, s34, v77
    v_lshlrev_b32 v22, 16, v93
    v_and_b32 v23, s34, v93
    v_add_f32 v20, v20, v22
    v_add_f32 v21, v21, v23
    v_mul_f32 v20, s35, v20
    v_mul_f32 v21, s35, v21
    v_cvt_pk_bf16_f32 v125, v20, v21
    v_lshlrev_b32 v20, 16, v78
    v_and_b32 v21, s34, v78
    v_lshlrev_b32 v22, 16, v94
    v_and_b32 v23, s34, v94
    v_add_f32 v20, v20, v22
    v_add_f32 v21, v21, v23
    v_mul_f32 v20, s35, v20
    v_mul_f32 v21, s35, v21
    v_cvt_pk_bf16_f32 v126, v20, v21
    v_lshlrev_b32 v20, 16, v79
    v_and_b32 v21, s34, v79
    v_lshlrev_b32 v22, 16, v95
    v_and_b32 v23, s34, v95
    v_add_f32 v20, v20, v22
    v_add_f32 v21, v21, v23
    v_mul_f32 v20, s35, v20
    v_mul_f32 v21, s35, v21
    v_cvt_pk_bf16_f32 v127, v20, v21
    buffer_store_dwordx4 v[124:127], v15, s[44:47], s41 offen offset:1024 sc1
    ds_read_b64_tr_b16 v[32:33], v10 offset:0
    ds_read_b64_tr_b16 v[34:35], v10 offset:512
    ds_read_b64_tr_b16 v[36:37], v11 offset:0
    ds_read_b64_tr_b16 v[38:39], v11 offset:512
    ds_read_b64_tr_b16 v[40:41], v12 offset:0
    ds_read_b64_tr_b16 v[42:43], v12 offset:512
    ds_read_b64_tr_b16 v[44:45], v13 offset:0
    ds_read_b64_tr_b16 v[46:47], v13 offset:512
    ds_read_b64_tr_b16 v[48:49], v10 offset:4096
    ds_read_b64_tr_b16 v[50:51], v10 offset:4608
    ds_read_b64_tr_b16 v[52:53], v11 offset:4096
    ds_read_b64_tr_b16 v[54:55], v11 offset:4608
    ds_read_b64_tr_b16 v[56:57], v12 offset:4096
    ds_read_b64_tr_b16 v[58:59], v12 offset:4608
    ds_read_b64_tr_b16 v[60:61], v13 offset:4096
    ds_read_b64_tr_b16 v[62:63], v13 offset:4608
    s_add_u32 s41, s40, 458752
    s_waitcnt lgkmcnt(15)
    v_lshlrev_b32 v20, 16, v32
    v_and_b32 v21, s34, v32
    s_waitcnt lgkmcnt(7)
    v_lshlrev_b32 v22, 16, v48
    v_and_b32 v23, s34, v48
    v_add_f32 v20, v20, v22
    v_add_f32 v21, v21, v23
    v_mul_f32 v20, s35, v20
    v_mul_f32 v21, s35, v21
    v_cvt_pk_bf16_f32 v112, v20, v21
    v_lshlrev_b32 v20, 16, v33
    v_and_b32 v21, s34, v33
    v_lshlrev_b32 v22, 16, v49
    v_and_b32 v23, s34, v49
    v_add_f32 v20, v20, v22
    v_add_f32 v21, v21, v23
    v_mul_f32 v20, s35, v20
    v_mul_f32 v21, s35, v21
    v_cvt_pk_bf16_f32 v113, v20, v21
    v_lshlrev_b32 v20, 16, v34
    v_and_b32 v21, s34, v34
    s_waitcnt lgkmcnt(6)
    v_lshlrev_b32 v22, 16, v50
    v_and_b32 v23, s34, v50
    v_add_f32 v20, v20, v22
    v_add_f32 v21, v21, v23
    v_mul_f32 v20, s35, v20
    v_mul_f32 v21, s35, v21
    v_cvt_pk_bf16_f32 v114, v20, v21
    v_lshlrev_b32 v20, 16, v35
    v_and_b32 v21, s34, v35
    v_lshlrev_b32 v22, 16, v51
    v_and_b32 v23, s34, v51
    v_add_f32 v20, v20, v22
    v_add_f32 v21, v21, v23
    v_mul_f32 v20, s35, v20
    v_mul_f32 v21, s35, v21
    v_cvt_pk_bf16_f32 v115, v20, v21
    buffer_store_dwordx4 v[112:115], v14, s[44:47], s41 offen offset:0 sc1
    v_lshlrev_b32 v20, 16, v36
    v_and_b32 v21, s34, v36
    s_waitcnt lgkmcnt(5)
    v_lshlrev_b32 v22, 16, v52
    v_and_b32 v23, s34, v52
    v_add_f32 v20, v20, v22
    v_add_f32 v21, v21, v23
    v_mul_f32 v20, s35, v20
    v_mul_f32 v21, s35, v21
    v_cvt_pk_bf16_f32 v116, v20, v21
    v_lshlrev_b32 v20, 16, v37
    v_and_b32 v21, s34, v37
    v_lshlrev_b32 v22, 16, v53
    v_and_b32 v23, s34, v53
    v_add_f32 v20, v20, v22
    v_add_f32 v21, v21, v23
    v_mul_f32 v20, s35, v20
    v_mul_f32 v21, s35, v21
    v_cvt_pk_bf16_f32 v117, v20, v21
    v_lshlrev_b32 v20, 16, v38
    v_and_b32 v21, s34, v38
    s_waitcnt lgkmcnt(0)
    v_lshlrev_b32 v22, 16, v54
    v_and_b32 v23, s34, v54
    v_add_f32 v20, v20, v22
    v_add_f32 v21, v21, v23
    v_mul_f32 v20, s35, v20
    v_mul_f32 v21, s35, v21
    v_cvt_pk_bf16_f32 v118, v20, v21
    v_lshlrev_b32 v20, 16, v39
    v_and_b32 v21, s34, v39
    v_lshlrev_b32 v22, 16, v55
    v_and_b32 v23, s34, v55
    v_add_f32 v20, v20, v22
    v_add_f32 v21, v21, v23
    v_mul_f32 v20, s35, v20
    v_mul_f32 v21, s35, v21
    v_cvt_pk_bf16_f32 v119, v20, v21
    buffer_store_dwordx4 v[116:119], v14, s[44:47], s41 offen offset:1024 sc1
    v_lshlrev_b32 v20, 16, v40
    v_and_b32 v21, s34, v40
    v_lshlrev_b32 v22, 16, v56
    v_and_b32 v23, s34, v56
    v_add_f32 v20, v20, v22
    v_add_f32 v21, v21, v23
    v_mul_f32 v20, s35, v20
    v_mul_f32 v21, s35, v21
    v_cvt_pk_bf16_f32 v120, v20, v21
    v_lshlrev_b32 v20, 16, v41
    v_and_b32 v21, s34, v41
    v_lshlrev_b32 v22, 16, v57
    v_and_b32 v23, s34, v57
    v_add_f32 v20, v20, v22
    v_add_f32 v21, v21, v23
    v_mul_f32 v20, s35, v20
    v_mul_f32 v21, s35, v21
    v_cvt_pk_bf16_f32 v121, v20, v21
    v_lshlrev_b32 v20, 16, v42
    v_and_b32 v21, s34, v42
    v_lshlrev_b32 v22, 16, v58
    v_and_b32 v23, s34, v58
    v_add_f32 v20, v20, v22
    v_add_f32 v21, v21, v23
    v_mul_f32 v20, s35, v20
    v_mul_f32 v21, s35, v21
    v_cvt_pk_bf16_f32 v122, v20, v21
    v_lshlrev_b32 v20, 16, v43
    v_and_b32 v21, s34, v43
    v_lshlrev_b32 v22, 16, v59
    v_and_b32 v23, s34, v59
    v_add_f32 v20, v20, v22
    v_add_f32 v21, v21, v23
    v_mul_f32 v20, s35, v20
    v_mul_f32 v21, s35, v21
    v_cvt_pk_bf16_f32 v123, v20, v21
    buffer_store_dwordx4 v[120:123], v15, s[44:47], s41 offen offset:0 sc1
    v_lshlrev_b32 v20, 16, v44
    v_and_b32 v21, s34, v44
    v_lshlrev_b32 v22, 16, v60
    v_and_b32 v23, s34, v60
    v_add_f32 v20, v20, v22
    v_add_f32 v21, v21, v23
    v_mul_f32 v20, s35, v20
    v_mul_f32 v21, s35, v21
    v_cvt_pk_bf16_f32 v124, v20, v21
    v_lshlrev_b32 v20, 16, v45
    v_and_b32 v21, s34, v45
    v_lshlrev_b32 v22, 16, v61
    v_and_b32 v23, s34, v61
    v_add_f32 v20, v20, v22
    v_add_f32 v21, v21, v23
    v_mul_f32 v20, s35, v20
    v_mul_f32 v21, s35, v21
    v_cvt_pk_bf16_f32 v125, v20, v21
    v_lshlrev_b32 v20, 16, v46
    v_and_b32 v21, s34, v46
    v_lshlrev_b32 v22, 16, v62
    v_and_b32 v23, s34, v62
    v_add_f32 v20, v20, v22
    v_add_f32 v21, v21, v23
    v_mul_f32 v20, s35, v20
    v_mul_f32 v21, s35, v21
    v_cvt_pk_bf16_f32 v126, v20, v21
    v_lshlrev_b32 v20, 16, v47
    v_and_b32 v21, s34, v47
    v_lshlrev_b32 v22, 16, v63
    v_and_b32 v23, s34, v63
    v_add_f32 v20, v20, v22
    v_add_f32 v21, v21, v23
    v_mul_f32 v20, s35, v20
    v_mul_f32 v21, s35, v21
    v_cvt_pk_bf16_f32 v127, v20, v21
    buffer_store_dwordx4 v[124:127], v15, s[44:47], s41 offen offset:1024 sc1
    s_waitcnt vmcnt(9)
    ds_read_b64_tr_b16 v[64:65], v10 offset:8192
    ds_read_b64_tr_b16 v[66:67], v10 offset:8704
    ds_read_b64_tr_b16 v[68:69], v11 offset:8192
    ds_read_b64_tr_b16 v[70:71], v11 offset:8704
    ds_read_b64_tr_b16 v[72:73], v12 offset:8192
    ds_read_b64_tr_b16 v[74:75], v12 offset:8704
    ds_read_b64_tr_b16 v[76:77], v13 offset:8192
    ds_read_b64_tr_b16 v[78:79], v13 offset:8704
    s_add_u32 s41, s40, 393216
    s_waitcnt lgkmcnt(7)
    v_lshlrev_b32 v20, 16, v64
    v_and_b32 v21, s34, v64
    v_mul_f32 v20, s35, v20
    v_mul_f32 v21, s35, v21
    v_cvt_pk_bf16_f32 v112, v20, v21
    v_lshlrev_b32 v20, 16, v65
    v_and_b32 v21, s34, v65
    v_mul_f32 v20, s35, v20
    v_mul_f32 v21, s35, v21
    v_cvt_pk_bf16_f32 v113, v20, v21
    s_waitcnt lgkmcnt(6)
    v_lshlrev_b32 v20, 16, v66
    v_and_b32 v21, s34, v66
    v_mul_f32 v20, s35, v20
    v_mul_f32 v21, s35, v21
    v_cvt_pk_bf16_f32 v114, v20, v21
    v_lshlrev_b32 v20, 16, v67
    v_and_b32 v21, s34, v67
    v_mul_f32 v20, s35, v20
    v_mul_f32 v21, s35, v21
    v_cvt_pk_bf16_f32 v115, v20, v21
    buffer_store_dwordx4 v[112:115], v14, s[44:47], s41 offen offset:0 sc1
    s_waitcnt lgkmcnt(5)
    v_lshlrev_b32 v20, 16, v68
    v_and_b32 v21, s34, v68
    v_mul_f32 v20, s35, v20
    v_mul_f32 v21, s35, v21
    v_cvt_pk_bf16_f32 v116, v20, v21
    v_lshlrev_b32 v20, 16, v69
    v_and_b32 v21, s34, v69
    v_mul_f32 v20, s35, v20
    v_mul_f32 v21, s35, v21
    v_cvt_pk_bf16_f32 v117, v20, v21
    s_waitcnt lgkmcnt(4)
    v_lshlrev_b32 v20, 16, v70
    v_and_b32 v21, s34, v70
    v_mul_f32 v20, s35, v20
    v_mul_f32 v21, s35, v21
    v_cvt_pk_bf16_f32 v118, v20, v21
    v_lshlrev_b32 v20, 16, v71
    v_and_b32 v21, s34, v71
    v_mul_f32 v20, s35, v20
    v_mul_f32 v21, s35, v21
    v_cvt_pk_bf16_f32 v119, v20, v21
    buffer_store_dwordx4 v[116:119], v14, s[44:47], s41 offen offset:1024 sc1
    s_waitcnt lgkmcnt(2)
    v_lshlrev_b32 v20, 16, v72
    v_and_b32 v21, s34, v72
    v_mul_f32 v20, s35, v20
    v_mul_f32 v21, s35, v21
    v_cvt_pk_bf16_f32 v120, v20, v21
    v_lshlrev_b32 v20, 16, v73
    v_and_b32 v21, s34, v73
    v_mul_f32 v20, s35, v20
    v_mul_f32 v21, s35, v21
    v_cvt_pk_bf16_f32 v121, v20, v21
    v_lshlrev_b32 v20, 16, v74
    v_and_b32 v21, s34, v74
    v_mul_f32 v20, s35, v20
    v_mul_f32 v21, s35, v21
    v_cvt_pk_bf16_f32 v122, v20, v21
    v_lshlrev_b32 v20, 16, v75
    v_and_b32 v21, s34, v75
    v_mul_f32 v20, s35, v20
    v_mul_f32 v21, s35, v21
    v_cvt_pk_bf16_f32 v123, v20, v21
    buffer_store_dwordx4 v[120:123], v15, s[44:47], s41 offen offset:0 sc1
    s_waitcnt lgkmcnt(0)
    v_lshlrev_b32 v20, 16, v76
    v_and_b32 v21, s34, v76
    v_mul_f32 v20, s35, v20
    v_mul_f32 v21, s35, v21
    v_cvt_pk_bf16_f32 v124, v20, v21
    v_lshlrev_b32 v20, 16, v77
    v_and_b32 v21, s34, v77
    v_mul_f32 v20, s35, v20
    v_mul_f32 v21, s35, v21
    v_cvt_pk_bf16_f32 v125, v20, v21
    v_lshlrev_b32 v20, 16, v78
    v_and_b32 v21, s34, v78
    v_mul_f32 v20, s35, v20
    v_mul_f32 v21, s35, v21
    v_cvt_pk_bf16_f32 v126, v20, v21
    v_lshlrev_b32 v20, 16, v79
    v_and_b32 v21, s34, v79
    v_mul_f32 v20, s35, v20
    v_mul_f32 v21, s35, v21
    v_cvt_pk_bf16_f32 v127, v20, v21
    buffer_store_dwordx4 v[124:127], v15, s[44:47], s41 offen offset:1024 sc1
    s_waitcnt vmcnt(0)
    s_barrier
    buffer_atomic_add v18, v17, s[48:51], 0 offen offset:12
L_exit:
    s_endpgm
L_code_end:
.section .rodata,"a"
.p2align 6
.amdhsa_kernel standalone__autoregressive_conv_wavernn__speech_kernel
  .amdhsa_next_free_vgpr 512
  .amdhsa_next_free_sgpr 96
  .amdhsa_accum_offset 256
  .amdhsa_group_segment_fixed_size 0
  .amdhsa_kernarg_size 40
  .amdhsa_user_sgpr_count 2
  .amdhsa_user_sgpr_kernarg_segment_ptr 1
  .amdhsa_system_sgpr_workgroup_id_x 1
.end_amdhsa_kernel
```
